```python
import torch

def _softmax(x, axis=-1):
    return torch.softmax(x, dim=axis)
def _gelu(x):
    return torch.nn.functional.gelu(x, approximate="tanh")
def _silu(x):
    return torch.nn.functional.silu(x)
def _sigmoid(x):
    return torch.sigmoid(x)
def _layernorm(x, axis=-1, eps=1e-5):
    m = x.mean(dim=axis, keepdim=True)
    v = x.var(dim=axis, keepdim=True, unbiased=False)
    return (x - m) / torch.sqrt(v + eps)
def _scatter_add(tgt, idx, src, axis=0):
    return tgt.clone().index_add_(axis, idx, src)
def _segment_sum(src, seg, n):
    out = torch.zeros((n,) + src.shape[1:], dtype=src.dtype)
    return out.index_add_(0, seg, src)
def _pad(x, pw):
    flat = tuple(v for pair in reversed(pw) for v in pair)
    return torch.nn.functional.pad(x, flat)

kernel_name = 'recurrent_scan__sliding_local_dilated__glu_gated_reglu__prompt'

def setup_inputs():

    _w = (lambda a: (lambda t: t.to(torch.bfloat16) if t.is_floating_point() else t)(torch.as_tensor(a)))
    def _A_setup():
        B, S, D = 1, 2048, 640
        return {
            "x": _w((lambda *s: torch.randn(*s, dtype=torch.bfloat16) * 0.05)(B, S, D)),
            "wqkv": _w((lambda *s: torch.randn(*s, dtype=torch.bfloat16) * 0.2)(D, 3 * D)),
            "wo": _w((lambda *s: torch.randn(*s, dtype=torch.bfloat16) * 0.2)(D, D)),
        }
    _A_in = _A_setup()

    def _B_setup():
        B, S, D, F = 1, 2048, 640, 1728
        return {
            "x": _w((lambda *s: torch.randn(*s, dtype=torch.bfloat16) * 0.05)(B, S, D)),
            "W_gate": _w((lambda *s: torch.randn(*s, dtype=torch.bfloat16) * 0.1)(D, F) * (2.0 / D) ** 0.5),
            "W_up": _w((lambda *s: torch.randn(*s, dtype=torch.bfloat16) * 0.1)(D, F) * (2.0 / D) ** 0.5),
            "W_down": _w((lambda *s: torch.randn(*s, dtype=torch.bfloat16) * 0.1)(F, D) * (1.0 / F) ** 0.5),
        }
    _B_in = _B_setup()

    return {
        "A_x": _A_in["x"],
        "A_wqkv": _A_in["wqkv"],
        "A_wo": _A_in["wo"],
        "B_x": _B_in["x"],
        "B_W_gate": _B_in["W_gate"],
        "B_W_up": _B_in["W_up"],
        "B_W_down": _B_in["W_down"],
    }

def reference(A_x, A_wqkv, A_wo, B_x, B_W_gate, B_W_up, B_W_down):
    def _A_ref(x, wqkv, wo):
        B, S, D = x.shape
        H = 32; Dh = D // H
        W, dil = 8, 2
        qkv = (lambda x, *d: x.permute(*d))((x @ wqkv).reshape(B, S, 3, H, Dh), 2, 0, 3, 1, 4)
        q, k, v = qkv[0], qkv[1], qkv[2]
        scale = Dh ** -0.5
        pos = torch.arange(S)
        off = torch.arange(W) * dil
        idx = pos[:, None] - off[None, :]
        mask = idx >= 0
        idx_c = torch.where(mask, idx, 0).reshape(-1)
        kg = k[:, :, idx_c, :].reshape(B, H, S, W, Dh)
        vg = v[:, :, idx_c, :].reshape(B, H, S, W, Dh)
        logits = torch.einsum("bhsd,bhswd->bhsw", q, kg) * scale
        logits = torch.where(mask[None, None, :, :], logits, -1e9)
        attn = _softmax(logits, axis=-1)
        o = torch.einsum("bhsw,bhswd->bhsd", attn, vg)
        return (lambda x, *d: x.permute(*d))(o, 0, 2, 1, 3).reshape(B, S, D) @ wo

    def _B_ref(x, W_gate, W_up, W_down):
        gate = torch.einsum("bsd,df->bsf", x, W_gate)
        up = torch.einsum("bsd,df->bsf", x, W_up)
        gate = gate * (lambda x, dt: x.to(dt))(gate > 0, gate.dtype)
        h = gate * up
        return torch.einsum("bsf,fd->bsd", h, W_down)

    x = A_x
    xn = _layernorm(x, axis=-1)
    s = _A_ref(xn, A_wqkv, A_wo)
    g = _silu(_B_ref(xn, B_W_gate, B_W_up, B_W_down))
    return x + s * g
```

```asm
; @launch grid=(256,1,1) block=(256,1,1) lds=163840
.amdgcn_target "amdgcn-amd-amdhsa--gfx950"
.text
.globl recurrent_scan__sliding_local_dilated__glu_gated_reglu__prompt_kernel
.p2align 8
.type recurrent_scan__sliding_local_dilated__glu_gated_reglu__prompt_kernel,@function
recurrent_scan__sliding_local_dilated__glu_gated_reglu__prompt_kernel:
    s_cmp_ge_u32 s2, 256
    s_cbranch_scc1 L_exit
    s_load_dwordx16 s[36:51], s[0:1], 0
    s_load_dwordx4 s[52:55], s[0:1], 64
    s_lshr_b32 s65, s2, 3
    s_getpc_b64 s[66:67]
L_pc:
    s_and_b32 s3, s65, 15
    s_lshl_b32 s3, s3, 12
    v_lshrrev_b32 v1, 3, v0
    v_lshl_add_u32 v1, v1, 7, s3
    v_min_u32 v22, CODE_END-L_pc-4, v1
    global_load_dword v63, v22, s[66:67]
    s_mov_b64 s[28:29], s[66:67]
    v_lshrrev_b32 v1, 6, v0
    v_and_b32 v0, 63, v0
    v_readfirstlane_b32 s4, v1
    s_and_b32 s64, s2, 7
    s_and_b32 s68, s64, 1
    s_lshr_b32 s69, s64, 1
    v_lshrrev_b32 v3, 3, v0
    v_lshlrev_b32 v21, 4, v0
    s_cmp_ge_u32 s65, 18
    s_cbranch_scc1 L_qkv
L_gu:
    s_and_b32 s5, s65, 7
    s_lshr_b32 s6, s65, 3
    s_lshl_b32 s3, s69, 1
    s_add_u32 s6, s6, s3
    s_add_u32 s7, s5, s3
    s_cmp_ge_u32 s65, 16
    s_cselect_b32 s5, s7, s5
    s_cselect_b32 s6, 8, s6
    s_cselect_b32 s7, 4, 0
    s_lshl_b32 s3, s68, 3
    s_add_u32 s5, s5, s3
    s_and_b32 s3, s6, 1
    s_mul_i32 s3, s3, 2
    s_add_u32 s3, s3, s7
    s_add_u32 s3, s3, s5
    s_mul_i32 s7, s3, 52
    s_lshr_b32 s7, s7, 8
    s_mul_i32 s7, s7, 5
    s_sub_u32 s3, s3, s7
    s_mov_b32 s30, 0x76543210
    s_mov_b32 s31, 0xc0398
    s_cmp_eq_u32 s3, 1
    s_cselect_b32 s30, 0x75642301, s30
    s_cselect_b32 s31, 0xc0398, s31
    s_cmp_eq_u32 s3, 2
    s_cselect_b32 s30, 0x65732410, s30
    s_cselect_b32 s31, 0xc3098, s31
    s_cmp_eq_u32 s3, 3
    s_cselect_b32 s30, 0x65843201, s30
    s_cselect_b32 s31, 0xc3097, s31
    s_cmp_eq_u32 s3, 4
    s_cselect_b32 s30, 0x65942310, s30
    s_cselect_b32 s31, 0xc3087, s31
    s_and_b32 s3, s30, 15
    s_lshl_b32 s61, s5, 2
    s_add_u32 s61, s61, s4
    s_mul_i32 s58, s61, 40960
    s_lshl_b32 s7, s3, 7
    s_add_u32 s61, s58, s7
    s_lshl_b32 s63, s4, 12
    v_lshrrev_b32 v1, 4, v0
    v_and_b32 v2, 7, v0
    v_xor_b32_e64 v1, v1, v2
    v_mul_u32_u24 v2, 1280, v3
    v_lshl_add_u32 v8, v1, 4, v2
    v_xor_b32_e64 v9, 64, v8
    v_add_u32 v11, 27648, v9
    v_add_u32 v10, 18432, v8
    v_add_u32 v9, 9216, v9
    s_mov_b32 s10, 2621440
    s_mov_b32 s11, 0x20000
    s_waitcnt lgkmcnt(0)
    s_mov_b64 s[8:9], s[36:37]
    s_add_u32 m0, s63, 98304
    s_nop 0
    s_nop 0
    buffer_load_dwordx4 v8, s[8:11], s61 offen lds
    buffer_load_dwordx4 v9, s[8:11], s61 offen offset:1024 lds
    buffer_load_dwordx4 v10, s[8:11], s61 offen offset:2048 lds
    buffer_load_dwordx4 v11, s[8:11], s61 offen offset:3072 lds
    s_bfe_u32 s59, s30, 0x40004
    s_lshl_b32 s59, s59, 7
    s_add_u32 s61, s58, s59
    s_mul_i32 s60, s6, 384
    s_mul_i32 s7, s4, 27648
    s_add_u32 s56, s60, s7
    s_lshr_b32 s1, 0xcccc, s5
    s_and_b32 s1, s1, 1
    s_mul_i32 s7, s1, 110592
    s_add_u32 s56, s56, s7
    s_lshl_b32 s7, s7, 1
    s_sub_u32 s0, 110592, s7
    s_mul_i32 s7, s3, 221184
    s_add_u32 s60, s56, s7
    s_mul_i32 s62, s4, 6144
    s_add_u32 s43, s62, 3072
    s_and_b32 s7, s4, 1
    s_lshl_b32 s7, s7, 2
    v_bfe_u32 v1, v0, 4, 1
    v_lshlrev_b32 v1, 1, v1
    v_and_b32 v2, 7, v0
    v_xor_b32 v1, v1, v2
    v_xor_b32_e64 v1, s7, v1
    v_mul_u32_u24 v2, 3456, v3
    v_lshl_add_u32 v6, v1, 4, v2
    v_add_u32 v4, 2048, v6
    v_add_u32 v5, 1152, v6
    v_add_u32 v6, 256, v6
    s_mov_b32 s14, 2213888
    s_mov_b32 s15, 0x20000
    s_mov_b32 s18, 2213888
    s_mov_b32 s19, 0x20000
    s_sub_u32 s12, s44, 2048
    s_subb_u32 s13, s45, 0
    s_sub_u32 s16, s46, 2048
    s_subb_u32 s17, s47, 0
    s_add_u32 m0, s62, 0
    s_nop 0
    buffer_load_dwordx4 v4, s[12:15], s60 offen lds
    buffer_load_dwordx4 v5, s[12:15], s60 offen offset:1024 lds
    buffer_load_dwordx4 v6, s[12:15], s60 offen offset:2048 lds
    s_add_u32 m0, s43, 0
    s_nop 0
    buffer_load_dwordx4 v4, s[16:19], s60 offen lds
    buffer_load_dwordx4 v5, s[16:19], s60 offen offset:1024 lds
    buffer_load_dwordx4 v6, s[16:19], s60 offen offset:2048 lds
    s_add_u32 s60, s60, s0
    v_mov_b32 v38, 1073741824
    v_and_b32 v1, 15, v0
    v_lshrrev_b32 v2, 4, v0
    v_lshrrev_b32 v13, 1, v1
    v_xor_b32 v2, v2, v13
    v_lshlrev_b32_e64 v2, 4, v2
    v_lshl_add_u32 v13, v1, 7, v2
    v_add_u32 v13, 98304, v13
    s_lshl_b32 s7, s1, 6
    v_xor_b32 v13, s7, v13
    v_xor_b32 v14, 64, v13
    s_lshr_b32 s3, s4, 1
    s_lshl_b32 s3, s3, 13
    v_subrev_u32 v7, s3, v13
    v_subrev_u32 v12, s3, v14
    v_add_u32 v13, s3, v13
    v_add_u32 v14, s3, v14
    v_lshrrev_b32 v1, 4, v0
    v_mul_u32_u24 v1, 6144, v1
    v_bfe_u32 v2, v0, 2, 2
    v_lshl_add_u32 v1, v2, 7, v1
    v_and_b32_e64 v2, 3, v0
    v_lshl_add_u32 v1, v2, 3, v1
    v_bfe_u32 v2, v0, 3, 2
    s_mul_i32 s3, s4, 3
    s_add_u32 s3, s3, 0
    s_and_b32 s7, s3, 3
    s_lshr_b32 s3, s3, 2
    s_lshl_b32 s3, s3, 10
    v_xor_b32 v18, s7, v2
    v_lshl_add_u32 v18, v18, 5, v1
    v_add_u32 v15, s3, v18
    s_mul_i32 s3, s4, 3
    s_add_u32 s3, s3, 1
    s_and_b32 s7, s3, 3
    s_lshr_b32 s3, s3, 2
    s_lshl_b32 s3, s3, 10
    v_xor_b32_e64 v18, s7, v2
    v_lshl_add_u32 v18, v18, 5, v1
    v_add_u32 v16, s3, v18
    s_mul_i32 s3, s4, 3
    s_add_u32 s3, s3, 2
    s_and_b32 s7, s3, 3
    s_lshr_b32 s3, s3, 2
    s_lshl_b32 s3, s3, 10
    v_xor_b32_e64 v18, s7, v2
    v_lshl_add_u32 v18, v18, 5, v1
    v_add_u32_e64 v17, s3, v18
    v_add_u32 v18, 49152, v15
    v_add_u32 v19, 49152, v16
    v_add_u32 v20, 49152, v17
    s_mul_i32 s77, s5, 9
    s_add_u32 s77, s77, s6
    s_lshl_b32 s77, s77, 8
    s_add_u32 s77, s77, 23068672
    s_lshl_b32 s42, s6, 2
    s_add_u32 s42, s42, s4
    s_mul_i32 s42, s42, 3072
    s_add_u32 s42, s42, 20971520
    s_mov_b32 s100, s5
    s_cmp_lg_u32 s2, 0
    s_cbranch_scc1 L_noroot
    s_mov_b32 s20, s54
    s_nop 0
    s_and_b32 s21, s55, 0xffff
    s_mov_b32 s22, 33554432
    s_mov_b32 s23, 0x20000
    s_mov_b32 s32, s52
    s_nop 0
    s_and_b32 s33, s53, 0xffff
    s_mov_b32 s34, 256
    s_mov_b32 s35, 0x20000
    s_lshl_b32 s79, s4, 12
    s_lshl_b32 s3, s2, 2
    s_add_u32 s76, s3, s4
    s_lshl_b32 s3, s4, 10
    s_add_u32 s3, s3, 23134208
    v_add_u32 v46, s3, v21
    v_mov_b32 v48, 0
    v_mov_b32 v49, 0
    v_mov_b32 v50, 0
    v_mov_b32_e64 v51, 0
    buffer_store_dwordx4 v[48:51], v46, s[20:23], 0 offen sc1
L_noroot:
    s_add_u32 m0, s62, 24576
    s_nop 0
    s_nop 0
    buffer_load_dwordx4 v4, s[12:15], s60 offen lds
    buffer_load_dwordx4 v5, s[12:15], s60 offen offset:1024 lds
    buffer_load_dwordx4 v6, s[12:15], s60 offen offset:2048 lds
    s_add_u32 m0, s43, 24576
    s_nop 0
    s_nop 0
    buffer_load_dwordx4 v4, s[16:19], s60 offen lds
    buffer_load_dwordx4 v5, s[16:19], s60 offen offset:1024 lds
    buffer_load_dwordx4 v6, s[16:19], s60 offen offset:2048 lds
    s_bfe_u32 s59, s30, 0x40004
    s_mul_i32 s59, s59, 221184
    s_add_u32 s60, s56, s59
    s_mov_b64 exec, 0
    s_cmp_eq_u32 s4, 0
    s_cbranch_scc1 L_isl_gu_0
    s_cmp_eq_u32 s4, 1
    s_cbranch_scc1 L_isl_gu_1
    s_cmp_eq_u32 s4, 2
    s_cbranch_scc1 L_isl_gu_2
    s_branch L_isl_gu_3
L_warm_gu_0:
    s_mov_b64 exec, -1
    s_add_u32 m0, s63, 114688
    s_nop 0
    s_nop 0
    buffer_load_dwordx4 v8, s[8:11], s61 offen lds
    buffer_load_dwordx4 v9, s[8:11], s61 offen offset:1024 lds
    buffer_load_dwordx4 v10, s[8:11], s61 offen offset:2048 lds
    buffer_load_dwordx4 v11, s[8:11], s61 offen offset:3072 lds
    s_bfe_u32 s59, s30, 0x40008
    s_lshl_b32 s59, s59, 7
    s_add_u32 s61, s58, s59
    s_add_u32 m0, s62, 49152
    s_nop 0
    s_nop 0
    buffer_load_dwordx4 v4, s[12:15], s60 offen lds
    buffer_load_dwordx4 v5, s[12:15], s60 offen offset:1024 lds
    buffer_load_dwordx4 v6, s[12:15], s60 offen offset:2048 lds
    s_add_u32 m0, s43, 49152
    s_nop 0
    s_nop 0
    buffer_load_dwordx4 v4, s[16:19], s60 offen lds
    buffer_load_dwordx4 v5, s[16:19], s60 offen offset:1024 lds
    buffer_load_dwordx4 v6, s[16:19], s60 offen offset:2048 lds
    s_add_u32 s60, s60, s0
    s_branch L_main_gu
.p2align 3
L_qkv:
    s_sub_u32 s65, s65, 18
    s_cmp_ge_u32 s65, 7
    s_cselect_b32 s7, 7, 0
    s_cselect_b32 s6, 1, 0
    s_sub_u32 s5, s65, s7
    s_mul_i32 s3, s68, 7
    s_add_u32 s5, s5, s3
    s_mul_i32 s16, s5, 146
    s_min_u32 s16, s16, 1888
    s_mov_b32 s3, s5
    s_cmp_eq_u32 s6, 0
    s_cselect_b32 s7, 4, 1
    s_add_u32 s3, s3, s7
    s_lshl_b32 s7, s69, 1
    s_add_u32 s6, s6, s7
    s_mul_i32 s7, s3, 52
    s_lshr_b32 s7, s7, 8
    s_mul_i32 s7, s7, 5
    s_sub_u32 s3, s3, s7
    s_mov_b32 s30, 0x76543210
    s_mov_b32 s31, 0xc0398
    s_cmp_eq_u32 s3, 1
    s_cselect_b32 s30, 0x75642301, s30
    s_cselect_b32 s31, 0xc0398, s31
    s_cmp_eq_u32 s3, 2
    s_cselect_b32 s30, 0x65732410, s30
    s_cselect_b32 s31, 0xc3098, s31
    s_cmp_eq_u32 s3, 3
    s_cselect_b32 s30, 0x65843201, s30
    s_cselect_b32 s31, 0xc3097, s31
    s_cmp_eq_u32 s3, 4
    s_cselect_b32 s30, 0x65942310, s30
    s_cselect_b32 s31, 0xc3087, s31
    s_and_b32 s3, s30, 15
    s_and_b32 s18, s16, 15
    s_and_b32 s16, s16, 0xff0
    s_mul_i32 s61, s4, 40
    s_add_u32 s61, s61, s16
    s_mul_i32 s58, s61, 1280
    s_lshl_b32 s7, s3, 7
    s_add_u32 s61, s58, s7
    s_mul_i32 s63, s4, 5120
    s_and_b32 s7, s4, 1
    s_lshl_b32 s7, s7, 2
    v_lshrrev_b32 v1, 4, v0
    v_and_b32 v2, 7, v0
    v_xor_b32 v1, v1, v2
    v_xor_b32_e64 v1, s7, v1
    v_mul_u32_u24 v2, 1280, v3
    v_lshl_add_u32 v8, v1, 4, v2
    v_xor_b32_e64 v9, 64, v8
    v_add_u32 v12, 40960, v8
    v_add_u32 v11, 27648, v9
    v_add_u32 v10, 18432, v8
    v_add_u32 v9, 9216, v9
    s_cmp_eq_u32 s4, 0
    s_cselect_b32 s7, s18, 0
    v_mov_b32 v2, 204800
    v_add_u32_e64 v1, 8, v3
    v_cmp_gt_u32 s[70:71], s7, v3
    v_cmp_gt_u32 s[72:73], s7, v1
    s_nop 0
    v_cndmask_b32 v1, 0, v2, s[70:71]
    v_cndmask_b32 v2, 0, v2, s[72:73]
    v_add_u32 v8, v8, v1
    v_add_u32_e64 v9, v9, v2
    s_mov_b32 s10, 2621440
    s_mov_b32 s11, 0x20000
    s_waitcnt lgkmcnt(0)
    s_mov_b64 s[8:9], s[36:37]
    s_add_u32 m0, s63, 126976
    s_nop 0
    s_nop 0
    buffer_load_dwordx4 v8, s[8:11], s61 offen lds
    buffer_load_dwordx4 v9, s[8:11], s61 offen offset:1024 lds
    buffer_load_dwordx4 v10, s[8:11], s61 offen offset:2048 lds
    buffer_load_dwordx4 v11, s[8:11], s61 offen offset:3072 lds
    s_add_u32 m0, s63, 131072
    s_nop 0
    buffer_load_dwordx4 v12, s[8:11], s61 offen lds
    s_bfe_u32 s59, s30, 0x40004
    s_lshl_b32 s59, s59, 7
    s_add_u32 s61, s58, s59
    s_mul_i32 s56, s6, 160
    s_lshr_b32 s1, 0xcccc, s5
    s_and_b32 s1, s1, 1
    s_mul_i32 s7, s1, 122880
    s_add_u32 s56, s56, s7
    s_lshl_b32 s7, s7, 1
    s_sub_u32 s0, 122880, s7
    s_mul_i32 s7, s3, 245760
    s_add_u32 s60, s56, s7
    s_lshl_b32 s62, s4, 12
    s_lshl_b32 s7, s4, 8
    v_add_u32 v1, s7, v0
    v_mul_u32_u24 v2, 2185, v1
    v_lshrrev_b32 v2, 16, v2
    v_mul_u32_u24 v4, 30, v2
    v_sub_u32 v1, v1, v4
    v_mul_u32_u24 v4, 26, v1
    v_lshrrev_b32_e64 v4, 8, v4
    v_mul_u32_u24 v4, 1120, v4
    v_lshl_add_u32 v4, v1, 4, v4
    v_lshrrev_b32 v1, 1, v2
    v_xor_b32 v1, v1, v2
    v_and_b32 v1, 4, v1
    v_mul_u32_u24 v1, 3, v1
    v_xor_b32_e64 v1, v1, v2
    v_mul_u32_u24 v1, 3840, v1
    v_add_u32_e64 v4, v1, v4
    v_add_u32 v4, 3072, v4
    v_add_u32 v1, s7, v0
    v_add_u32 v1, 64, v1
    v_mul_u32_u24 v2, 2185, v1
    v_lshrrev_b32 v2, 16, v2
    v_mul_u32_u24 v5, 30, v2
    v_sub_u32 v1, v1, v5
    v_mul_u32_u24 v5, 26, v1
    v_lshrrev_b32_e64 v5, 8, v5
    v_mul_u32_u24 v5, 1120, v5
    v_lshl_add_u32 v5, v1, 4, v5
    v_lshrrev_b32 v1, 1, v2
    v_xor_b32 v1, v1, v2
    v_and_b32 v1, 4, v1
    v_mul_u32_u24 v1, 3, v1
    v_xor_b32_e64 v1, v1, v2
    v_mul_u32_u24 v1, 3840, v1
    v_add_u32_e64 v5, v1, v5
    v_add_u32 v5, 2048, v5
    v_add_u32_e64 v1, s7, v0
    v_add_u32 v1, 128, v1
    v_mul_u32_u24 v2, 2185, v1
    v_lshrrev_b32 v2, 16, v2
    v_mul_u32_u24 v6, 30, v2
    v_sub_u32 v1, v1, v6
    v_mul_u32_u24 v6, 26, v1
    v_lshrrev_b32_e64 v6, 8, v6
    v_mul_u32_u24 v6, 1120, v6
    v_lshl_add_u32 v6, v1, 4, v6
    v_lshrrev_b32 v1, 1, v2
    v_xor_b32 v1, v1, v2
    v_and_b32 v1, 4, v1
    v_mul_u32_u24 v1, 3, v1
    v_xor_b32_e64 v1, v1, v2
    v_mul_u32_u24 v1, 3840, v1
    v_add_u32_e64 v6, v1, v6
    v_add_u32 v6, 1024, v6
    v_add_u32_e64 v1, s7, v0
    v_add_u32 v1, 192, v1
    v_mul_u32_u24 v2, 2185, v1
    v_lshrrev_b32 v2, 16, v2
    v_mul_u32_u24 v7, 30, v2
    v_sub_u32 v1, v1, v7
    v_mul_u32_u24 v7, 26, v1
    v_lshrrev_b32_e64 v7, 8, v7
    v_mul_u32_u24 v7, 1120, v7
    v_lshl_add_u32 v7, v1, 4, v7
    v_lshrrev_b32 v1, 1, v2
    v_xor_b32 v1, v1, v2
    v_and_b32 v1, 4, v1
    v_mul_u32_u24 v1, 3, v1
    v_xor_b32_e64 v1, v1, v2
    v_mul_u32_u24 v1, 3840, v1
    v_add_u32 v7, v1, v7
    v_lshrrev_b32 v2, 5, v2
    v_lshl_add_u32 v7, v2, 30, v7
    s_mov_b32 s14, 2460672
    s_mov_b32 s15, 0x20000
    s_sub_u32 s12, s38, 3072
    s_subb_u32 s13, s39, 0
    s_add_u32 m0, s62, 0
    s_nop 0
    s_nop 0
    buffer_load_dwordx4 v4, s[12:15], s60 offen lds
    buffer_load_dwordx4 v5, s[12:15], s60 offen offset:1024 lds
    buffer_load_dwordx4 v6, s[12:15], s60 offen offset:2048 lds
    buffer_load_dwordx4 v7, s[12:15], s60 offen offset:3072 lds
    s_add_u32 s60, s60, s0
    v_mov_b32 v38, 1073741824
    v_and_b32 v1, 15, v0
    v_lshrrev_b32 v2, 4, v0
    v_lshrrev_b32 v13, 1, v1
    v_xor_b32 v2, v2, v13
    v_lshlrev_b32_e64 v2, 4, v2
    v_lshl_add_u32 v13, v1, 7, v2
    v_add_u32 v13, 86016, v13
    s_lshl_b32 s7, s1, 6
    v_xor_b32 v13, s7, v13
    v_xor_b32_e64 v14, 64, v13
    v_bfe_u32 v1, v0, 2, 3
    v_lshrrev_b32_e64 v2, 5, v0
    v_lshl_add_u32 v1, v2, 4, v1
    v_mul_u32_u24 v1, 480, v1
    s_mul_i32 s3, s4, 40
    v_add_u32 v1, s3, v1
    v_and_b32_e64 v2, 3, v0
    v_lshl_add_u32 v15, v2, 3, v1
    v_mul_u32_u24 v16, 160, v2
    v_add3_u32 v16, v16, v1, 32
    v_add_u32 v17, 3840, v16
    v_cmp_eq_u32 s[70:71], 3, v2
    v_mov_b32 v1, 15360
    s_nop 0
    v_cndmask_b32 v16, v16, v1, s[70:71]
    v_cndmask_b32 v17, v17, v1, s[70:71]
    s_lshl_b32 s77, s5, 3
    s_add_u32 s77, s77, s6
    s_lshl_b32 s77, s77, 8
    s_add_u32 s77, s77, 23105536
    s_lshl_b32 s17, s6, 2
    s_add_u32 s17, s17, s4
    s_lshl_b32 s42, s17, 11
    s_add_u32 s42, s42, 21102592
    s_sub_u32 s100, s5, 0
    s_add_u32 m0, s62, 16384
    s_nop 0
    s_nop 0
    buffer_load_dwordx4 v4, s[12:15], s60 offen lds
    buffer_load_dwordx4 v5, s[12:15], s60 offen offset:1024 lds
    buffer_load_dwordx4 v6, s[12:15], s60 offen offset:2048 lds
    buffer_load_dwordx4 v7, s[12:15], s60 offen offset:3072 lds
    s_bfe_u32 s59, s30, 0x40004
    s_mul_i32 s59, s59, 245760
    s_add_u32 s60, s56, s59
    s_mov_b64 exec, 0
    s_cmp_eq_u32 s4, 0
    s_cbranch_scc1 L_isl_qkv_0
    s_cmp_eq_u32 s4, 1
    s_cbranch_scc1 L_isl_qkv_1
    s_cmp_eq_u32 s4, 2
    s_cbranch_scc1 L_isl_qkv_2
    s_branch L_isl_qkv_3
L_warm_qkv_0:
    s_mov_b64 exec, -1
    s_add_u32 m0, s63, 86016
    s_nop 0
    s_nop 0
    buffer_load_dwordx4 v8, s[8:11], s61 offen lds
    buffer_load_dwordx4 v9, s[8:11], s61 offen offset:1024 lds
    buffer_load_dwordx4 v10, s[8:11], s61 offen offset:2048 lds
    buffer_load_dwordx4 v11, s[8:11], s61 offen offset:3072 lds
    s_add_u32 m0, s63, 90112
    s_nop 0
    buffer_load_dwordx4 v12, s[8:11], s61 offen lds
    s_bfe_u32 s59, s30, 0x40008
    s_lshl_b32 s59, s59, 7
    s_add_u32 s61, s58, s59
    s_add_u32 m0, s62, 32768
    s_nop 0
    buffer_load_dwordx4 v4, s[12:15], s60 offen lds
    buffer_load_dwordx4 v5, s[12:15], s60 offen offset:1024 lds
    buffer_load_dwordx4 v6, s[12:15], s60 offen offset:2048 lds
    buffer_load_dwordx4 v7, s[12:15], s60 offen offset:3072 lds
    s_add_u32 s60, s60, s0
    s_branch L_main_qkv
.p2align 12
L_main_gu:
L_isl_gu_0:
    s_cbranch_execz L_isl_gu_4
    s_waitcnt vmcnt(16)
    s_barrier
    s_nop 0
    ds_read_b128 a[0:3], v13 offset:0
    ds_read_b64_tr_b16 a[32:33], v15 offset:0
    ds_read_b64_tr_b16 a[34:35], v15 offset:512
    ds_read_b64_tr_b16 a[36:37], v15 offset:3072
    ds_read_b64_tr_b16 a[38:39], v15 offset:3584
    ds_read_b64_tr_b16 a[40:41], v16 offset:0
    ds_read_b64_tr_b16 a[42:43], v16 offset:512
    ds_read_b64_tr_b16 a[44:45], v16 offset:3072
    ds_read_b64_tr_b16 a[46:47], v16 offset:3584
    ds_read_b64_tr_b16 a[48:49], v17 offset:0
    ds_read_b64_tr_b16 a[50:51], v17 offset:512
    ds_read_b64_tr_b16 a[52:53], v17 offset:3072
    ds_read_b64_tr_b16 a[54:55], v17 offset:3584
    ds_read_b128 a[4:7], v13 offset:2048
    ds_read_b128 a[8:11], v13 offset:4096
    ds_read_b128 a[12:15], v13 offset:6144
    ds_read_b128 a[16:19], v7 offset:8192
    ds_read_b128 a[20:23], v7 offset:10240
    ds_read_b128 a[24:27], v7 offset:12288
    ds_read_b128 a[28:31], v7 offset:14336
    s_waitcnt vmcnt(10) lgkmcnt(0)
    s_barrier
    v_mfma_f32_16x16x32_bf16 v[64:67], a[32:35], a[0:3], 0
    s_mov_b32 s20, s54
    ds_read_b128 a[56:59], v14 offset:0
    s_add_u32 m0, s62, 73728
    v_mfma_f32_16x16x32_bf16 v[68:71], a[36:39], a[0:3], 0
    s_and_b32 s21, s55, 0xffff
    s_mov_b32 s22, 33554432
    v_mfma_f32_16x16x32_bf16 v[72:75], a[40:43], a[0:3], 0
    s_mov_b32 s23, 0x20000
    ds_read_b64_tr_b16 a[88:89], v15 offset:24576
    v_mfma_f32_16x16x32_bf16 v[76:79], a[44:47], a[0:3], 0
    s_mov_b32 s32, s52
    buffer_load_dwordx4 v4, s[12:15], s60 offen lds
    v_mfma_f32_16x16x32_bf16 v[80:83], a[48:51], a[0:3], 0
    s_and_b32 s33, s53, 0xffff
    ds_read_b64_tr_b16 a[90:91], v15 offset:25088
    s_mov_b32 s34, 256
    v_mfma_f32_16x16x32_bf16 v[84:87], a[52:55], a[0:3], 0
    s_mov_b32 s35, 0x20000
    v_mfma_f32_16x16x32_bf16 v[108:111], a[52:55], a[4:7], 0
    s_lshl_b32 s79, s4, 12
    ds_read_b64_tr_b16 a[92:93], v15 offset:27648
    v_mfma_f32_16x16x32_bf16 v[104:107], a[48:51], a[4:7], 0
    s_lshl_b32 s3, s2, 2
    buffer_load_dwordx4 v5, s[12:15], s60 offen offset:1024 lds
    v_mfma_f32_16x16x32_bf16 v[100:103], a[44:47], a[4:7], 0
    s_add_u32 s76, s3, s4
    s_lshl_b32 s3, s4, 10
    ds_read_b64_tr_b16 a[94:95], v15 offset:28160
    v_mfma_f32_16x16x32_bf16 v[96:99], a[40:43], a[4:7], 0
    s_add_u32 s3, s3, 23134208
    v_mfma_f32_16x16x32_bf16 v[92:95], a[36:39], a[4:7], 0
    v_add_u32_e64 v46, s3, v21
    v_mfma_f32_16x16x32_bf16 v[88:91], a[32:35], a[4:7], 0
    s_lshr_b32 s101, s31, 8
    buffer_load_dwordx4 v6, s[12:15], s60 offen offset:2048 lds
    ds_read_b64_tr_b16 a[96:97], v16 offset:24576
    v_mfma_f32_16x16x32_bf16 v[112:115], a[32:35], a[8:11], 0
    s_cmp_lt_u32 s100, 5
    s_cselect_b32 s101, s101, 0
    s_add_u32 m0, s43, 73728
    v_mfma_f32_16x16x32_bf16 v[116:119], a[36:39], a[8:11], 0
    s_mov_b32 s3, 0x3f803f80
    ds_read_b64_tr_b16 a[98:99], v16 offset:25088
    v_mfma_f32_16x16x32_bf16 v[120:123], a[40:43], a[8:11], 0
    v_accvgpr_write_b32 a200, s3
    v_mfma_f32_16x16x32_bf16 v[124:127], a[44:47], a[8:11], 0
    v_accvgpr_write_b32 a201, s3
    ds_read_b64_tr_b16 a[100:101], v16 offset:27648
    v_mfma_f32_16x16x32_bf16 v[128:131], a[48:51], a[8:11], 0
    buffer_load_dwordx4 v4, s[16:19], s60 offen lds
    v_accvgpr_write_b32 a202, s3
    v_mfma_f32_16x16x32_bf16 v[132:135], a[52:55], a[8:11], 0
    v_accvgpr_write_b32 a203, s3
    v_accvgpr_write_b32 a176, 0
    v_mfma_f32_16x16x32_bf16 v[156:159], a[52:55], a[12:15], 0
    ds_read_b64_tr_b16 a[102:103], v16 offset:28160
    v_accvgpr_write_b32 a180, 0
    v_mfma_f32_16x16x32_bf16 v[152:155], a[48:51], a[12:15], 0
    v_accvgpr_write_b32 a184, 0
    ds_read_b64_tr_b16 a[104:105], v17 offset:24576
    v_mfma_f32_16x16x32_bf16 v[148:151], a[44:47], a[12:15], 0
    buffer_load_dwordx4 v5, s[16:19], s60 offen offset:1024 lds
    v_accvgpr_write_b32 a188, 0
    v_mfma_f32_16x16x32_bf16 v[144:147], a[40:43], a[12:15], 0
    v_accvgpr_write_b32 a192, 0
    v_accvgpr_write_b32 a196, 0
    v_mfma_f32_16x16x32_bf16 v[140:143], a[36:39], a[12:15], 0
    s_and_b32 s3, s2, 1
    ds_read_b64_tr_b16 a[106:107], v17 offset:25088
    v_mfma_f32_16x16x32_bf16 v[136:139], a[32:35], a[12:15], 0
    s_lshl_b32 s3, s3, 7
    v_mfma_f32_16x16x32_bf16 v[160:163], a[32:35], a[16:19], 0
    s_bfe_u32 s7, s2, 0x20001
    buffer_load_dwordx4 v6, s[16:19], s60 offen offset:2048 lds
    ds_read_b64_tr_b16 a[108:109], v17 offset:27648
    v_mfma_f32_16x16x32_bf16 v[164:167], a[36:39], a[16:19], 0
    s_lshl_b32 s7, s7, 5
    s_add_u32 s3, s3, s7
    s_bfe_u32 s59, s30, 0x40008
    v_mfma_f32_16x16x32_bf16 v[168:171], a[40:43], a[16:19], 0
    s_lshr_b32 s7, s2, 3
    ds_read_b64_tr_b16 a[110:111], v17 offset:28160
    v_mfma_f32_16x16x32_bf16 v[172:175], a[44:47], a[16:19], 0
    s_add_u32 s3, s3, s7
    v_mfma_f32_16x16x32_bf16 v[176:179], a[48:51], a[16:19], 0
    s_lshl_b32 s3, s3, 2
    ds_read_b128 a[60:63], v14 offset:2048
    s_add_u32 s3, s3, s4
    v_mfma_f32_16x16x32_bf16 v[180:183], a[52:55], a[16:19], 0
    s_mul_i32 s59, s59, 221184
    s_lshl_b32 s7, s3, 1
    v_mfma_f32_16x16x32_bf16 v[204:207], a[52:55], a[20:23], 0
    s_mul_i32 s3, s3, 2560
    ds_read_b128 a[64:67], v14 offset:4096
    v_mfma_f32_16x16x32_bf16 v[200:203], a[48:51], a[20:23], 0
    s_add_u32 s60, s56, s59
    v_lshrrev_b32 v1, 5, v0
    v_mfma_f32_16x16x32_bf16 v[196:199], a[44:47], a[20:23], 0
    s_add_u32 m0, s63, 131072
    v_and_b32_e64 v2, 31, v0
    v_mul_u32_u24 v36, 1280, v1
    v_mfma_f32_16x16x32_bf16 v[192:195], a[40:43], a[20:23], 0
    ds_read_b128 a[68:71], v14 offset:6144
    v_lshl_add_u32 v36, v2, 4, v36
    v_mfma_f32_16x16x32_bf16 v[188:191], a[36:39], a[20:23], 0
    v_cmp_gt_u32 s[70:71], 16, v2
    v_mfma_f32_16x16x32_bf16 v[184:187], a[32:35], a[20:23], 0
    v_add_u32 v37, 1024, v36
    ds_read_b128 a[72:75], v12 offset:8192
    v_mfma_f32_16x16x32_bf16 v[208:211], a[32:35], a[24:27], 0
    v_add_u32_e64 v1, s7, v1
    v_cndmask_b32 v37, v38, v37, s[70:71]
    v_mfma_f32_16x16x32_bf16 v[212:215], a[36:39], a[24:27], 0
    buffer_load_dwordx4 v[24:27], v36, s[8:11], s3 offen
    ds_read_b128 a[76:79], v12 offset:10240
    v_mfma_f32_16x16x32_bf16 v[216:219], a[40:43], a[24:27], 0
    v_mfma_f32_16x16x32_bf16 v[220:223], a[44:47], a[24:27], 0
    ds_read_b128 a[80:83], v12 offset:12288
    v_mfma_f32_16x16x32_bf16 v[224:227], a[48:51], a[24:27], 0
    v_mfma_f32_16x16x32_bf16 v[228:231], a[52:55], a[24:27], 0
    buffer_load_dwordx4 v[28:31], v36, s[8:11], s3 offen offset:512
    ds_read_b128 a[84:87], v12 offset:14336
    v_mfma_f32_16x16x32_bf16 v[252:255], a[52:55], a[28:31], 0
    buffer_load_dwordx4 v[32:35], v37, s[8:11], s3 offen
    v_mfma_f32_16x16x32_bf16 v[248:251], a[48:51], a[28:31], 0
    v_lshlrev_b32_e64 v36, 2, v2
    v_lshl_add_u32 v36, v1, 3, v36
    v_add_u32 v36, 22020096, v36
    v_mfma_f32_16x16x32_bf16 v[244:247], a[44:47], a[28:31], 0
    v_lshlrev_b32_e64 v1, 2, v1
    v_add_u32 v1, 22085632, v1
    buffer_load_dwordx4 v8, s[8:11], s61 offen lds
    buffer_load_dwordx4 v9, s[8:11], s61 offen offset:1024 lds
    v_mfma_f32_16x16x32_bf16 v[240:243], a[40:43], a[28:31], 0
    v_cmp_gt_u32 s[70:71], 2, v2
    v_cmp_eq_u32 s[74:75], 2, v2
    v_mfma_f32_16x16x32_bf16 v[236:239], a[36:39], a[28:31], 0
    v_cndmask_b32 v36, v38, v36, s[70:71]
    v_cndmask_b32 v36, v36, v1, s[74:75]
    v_mfma_f32_16x16x32_bf16 v[232:235], a[32:35], a[28:31], 0
    buffer_load_dword v23, v36, s[20:23], 0 offen sc1
    s_bitcmp0_b32 s101, 0
    s_cbranch_scc1 L_nocs_gu_0
    v_mfma_f32_16x16x32_bf16 a[176:179], a[200:203], a[32:35], a[176:179]
    v_mfma_f32_16x16x32_bf16 a[180:183], a[200:203], a[36:39], a[180:183]
    v_mfma_f32_16x16x32_bf16 a[184:187], a[200:203], a[40:43], a[184:187]
    v_mfma_f32_16x16x32_bf16 a[188:191], a[200:203], a[44:47], a[188:191]
    v_mfma_f32_16x16x32_bf16 a[192:195], a[200:203], a[48:51], a[192:195]
    v_mfma_f32_16x16x32_bf16 a[196:199], a[200:203], a[52:55], a[196:199]
L_nocs_gu_0:
    s_waitcnt vmcnt(12) lgkmcnt(0)
    s_barrier
    v_mfma_f32_16x16x32_bf16 v[64:67], a[88:91], a[56:59], v[64:67]
    s_add_u32 m0, s63, 131072
    v_or_b32_e64 v1, s76, v0
    ds_read_b128 a[0:3], v13 offset:16384
    v_cmp_eq_u32 s[70:71], 0, v1
    v_mfma_f32_16x16x32_bf16 v[68:71], a[92:95], a[56:59], v[68:71]
    v_mov_b32_e64 v2, 1
    v_cndmask_b32 v1, v38, 0, s[70:71]
    buffer_store_dword v2, v1, s[32:35], 0 offen sc1
    v_mfma_f32_16x16x32_bf16 v[72:75], a[96:99], a[56:59], v[72:75]
    s_min_u32 s3, s4, 1
    ds_read_b64_tr_b16 a[32:33], v18 offset:0
    s_lshl_b32 s3, s3, 30
    v_mfma_f32_16x16x32_bf16 v[76:79], a[100:103], a[56:59], v[76:79]
    v_lshl_add_u32 v1, v0, 2, s3
    v_mfma_f32_16x16x32_bf16 v[80:83], a[104:107], a[56:59], v[80:83]
    buffer_load_dwordx4 v10, s[8:11], s61 offen offset:2048 lds
    ds_read_b64_tr_b16 a[34:35], v18 offset:512
    v_mov_b32_e64 v2, 0
    v_mfma_f32_16x16x32_bf16 v[84:87], a[108:111], a[56:59], v[84:87]
    buffer_store_dword v2, v1, s[20:23], s77 offen sc1
    v_mfma_f32_16x16x32_bf16 v[108:111], a[108:111], a[60:63], v[108:111]
    s_mov_b32 s57, s76
    s_mul_i32 s64, s57, 6554
    ds_read_b64_tr_b16 a[36:37], v18 offset:3072
    s_lshr_b32 s64, s64, 16
    v_mfma_f32_16x16x32_bf16 v[104:107], a[104:107], a[60:63], v[104:107]
    s_mul_i32 s3, s64, 10
    s_sub_u32 s65, s57, s3
    v_mfma_f32_16x16x32_bf16 v[100:103], a[100:103], a[60:63], v[100:103]
    s_sub_u32 s66, s64, 20
    buffer_load_dwordx4 v11, s[8:11], s61 offen offset:3072 lds
    ds_read_b64_tr_b16 a[38:39], v18 offset:3584
    s_mul_i32 s67, s66, 86
    v_mfma_f32_16x16x32_bf16 v[96:99], a[96:99], a[60:63], v[96:99]
    s_bfe_u32 s59, s30, 0x4000c
    s_lshr_b32 s67, s67, 8
    s_mul_i32 s3, s67, 3
    v_mfma_f32_16x16x32_bf16 v[92:95], a[92:95], a[60:63], v[92:95]
    s_sub_u32 s66, s66, s3
    s_mul_i32 s67, s67, 192
    v_mfma_f32_16x16x32_bf16 v[88:91], a[88:91], a[60:63], v[88:91]
    s_lshl_b32 s59, s59, 7
    ds_read_b64_tr_b16 a[40:41], v19 offset:0
    s_cmp_ge_u32 s64, 47
    v_mfma_f32_16x16x32_bf16 v[112:115], a[88:91], a[64:67], v[112:115]
    s_cselect_b32 s3, 1632, 0
    s_sub_u32 s67, s67, s3
    v_mfma_f32_16x16x32_bf16 v[116:119], a[92:95], a[64:67], v[116:119]
    s_mul_i32 s3, s66, 48
    ds_read_b64_tr_b16 a[42:43], v19 offset:512
    s_cmp_eq_u32 s66, 2
    v_mfma_f32_16x16x32_bf16 v[120:123], a[96:99], a[64:67], v[120:123]
    s_cselect_b32 s3, 32, s3
    s_cselect_b32 s68, 48, 8
    s_cselect_b32 s69, 8, 16
    v_mfma_f32_16x16x32_bf16 v[124:127], a[100:103], a[64:67], v[124:127]
    s_add_u32 s61, s58, s59
    ds_read_b64_tr_b16 a[44:45], v19 offset:3072
    v_mfma_f32_16x16x32_bf16 v[128:131], a[104:107], a[64:67], v[128:131]
    s_add_u32 s67, s67, s3
    s_mov_b32 s7, 2211840
    v_mfma_f32_16x16x32_bf16 v[132:135], a[108:111], a[64:67], v[132:135]
    s_add_u32 m0, s62, 0
    ds_read_b64_tr_b16 a[46:47], v19 offset:3584
    s_mul_i32 s3, s64, 160
    v_mfma_f32_16x16x32_bf16 v[156:159], a[108:111], a[68:71], v[156:159]
    s_sub_u32 s3, s3, 2544
    s_cmp_lt_u32 s64, 20
    v_mfma_f32_16x16x32_bf16 v[152:155], a[104:107], a[68:71], v[152:155]
    s_cselect_b32 s67, s3, s67
    s_cselect_b32 s68, 0x50, s68
    s_cselect_b32 s66, 40, 4
    v_mfma_f32_16x16x32_bf16 v[148:151], a[100:103], a[68:71], v[148:151]
    s_cselect_b32 s69, 20, s69
    s_cselect_b32 s24, s40, s48
    s_cselect_b32 s25, s41, s49
    v_mfma_f32_16x16x32_bf16 v[144:147], a[96:99], a[68:71], v[144:147]
    s_cselect_b32 s26, 819200, s7
    buffer_load_dwordx4 v4, s[12:15], s60 offen lds
    ds_read_b64_tr_b16 a[48:49], v20 offset:0
    v_mfma_f32_16x16x32_bf16 v[140:143], a[92:95], a[68:71], v[140:143]
    s_mul_i32 s3, s64, 40
    ds_read_b64_tr_b16 a[50:51], v20 offset:512
    v_mfma_f32_16x16x32_bf16 v[136:139], a[88:91], a[68:71], v[136:139]
    s_cmp_lt_u32 s64, 16
    s_cselect_b32 s67, s3, s67
    s_cselect_b32 s68, 20, s68
    v_mfma_f32_16x16x32_bf16 v[160:163], a[88:91], a[72:75], v[160:163]
    s_cselect_b32 s66, 4, s66
    s_cselect_b32 s69, 8, s69
    buffer_load_dwordx4 v5, s[12:15], s60 offen offset:1024 lds
    v_mfma_f32_16x16x32_bf16 v[164:167], a[92:95], a[72:75], v[164:167]
    ds_read_b64_tr_b16 a[52:53], v20 offset:3072
    v_mfma_f32_16x16x32_bf16 v[168:171], a[96:99], a[72:75], v[168:171]
    s_and_b32 s25, s25, 0xffff
    ds_read_b64_tr_b16 a[54:55], v20 offset:3584
    v_mfma_f32_16x16x32_bf16 v[172:175], a[100:103], a[72:75], v[172:175]
    s_mov_b32 s27, 0x20000
    buffer_load_dwordx4 v6, s[12:15], s60 offen offset:2048 lds
    v_mfma_f32_16x16x32_bf16 v[176:179], a[104:107], a[72:75], v[176:179]
    s_cmp_lt_u32 s57, 740
    s_cselect_b32 s26, s26, 0
    s_cselect_b32 s67, s67, 0
    v_mfma_f32_16x16x32_bf16 v[180:183], a[108:111], a[72:75], v[180:183]
    s_cselect_b32 s3, 0, 1073741824
    ds_read_b128 a[4:7], v13 offset:18432
    v_mfma_f32_16x16x32_bf16 v[204:207], a[108:111], a[76:79], v[204:207]
    s_add_u32 m0, s43, 0
    ds_read_b128 a[8:11], v13 offset:20480
    v_mfma_f32_16x16x32_bf16 v[200:203], a[104:107], a[76:79], v[200:203]
    v_add_u32 v43, s3, v21
    s_mul_i32 s67, s67, 1280
    v_mfma_f32_16x16x32_bf16 v[196:199], a[100:103], a[76:79], v[196:199]
    s_lshl_b32 s3, s65, 7
    s_add_u32 s67, s67, s3
    v_mfma_f32_16x16x32_bf16 v[192:195], a[96:99], a[76:79], v[192:195]
    s_mul_i32 s68, s68, 1280
    buffer_load_dwordx4 v4, s[16:19], s60 offen lds
    ds_read_b128 a[12:15], v13 offset:22528
    v_mfma_f32_16x16x32_bf16 v[188:191], a[92:95], a[76:79], v[188:191]
    s_mul_i32 s66, s66, 1280
    v_lshrrev_b32_e64 v1, 5, v0
    v_mfma_f32_16x16x32_bf16 v[184:187], a[88:91], a[76:79], v[184:187]
    v_mul_u32_u24_e64 v1, s69, v1
    ds_read_b128 a[16:19], v7 offset:24576
    v_mfma_f32_16x16x32_bf16 v[208:211], a[88:91], a[80:83], v[208:211]
    buffer_load_dwordx4 v5, s[16:19], s60 offen offset:1024 lds
    v_bfe_u32 v2, v0, 3, 2
    v_mfma_f32_16x16x32_bf16 v[212:215], a[92:95], a[80:83], v[212:215]
    v_add_u32_e64 v1, v1, v2
    v_mul_u32_u24 v1, 1280, v1
    v_mfma_f32_16x16x32_bf16 v[216:219], a[96:99], a[80:83], v[216:219]
    v_bfe_u32 v2, v0, 4, 1
    v_lshlrev_b32_e64 v2, 1, v2
    v_mfma_f32_16x16x32_bf16 v[220:223], a[100:103], a[80:83], v[220:223]
    buffer_load_dwordx4 v6, s[16:19], s60 offen offset:2048 lds
    ds_read_b128 a[20:23], v7 offset:26624
    v_and_b32_e64 v39, 7, v0
    v_mfma_f32_16x16x32_bf16 v[224:227], a[104:107], a[80:83], v[224:227]
    s_add_u32 s60, s60, s0
    v_xor_b32 v2, v2, v39
    v_lshl_add_u32 v39, v2, 4, v1
    v_mfma_f32_16x16x32_bf16 v[228:231], a[108:111], a[80:83], v[228:231]
    v_xor_b32_e64 v40, 64, v39
    ds_read_b128 a[24:27], v7 offset:28672
    v_mfma_f32_16x16x32_bf16 v[252:255], a[108:111], a[84:87], v[252:255]
    s_add_u32 m0, s79, 147456
    s_mov_b32 s3, s67
    buffer_load_dwordx4 v39, s[24:27], s3 offen nt lds
    v_mfma_f32_16x16x32_bf16 v[248:251], a[104:107], a[84:87], v[248:251]
    s_add_u32 m0, s79, 148480
    ds_read_b128 a[28:31], v7 offset:30720
    s_add_u32 s3, s67, s66
    v_mfma_f32_16x16x32_bf16 v[244:247], a[100:103], a[84:87], v[244:247]
    v_mfma_f32_16x16x32_bf16 v[240:243], a[96:99], a[84:87], v[240:243]
    buffer_load_dwordx4 v40, s[24:27], s3 offen nt lds
    s_add_u32 m0, s79, 149504
    v_mfma_f32_16x16x32_bf16 v[236:239], a[92:95], a[84:87], v[236:239]
    s_add_u32 s3, s67, s68
    buffer_load_dwordx4 v39, s[24:27], s3 offen nt lds
    s_add_u32 m0, s79, 150528
    v_mfma_f32_16x16x32_bf16 v[232:235], a[88:91], a[84:87], v[232:235]
    s_add_u32 s3, s3, s66
    buffer_load_dwordx4 v40, s[24:27], s3 offen nt lds
    s_bitcmp0_b32 s101, 1
    s_cbranch_scc1 L_nocs_gu_1
    v_mfma_f32_16x16x32_bf16 a[176:179], a[200:203], a[88:91], a[176:179]
    v_mfma_f32_16x16x32_bf16 a[180:183], a[200:203], a[92:95], a[180:183]
    v_mfma_f32_16x16x32_bf16 a[184:187], a[200:203], a[96:99], a[184:187]
    v_mfma_f32_16x16x32_bf16 a[188:191], a[200:203], a[100:103], a[188:191]
    v_mfma_f32_16x16x32_bf16 a[192:195], a[200:203], a[104:107], a[192:195]
    v_mfma_f32_16x16x32_bf16 a[196:199], a[200:203], a[108:111], a[196:199]
L_nocs_gu_1:
    s_waitcnt vmcnt(20) lgkmcnt(0)
    s_barrier
    v_mfma_f32_16x16x32_bf16 v[64:67], a[32:35], a[0:3], v[64:67]
    s_lshr_b32 s3, s100, 1
    ds_read_b128 a[56:59], v14 offset:16384
    s_add_u32 m0, s63, 98304
    v_mfma_f32_16x16x32_bf16 v[68:71], a[36:39], a[0:3], v[68:71]
    s_lshl_b32 s3, s3, 7
    v_mfma_f32_16x16x32_bf16 v[72:75], a[40:43], a[0:3], v[72:75]
    s_and_b32 s7, s100, 1
    ds_read_b64_tr_b16 a[88:89], v18 offset:24576
    v_mfma_f32_16x16x32_bf16 v[76:79], a[44:47], a[0:3], v[76:79]
    s_lshl_b32 s7, s7, 2
    buffer_load_dwordx4 v8, s[8:11], s61 offen lds
    v_mfma_f32_16x16x32_bf16 v[80:83], a[48:51], a[0:3], v[80:83]
    s_add_u32 s3, s3, s7
    ds_read_b64_tr_b16 a[90:91], v18 offset:25088
    v_mfma_f32_16x16x32_bf16 v[84:87], a[52:55], a[0:3], v[84:87]
    s_add_u32 s3, s3, s42
    v_mfma_f32_16x16x32_bf16 v[108:111], a[52:55], a[4:7], v[108:111]
    s_cmp_lt_u32 s100, 8
    s_cselect_b32 s3, s3, 1073741824
    ds_read_b64_tr_b16 a[92:93], v18 offset:27648
    v_mfma_f32_16x16x32_bf16 v[104:107], a[48:51], a[4:7], v[104:107]
    buffer_load_dwordx4 v9, s[8:11], s61 offen offset:1024 lds
    v_mfma_f32_16x16x32_bf16 v[100:103], a[44:47], a[4:7], v[100:103]
    s_add_u32 m0, s62, 24576
    v_lshrrev_b32_e64 v1, 4, v0
    ds_read_b64_tr_b16 a[94:95], v18 offset:28160
    v_mfma_f32_16x16x32_bf16 v[96:99], a[40:43], a[4:7], v[96:99]
    v_and_b32_e64 v2, 15, v0
    v_mfma_f32_16x16x32_bf16 v[92:95], a[36:39], a[4:7], v[92:95]
    v_lshlrev_b32_e64 v2, 3, v2
    v_mfma_f32_16x16x32_bf16 v[88:91], a[32:35], a[4:7], v[88:91]
    ds_read_b64_tr_b16 a[96:97], v19 offset:24576
    v_lshl_add_u32 v1, v1, 9, v2
    v_mfma_f32_16x16x32_bf16 v[112:115], a[32:35], a[8:11], v[112:115]
    buffer_load_dwordx4 v4, s[12:15], s60 offen lds
    v_add_u32_e64 v44, s3, v1
    v_mfma_f32_16x16x32_bf16 v[116:119], a[36:39], a[8:11], v[116:119]
    ds_read_b64_tr_b16 a[98:99], v19 offset:25088
    v_cmp_gt_u32 s[70:71], 32, v0
    v_mfma_f32_16x16x32_bf16 v[120:123], a[40:43], a[8:11], v[120:123]
    v_mfma_f32_16x16x32_bf16 v[124:127], a[44:47], a[8:11], v[124:127]
    v_cndmask_b32 v45, v38, v44, s[70:71]
    ds_read_b64_tr_b16 a[100:101], v19 offset:27648
    v_mfma_f32_16x16x32_bf16 v[128:131], a[48:51], a[8:11], v[128:131]
    buffer_load_dwordx4 v5, s[12:15], s60 offen offset:1024 lds
    v_mov_b32_e64 v48, -1
    v_mfma_f32_16x16x32_bf16 v[132:135], a[52:55], a[8:11], v[132:135]
    ds_read_b64_tr_b16 a[102:103], v19 offset:28160
    v_mfma_f32_16x16x32_bf16 v[156:159], a[52:55], a[12:15], v[156:159]
    v_mfma_f32_16x16x32_bf16 v[152:155], a[48:51], a[12:15], v[152:155]
    ds_read_b64_tr_b16 a[104:105], v20 offset:24576
    v_mfma_f32_16x16x32_bf16 v[148:151], a[44:47], a[12:15], v[148:151]
    buffer_store_dword v48, v44, s[20:23], 0 offen offset:0 sc1
    v_mfma_f32_16x16x32_bf16 v[144:147], a[40:43], a[12:15], v[144:147]
    v_mfma_f32_16x16x32_bf16 v[140:143], a[36:39], a[12:15], v[140:143]
    ds_read_b64_tr_b16 a[106:107], v20 offset:25088
    v_mfma_f32_16x16x32_bf16 v[136:139], a[32:35], a[12:15], v[136:139]
    v_mfma_f32_16x16x32_bf16 v[160:163], a[32:35], a[16:19], v[160:163]
    buffer_store_dword v48, v45, s[20:23], 0 offen offset:2048 sc1
    v_lshrrev_b32_e64 v1, 4, v0
    v_mfma_f32_16x16x32_bf16 v[164:167], a[36:39], a[16:19], v[164:167]
    v_bfe_u32 v2, v0, 2, 2
    v_lshlrev_b32_e64 v2, 7, v2
    v_mfma_f32_16x16x32_bf16 v[168:171], a[40:43], a[16:19], v[168:171]
    v_lshl_add_u32 v1, v1, 10, v2
    v_and_b32_e64 v2, 3, v0
    v_mfma_f32_16x16x32_bf16 v[172:175], a[44:47], a[16:19], v[172:175]
    v_lshl_add_u32 v1, v2, 3, v1
    v_bfe_u32 v2, v0, 3, 2
    v_mfma_f32_16x16x32_bf16 v[176:179], a[48:51], a[16:19], v[176:179]
    buffer_load_dwordx4 v6, s[12:15], s60 offen offset:2048 lds
    s_add_u32 m0, s43, 24576
    v_mfma_f32_16x16x32_bf16 v[180:183], a[52:55], a[16:19], v[180:183]
    ds_read_b64_tr_b16 a[108:109], v20 offset:27648
    v_lshl_add_u32 v1, v2, 5, v1
    v_mfma_f32_16x16x32_bf16 v[204:207], a[52:55], a[20:23], v[204:207]
    s_add_u32 s3, s79, 147456
    ds_read_b64_tr_b16 a[110:111], v20 offset:28160
    v_add_u32_e64 v39, s3, v1
    v_mfma_f32_16x16x32_bf16 v[200:203], a[48:51], a[20:23], v[200:203]
    v_xor_b32_e64 v40, 32, v39
    ds_read_b128 a[60:63], v14 offset:18432
    v_mfma_f32_16x16x32_bf16 v[196:199], a[44:47], a[20:23], v[196:199]
    buffer_load_dwordx4 v4, s[16:19], s60 offen lds
    v_xor_b32_e64 v41, 64, v39
    v_mfma_f32_16x16x32_bf16 v[192:195], a[40:43], a[20:23], v[192:195]
    v_xor_b32 v42, 96, v39
    ds_read_b128 a[64:67], v14 offset:20480
    v_mfma_f32_16x16x32_bf16 v[188:191], a[36:39], a[20:23], v[188:191]
    s_lshl_b32 s64, s57, 12
    s_add_u32 s64, s64, 16777216
    ds_read_b128 a[68:71], v14 offset:22528
    v_mfma_f32_16x16x32_bf16 v[184:187], a[32:35], a[20:23], v[184:187]
    v_mov_b32 v54, 0
    ds_read_b128 a[72:75], v12 offset:24576
    v_mfma_f32_16x16x32_bf16 v[208:211], a[32:35], a[24:27], v[208:211]
    buffer_load_dwordx4 v5, s[16:19], s60 offen offset:1024 lds
    v_mov_b32_e64 v55, 0
    v_mfma_f32_16x16x32_bf16 v[212:215], a[36:39], a[24:27], v[212:215]
    s_mov_b32 s7, 0x3f803f80
    s_waitcnt vmcnt(26)
    ds_read_b128 a[76:79], v12 offset:26624
    v_mfma_f32_16x16x32_bf16 v[216:219], a[40:43], a[24:27], v[216:219]
    v_dot2c_f32_bf16 v54, s7, v24
    v_dot2c_f32_bf16 v55, v24, v24
    v_dot2c_f32_bf16 v54, s7, v25
    v_dot2c_f32_bf16 v55, v25, v25
    v_dot2c_f32_bf16 v54, s7, v26
    v_dot2c_f32_bf16 v55, v26, v26
    v_dot2c_f32_bf16 v54, s7, v27
    v_dot2c_f32_bf16 v55, v27, v27
    v_dot2c_f32_bf16 v54, s7, v28
    v_dot2c_f32_bf16 v55, v28, v28
    v_dot2c_f32_bf16 v54, s7, v29
    v_dot2c_f32_bf16 v55, v29, v29
    v_dot2c_f32_bf16 v54, s7, v30
    v_dot2c_f32_bf16 v55, v30, v30
    v_dot2c_f32_bf16 v54, s7, v31
    v_dot2c_f32_bf16 v55, v31, v31
    v_dot2c_f32_bf16 v54, s7, v32
    v_dot2c_f32_bf16 v55, v32, v32
    v_dot2c_f32_bf16 v54, s7, v33
    v_dot2c_f32_bf16 v55, v33, v33
    v_dot2c_f32_bf16 v54, s7, v34
    v_dot2c_f32_bf16 v55, v34, v34
    v_dot2c_f32_bf16 v54, s7, v35
    v_dot2c_f32_bf16_e64 v55, v35, v35
    v_mfma_f32_16x16x32_bf16 v[220:223], a[44:47], a[24:27], v[220:223]
    ds_read_b128 a[80:83], v12 offset:28672
    v_add_f32_dpp v54, v54, v54 row_ror:8 row_mask:0xf bank_mask:0xf
    v_mfma_f32_16x16x32_bf16 v[224:227], a[48:51], a[24:27], v[224:227]
    buffer_load_dwordx4 v6, s[16:19], s60 offen offset:2048 lds
    s_bfe_u32 s59, s30, 0x4000c
    v_mfma_f32_16x16x32_bf16 v[228:231], a[52:55], a[24:27], v[228:231]
    s_mul_i32 s59, s59, 221184
    v_add_f32_dpp v55, v55, v55 row_ror:8 row_mask:0xf bank_mask:0xf
    v_add_f32_dpp v54, v54, v54 row_ror:4 row_mask:0xf bank_mask:0xf
    v_mfma_f32_16x16x32_bf16 v[252:255], a[52:55], a[28:31], v[252:255]
    s_add_u32 s60, s56, s59
    ds_read_b128 a[84:87], v12 offset:30720
    v_add_f32_dpp v55, v55, v55 row_ror:4 row_mask:0xf bank_mask:0xf
    v_mfma_f32_16x16x32_bf16 v[248:251], a[48:51], a[28:31], v[248:251]
    v_add_f32_dpp v54, v54, v54 row_ror:2 row_mask:0xf bank_mask:0xf
    v_mfma_f32_16x16x32_bf16 v[244:247], a[44:47], a[28:31], v[244:247]
    v_add_f32_dpp v55, v55, v55 row_ror:2 row_mask:0xf bank_mask:0xf
    v_mfma_f32_16x16x32_bf16 v[240:243], a[40:43], a[28:31], v[240:243]
    v_add_f32_dpp v54, v54, v54 row_ror:1 row_mask:0xf bank_mask:0xf
    v_mfma_f32_16x16x32_bf16 v[236:239], a[36:39], a[28:31], v[236:239]
    v_add_f32_dpp v55, v55, v55 row_ror:1 row_mask:0xf bank_mask:0xf
    v_mfma_f32_16x16x32_bf16 v[232:235], a[32:35], a[28:31], v[232:235]
    s_waitcnt vmcnt(14) lgkmcnt(0)
    s_barrier
    v_mfma_f32_16x16x32_bf16 v[64:67], a[88:91], a[56:59], v[64:67]
    s_waitcnt vmcnt(10)
    ds_read_b128 a[0:3], v13 offset:32768
    s_add_u32 m0, s63, 98304
    v_mfma_f32_16x16x32_bf16 v[68:71], a[92:95], a[56:59], v[68:71]
    ds_read_b64_tr_b16 a[216:217], v39 offset:0
    v_mfma_f32_16x16x32_bf16 v[72:75], a[96:99], a[56:59], v[72:75]
    buffer_load_dwordx4 v10, s[8:11], s61 offen offset:2048 lds
    ds_read_b64_tr_b16 a[32:33], v15 offset:0
    v_mfma_f32_16x16x32_bf16 v[76:79], a[100:103], a[56:59], v[76:79]
    ds_read_b64_tr_b16 a[218:219], v39 offset:512
    v_mfma_f32_16x16x32_bf16 v[80:83], a[104:107], a[56:59], v[80:83]
    ds_read_b64_tr_b16 a[220:221], v40 offset:0
    v_mfma_f32_16x16x32_bf16 v[84:87], a[108:111], a[56:59], v[84:87]
    ds_read_b64_tr_b16 a[34:35], v15 offset:512
    v_mfma_f32_16x16x32_bf16 v[108:111], a[108:111], a[60:63], v[108:111]
    buffer_load_dwordx4 v11, s[8:11], s61 offen offset:3072 lds
    ds_read_b64_tr_b16 a[222:223], v40 offset:512
    v_mfma_f32_16x16x32_bf16 v[104:107], a[104:107], a[60:63], v[104:107]
    s_bfe_u32 s59, s30, 0x40010
    ds_read_b64_tr_b16 a[36:37], v15 offset:3072
    ds_read_b64_tr_b16 a[224:225], v41 offset:0
    v_mfma_f32_16x16x32_bf16 v[100:103], a[100:103], a[60:63], v[100:103]
    s_lshl_b32 s59, s59, 7
    ds_read_b64_tr_b16 a[226:227], v41 offset:512
    ds_read_b64_tr_b16 a[38:39], v15 offset:3584
    v_mfma_f32_16x16x32_bf16 v[96:99], a[96:99], a[60:63], v[96:99]
    s_add_u32 s61, s58, s59
    ds_read_b64_tr_b16 a[228:229], v42 offset:0
    v_mfma_f32_16x16x32_bf16 v[92:95], a[92:95], a[60:63], v[92:95]
    s_add_u32 m0, s63, 114688
    v_mfma_f32_16x16x32_bf16 v[88:91], a[88:91], a[60:63], v[88:91]
    ds_read_b64_tr_b16 a[40:41], v16 offset:0
    v_mfma_f32_16x16x32_bf16 v[112:115], a[88:91], a[64:67], v[112:115]
    ds_read_b64_tr_b16 a[230:231], v42 offset:512
    v_mov_b32_e64 v24, v54
    v_mfma_f32_16x16x32_bf16 v[116:119], a[92:95], a[64:67], v[116:119]
    ds_read_b64_tr_b16 a[42:43], v16 offset:512
    v_mfma_f32_16x16x32_bf16 v[120:123], a[96:99], a[64:67], v[120:123]
    v_mov_b32_e64 v25, v55
    v_mfma_f32_16x16x32_bf16 v[124:127], a[100:103], a[64:67], v[124:127]
    ds_read_b64_tr_b16 a[44:45], v16 offset:3072
    v_mfma_f32_16x16x32_bf16 v[128:131], a[104:107], a[64:67], v[128:131]
    v_permlane16_swap_b32_e64 v54, v24
    v_mfma_f32_16x16x32_bf16 v[132:135], a[108:111], a[64:67], v[132:135]
    buffer_load_dwordx4 v8, s[8:11], s61 offen lds
    ds_read_b64_tr_b16 a[46:47], v16 offset:3584
    v_mfma_f32_16x16x32_bf16 v[156:159], a[108:111], a[68:71], v[156:159]
    v_permlane16_swap_b32_e64 v55, v25
    v_mfma_f32_16x16x32_bf16 v[152:155], a[104:107], a[68:71], v[152:155]
    v_add_f32_e64 v54, v54, v24
    ds_read_b64_tr_b16 a[48:49], v17 offset:0
    v_mfma_f32_16x16x32_bf16 v[148:151], a[100:103], a[68:71], v[148:151]
    v_add_f32_e64 v55, v55, v25
    v_mfma_f32_16x16x32_bf16 v[144:147], a[96:99], a[68:71], v[144:147]
    buffer_load_dwordx4 v9, s[8:11], s61 offen offset:1024 lds
    v_mul_f32 v54, 0x3acccccd, v54
    v_mfma_f32_16x16x32_bf16 v[140:143], a[92:95], a[68:71], v[140:143]
    s_add_u32 m0, s62, 49152
    ds_read_b64_tr_b16 a[50:51], v17 offset:512
    v_mul_f32 v55, 0x3acccccd, v55
    v_mfma_f32_16x16x32_bf16 v[136:139], a[88:91], a[68:71], v[136:139]
    v_mfma_f32_16x16x32_bf16 v[160:163], a[88:91], a[72:75], v[160:163]
    v_fma_f32 v55, -v54, v54, v55
    ds_read_b64_tr_b16 a[52:53], v17 offset:3072
    v_mfma_f32_16x16x32_bf16 v[164:167], a[92:95], a[72:75], v[164:167]
L_isl_gu_1:
    s_cbranch_execz L_isl_gu_5
    buffer_load_dwordx4 v4, s[12:15], s60 offen lds
    v_max_f32 v55, 0, v55
    v_mfma_f32_16x16x32_bf16 v[168:171], a[96:99], a[72:75], v[168:171]
    ds_read_b64_tr_b16 a[54:55], v17 offset:3584
    v_cvt_pk_bf16_f32 v55, v55, v55
    v_mfma_f32_16x16x32_bf16 v[172:175], a[100:103], a[72:75], v[172:175]
    v_mfma_f32_16x16x32_bf16 v[176:179], a[104:107], a[72:75], v[176:179]
    v_lshlrev_b32_e64 v55, 16, v55
    ds_read_b128 a[4:7], v13 offset:34816
    v_mfma_f32_16x16x32_bf16 v[180:183], a[108:111], a[72:75], v[180:183]
    buffer_load_dwordx4 v5, s[12:15], s60 offen offset:1024 lds
    v_add_f32 v55, 0x3727c5ac, v55
    v_mfma_f32_16x16x32_bf16 v[204:207], a[108:111], a[76:79], v[204:207]
    ds_read_b128 a[8:11], v13 offset:36864
    v_mfma_f32_16x16x32_bf16 v[200:203], a[104:107], a[76:79], v[200:203]
    v_cvt_pk_bf16_f32 v55, v55, v55
    v_mfma_f32_16x16x32_bf16 v[196:199], a[100:103], a[76:79], v[196:199]
    v_lshlrev_b32_e64 v55, 16, v55
    v_mfma_f32_16x16x32_bf16 v[192:195], a[96:99], a[76:79], v[192:195]
    buffer_load_dwordx4 v6, s[12:15], s60 offen offset:2048 lds
    s_add_u32 m0, s43, 49152
    v_mfma_f32_16x16x32_bf16 v[188:191], a[92:95], a[76:79], v[188:191]
    ds_read_b128 a[12:15], v13 offset:38912
    v_mfma_f32_16x16x32_bf16 v[184:187], a[88:91], a[76:79], v[184:187]
    v_sqrt_f32_e64 v55, v55
    v_mfma_f32_16x16x32_bf16 v[208:211], a[88:91], a[80:83], v[208:211]
    v_cvt_pk_bf16_f32 v54, -v54, -v54
    ds_read_b128 a[16:19], v7 offset:40960
    v_mfma_f32_16x16x32_bf16 v[212:215], a[92:95], a[80:83], v[212:215]
    buffer_load_dwordx4 v4, s[16:19], s60 offen lds
    v_cvt_pk_bf16_f32 v55, v55, v55
    v_mfma_f32_16x16x32_bf16 v[216:219], a[96:99], a[80:83], v[216:219]
    ds_read_b128 a[20:23], v7 offset:43008
    v_lshlrev_b32_e64 v55, 16, v55
    v_mfma_f32_16x16x32_bf16 v[220:223], a[100:103], a[80:83], v[220:223]
    ds_read_b128 a[24:27], v7 offset:45056
    v_mfma_f32_16x16x32_bf16 v[224:227], a[104:107], a[80:83], v[224:227]
    v_rcp_f32_e64 v55, v55
    v_mfma_f32_16x16x32_bf16 v[228:231], a[108:111], a[80:83], v[228:231]
    buffer_load_dwordx4 v5, s[16:19], s60 offen offset:1024 lds
    v_cndmask_b32 v54, v54, v55, s[74:75]
    v_mfma_f32_16x16x32_bf16 v[252:255], a[108:111], a[84:87], v[252:255]
    ds_read_b128 a[28:31], v7 offset:47104
    v_mfma_f32_16x16x32_bf16 v[248:251], a[104:107], a[84:87], v[248:251]
    buffer_store_dword v54, v36, s[20:23], 0 offen sc1
    v_mfma_f32_16x16x32_bf16 v[244:247], a[100:103], a[84:87], v[244:247]
    buffer_load_dwordx4 v6, s[16:19], s60 offen offset:2048 lds
    s_add_u32 s60, s60, s0
    v_mfma_f32_16x16x32_bf16 v[240:243], a[96:99], a[84:87], v[240:243]
    v_mfma_f32_16x16x32_bf16 v[236:239], a[92:95], a[84:87], v[236:239]
    v_mfma_f32_16x16x32_bf16 v[232:235], a[88:91], a[84:87], v[232:235]
    s_waitcnt vmcnt(11) lgkmcnt(0)
    s_barrier
    v_mfma_f32_16x16x32_bf16 v[64:67], a[32:35], a[0:3], v[64:67]
    s_add_u32 m0, s63, 114688
    ds_read_b128 a[56:59], v14 offset:32768
    v_mfma_f32_16x16x32_bf16 v[68:71], a[36:39], a[0:3], v[68:71]
    v_mfma_f32_16x16x32_bf16 v[72:75], a[40:43], a[0:3], v[72:75]
    buffer_load_dwordx4 v10, s[8:11], s61 offen offset:2048 lds
    ds_read_b64_tr_b16 a[88:89], v15 offset:24576
    v_mfma_f32_16x16x32_bf16 v[76:79], a[44:47], a[0:3], v[76:79]
    v_mfma_f32_16x16x32_bf16 v[80:83], a[48:51], a[0:3], v[80:83]
    ds_read_b64_tr_b16 a[90:91], v15 offset:25088
    v_mfma_f32_16x16x32_bf16 v[84:87], a[52:55], a[0:3], v[84:87]
    v_mfma_f32_16x16x32_bf16 v[108:111], a[52:55], a[4:7], v[108:111]
    buffer_load_dwordx4 v11, s[8:11], s61 offen offset:3072 lds
    ds_read_b64_tr_b16 a[92:93], v15 offset:27648
    v_mfma_f32_16x16x32_bf16 v[104:107], a[48:51], a[4:7], v[104:107]
    s_bfe_u32 s59, s30, 0x40014
    v_mfma_f32_16x16x32_bf16 v[100:103], a[44:47], a[4:7], v[100:103]
    s_lshl_b32 s59, s59, 7
    ds_read_b64_tr_b16 a[94:95], v15 offset:28160
    v_mfma_f32_16x16x32_bf16 v[96:99], a[40:43], a[4:7], v[96:99]
    s_add_u32 s61, s58, s59
    v_mfma_f32_16x16x32_bf16 v[92:95], a[36:39], a[4:7], v[92:95]
    s_add_u32 m0, s62, 73728
    v_mfma_f32_16x16x32_bf16 v[88:91], a[32:35], a[4:7], v[88:91]
    ds_read_b64_tr_b16 a[96:97], v16 offset:24576
    v_mfma_f32_16x16x32_bf16 v[112:115], a[32:35], a[8:11], v[112:115]
    v_mfma_f32_16x16x32_bf16 v[116:119], a[36:39], a[8:11], v[116:119]
    ds_read_b64_tr_b16 a[98:99], v16 offset:25088
    v_mfma_f32_16x16x32_bf16 v[120:123], a[40:43], a[8:11], v[120:123]
    v_mfma_f32_16x16x32_bf16 v[124:127], a[44:47], a[8:11], v[124:127]
    ds_read_b64_tr_b16 a[100:101], v16 offset:27648
    v_mfma_f32_16x16x32_bf16 v[128:131], a[48:51], a[8:11], v[128:131]
    buffer_store_dwordx4 a[216:219], v43, s[20:23], s64 offen offset:0 sc1
    v_mfma_f32_16x16x32_bf16 v[132:135], a[52:55], a[8:11], v[132:135]
    ds_read_b64_tr_b16 a[102:103], v16 offset:28160
    v_mfma_f32_16x16x32_bf16 v[156:159], a[52:55], a[12:15], v[156:159]
    v_mfma_f32_16x16x32_bf16 v[152:155], a[48:51], a[12:15], v[152:155]
    ds_read_b64_tr_b16 a[104:105], v17 offset:24576
    v_mfma_f32_16x16x32_bf16 v[148:151], a[44:47], a[12:15], v[148:151]
    buffer_load_dwordx4 v4, s[12:15], s60 offen lds
    v_mfma_f32_16x16x32_bf16 v[144:147], a[40:43], a[12:15], v[144:147]
    v_mfma_f32_16x16x32_bf16 v[140:143], a[36:39], a[12:15], v[140:143]
    ds_read_b64_tr_b16 a[106:107], v17 offset:25088
    v_mfma_f32_16x16x32_bf16 v[136:139], a[32:35], a[12:15], v[136:139]
    v_mfma_f32_16x16x32_bf16 v[160:163], a[32:35], a[16:19], v[160:163]
    buffer_load_dwordx4 v5, s[12:15], s60 offen offset:1024 lds
    ds_read_b64_tr_b16 a[108:109], v17 offset:27648
    v_mfma_f32_16x16x32_bf16 v[164:167], a[36:39], a[16:19], v[164:167]
    v_mfma_f32_16x16x32_bf16 v[168:171], a[40:43], a[16:19], v[168:171]
    ds_read_b64_tr_b16 a[110:111], v17 offset:28160
    v_mfma_f32_16x16x32_bf16 v[172:175], a[44:47], a[16:19], v[172:175]
    v_mfma_f32_16x16x32_bf16 v[176:179], a[48:51], a[16:19], v[176:179]
    buffer_load_dwordx4 v6, s[12:15], s60 offen offset:2048 lds
    s_add_u32 m0, s43, 73728
    v_mfma_f32_16x16x32_bf16 v[180:183], a[52:55], a[16:19], v[180:183]
    ds_read_b128 a[60:63], v14 offset:34816
    v_mfma_f32_16x16x32_bf16 v[204:207], a[52:55], a[20:23], v[204:207]
    ds_read_b128 a[64:67], v14 offset:36864
    v_mfma_f32_16x16x32_bf16 v[200:203], a[48:51], a[20:23], v[200:203]
    v_mfma_f32_16x16x32_bf16 v[196:199], a[44:47], a[20:23], v[196:199]
    buffer_load_dwordx4 v4, s[16:19], s60 offen lds
    v_mfma_f32_16x16x32_bf16 v[192:195], a[40:43], a[20:23], v[192:195]
    ds_read_b128 a[68:71], v14 offset:38912
    v_mfma_f32_16x16x32_bf16 v[188:191], a[36:39], a[20:23], v[188:191]
    v_mfma_f32_16x16x32_bf16 v[184:187], a[32:35], a[20:23], v[184:187]
    ds_read_b128 a[72:75], v12 offset:40960
    v_mfma_f32_16x16x32_bf16 v[208:211], a[32:35], a[24:27], v[208:211]
    buffer_load_dwordx4 v5, s[16:19], s60 offen offset:1024 lds
    v_mfma_f32_16x16x32_bf16 v[212:215], a[36:39], a[24:27], v[212:215]
    ds_read_b128 a[76:79], v12 offset:43008
    v_mfma_f32_16x16x32_bf16 v[216:219], a[40:43], a[24:27], v[216:219]
    v_mfma_f32_16x16x32_bf16 v[220:223], a[44:47], a[24:27], v[220:223]
    ds_read_b128 a[80:83], v12 offset:45056
    v_mfma_f32_16x16x32_bf16 v[224:227], a[48:51], a[24:27], v[224:227]
    buffer_load_dwordx4 v6, s[16:19], s60 offen offset:2048 lds
    s_bfe_u32 s59, s30, 0x40010
    v_mfma_f32_16x16x32_bf16 v[228:231], a[52:55], a[24:27], v[228:231]
    s_mul_i32 s59, s59, 221184
    ds_read_b128 a[84:87], v12 offset:47104
    v_mfma_f32_16x16x32_bf16 v[252:255], a[52:55], a[28:31], v[252:255]
    s_add_u32 s60, s56, s59
    v_mfma_f32_16x16x32_bf16 v[248:251], a[48:51], a[28:31], v[248:251]
    v_mfma_f32_16x16x32_bf16 v[244:247], a[44:47], a[28:31], v[244:247]
    buffer_store_dwordx4 a[220:223], v43, s[20:23], s64 offen offset:1024 sc1
    v_mfma_f32_16x16x32_bf16 v[240:243], a[40:43], a[28:31], v[240:243]
    v_mfma_f32_16x16x32_bf16 v[236:239], a[36:39], a[28:31], v[236:239]
    v_mfma_f32_16x16x32_bf16 v[232:235], a[32:35], a[28:31], v[232:235]
    s_bitcmp0_b32 s101, 4
    s_cbranch_scc1 L_nocs_gu_4
    v_mfma_f32_16x16x32_bf16 a[176:179], a[200:203], a[32:35], a[176:179]
    v_mfma_f32_16x16x32_bf16 a[180:183], a[200:203], a[36:39], a[180:183]
    v_mfma_f32_16x16x32_bf16 a[184:187], a[200:203], a[40:43], a[184:187]
    v_mfma_f32_16x16x32_bf16 a[188:191], a[200:203], a[44:47], a[188:191]
    v_mfma_f32_16x16x32_bf16 a[192:195], a[200:203], a[48:51], a[192:195]
    v_mfma_f32_16x16x32_bf16 a[196:199], a[200:203], a[52:55], a[196:199]
L_nocs_gu_4:
    s_waitcnt vmcnt(10) lgkmcnt(0)
    s_barrier
    v_mfma_f32_16x16x32_bf16 v[64:67], a[88:91], a[56:59], v[64:67]
    s_add_u32 m0, s63, 131072
    buffer_store_dwordx4 a[224:227], v43, s[20:23], s64 offen offset:2048 sc1
    ds_read_b128 a[0:3], v13 offset:0
    v_mfma_f32_16x16x32_bf16 v[68:71], a[92:95], a[56:59], v[68:71]
    v_mfma_f32_16x16x32_bf16 v[72:75], a[96:99], a[56:59], v[72:75]
    ds_read_b64_tr_b16 a[32:33], v18 offset:0
    v_mfma_f32_16x16x32_bf16 v[76:79], a[100:103], a[56:59], v[76:79]
    v_mfma_f32_16x16x32_bf16 v[80:83], a[104:107], a[56:59], v[80:83]
    buffer_load_dwordx4 v8, s[8:11], s61 offen lds
    ds_read_b64_tr_b16 a[34:35], v18 offset:512
    v_mfma_f32_16x16x32_bf16 v[84:87], a[108:111], a[56:59], v[84:87]
    v_mfma_f32_16x16x32_bf16 v[108:111], a[108:111], a[60:63], v[108:111]
    ds_read_b64_tr_b16 a[36:37], v18 offset:3072
    v_mfma_f32_16x16x32_bf16 v[104:107], a[104:107], a[60:63], v[104:107]
    v_mfma_f32_16x16x32_bf16 v[100:103], a[100:103], a[60:63], v[100:103]
    buffer_load_dwordx4 v9, s[8:11], s61 offen offset:1024 lds
    ds_read_b64_tr_b16 a[38:39], v18 offset:3584
    v_mfma_f32_16x16x32_bf16 v[96:99], a[96:99], a[60:63], v[96:99]
    s_add_u32 m0, s62, 0
    v_mfma_f32_16x16x32_bf16 v[92:95], a[92:95], a[60:63], v[92:95]
    v_mfma_f32_16x16x32_bf16 v[88:91], a[88:91], a[60:63], v[88:91]
    ds_read_b64_tr_b16 a[40:41], v19 offset:0
    v_mfma_f32_16x16x32_bf16 v[112:115], a[88:91], a[64:67], v[112:115]
    v_mfma_f32_16x16x32_bf16 v[116:119], a[92:95], a[64:67], v[116:119]
    ds_read_b64_tr_b16 a[42:43], v19 offset:512
    v_mfma_f32_16x16x32_bf16 v[120:123], a[96:99], a[64:67], v[120:123]
    v_mfma_f32_16x16x32_bf16 v[124:127], a[100:103], a[64:67], v[124:127]
    buffer_load_dwordx4 v4, s[12:15], s60 offen lds
    ds_read_b64_tr_b16 a[44:45], v19 offset:3072
    v_mfma_f32_16x16x32_bf16 v[128:131], a[104:107], a[64:67], v[128:131]
    v_mfma_f32_16x16x32_bf16 v[132:135], a[108:111], a[64:67], v[132:135]
    ds_read_b64_tr_b16 a[46:47], v19 offset:3584
    v_mfma_f32_16x16x32_bf16 v[156:159], a[108:111], a[68:71], v[156:159]
    v_mfma_f32_16x16x32_bf16 v[152:155], a[104:107], a[68:71], v[152:155]
    buffer_store_dwordx4 a[228:231], v43, s[20:23], s64 offen offset:3072 sc1
    ds_read_b64_tr_b16 a[48:49], v20 offset:0
    v_mfma_f32_16x16x32_bf16 v[148:151], a[100:103], a[68:71], v[148:151]
    v_mfma_f32_16x16x32_bf16 v[144:147], a[96:99], a[68:71], v[144:147]
    v_mfma_f32_16x16x32_bf16 v[140:143], a[92:95], a[68:71], v[140:143]
    ds_read_b64_tr_b16 a[50:51], v20 offset:512
    v_mfma_f32_16x16x32_bf16 v[136:139], a[88:91], a[68:71], v[136:139]
    buffer_load_dwordx4 v5, s[12:15], s60 offen offset:1024 lds
    v_mfma_f32_16x16x32_bf16 v[160:163], a[88:91], a[72:75], v[160:163]
    ds_read_b64_tr_b16 a[52:53], v20 offset:3072
    v_mfma_f32_16x16x32_bf16 v[164:167], a[92:95], a[72:75], v[164:167]
    v_mfma_f32_16x16x32_bf16 v[168:171], a[96:99], a[72:75], v[168:171]
    ds_read_b64_tr_b16 a[54:55], v20 offset:3584
    v_mfma_f32_16x16x32_bf16 v[172:175], a[100:103], a[72:75], v[172:175]
    buffer_load_dwordx4 v6, s[12:15], s60 offen offset:2048 lds
    s_add_u32 m0, s43, 0
    v_mfma_f32_16x16x32_bf16 v[176:179], a[104:107], a[72:75], v[176:179]
    ds_read_b128 a[4:7], v13 offset:2048
    v_mfma_f32_16x16x32_bf16 v[180:183], a[108:111], a[72:75], v[180:183]
    v_mfma_f32_16x16x32_bf16 v[204:207], a[108:111], a[76:79], v[204:207]
    ds_read_b128 a[8:11], v13 offset:4096
    v_mfma_f32_16x16x32_bf16 v[200:203], a[104:107], a[76:79], v[200:203]
    buffer_load_dwordx4 v4, s[16:19], s60 offen lds
    v_mfma_f32_16x16x32_bf16 v[196:199], a[100:103], a[76:79], v[196:199]
    v_mfma_f32_16x16x32_bf16 v[192:195], a[96:99], a[76:79], v[192:195]
    ds_read_b128 a[12:15], v13 offset:6144
    v_mfma_f32_16x16x32_bf16 v[188:191], a[92:95], a[76:79], v[188:191]
    v_mfma_f32_16x16x32_bf16 v[184:187], a[88:91], a[76:79], v[184:187]
    buffer_load_dwordx4 v5, s[16:19], s60 offen offset:1024 lds
    ds_read_b128 a[16:19], v7 offset:8192
    v_mfma_f32_16x16x32_bf16 v[208:211], a[88:91], a[80:83], v[208:211]
    v_mfma_f32_16x16x32_bf16 v[212:215], a[92:95], a[80:83], v[212:215]
    ds_read_b128 a[20:23], v7 offset:10240
    v_mfma_f32_16x16x32_bf16 v[216:219], a[96:99], a[80:83], v[216:219]
    v_mfma_f32_16x16x32_bf16 v[220:223], a[100:103], a[80:83], v[220:223]
    buffer_load_dword v47, off, s[32:35], 0 sc1
    ds_read_b128 a[24:27], v7 offset:12288
    v_mfma_f32_16x16x32_bf16 v[224:227], a[104:107], a[80:83], v[224:227]
    v_mfma_f32_16x16x32_bf16 v[228:231], a[108:111], a[80:83], v[228:231]
    ds_read_b128 a[28:31], v7 offset:14336
    v_mfma_f32_16x16x32_bf16 v[252:255], a[108:111], a[84:87], v[252:255]
    v_mfma_f32_16x16x32_bf16 v[248:251], a[104:107], a[84:87], v[248:251]
    buffer_load_dwordx4 v6, s[16:19], s60 offen offset:2048 lds
    s_add_u32 s60, s60, s0
    v_mfma_f32_16x16x32_bf16 v[244:247], a[100:103], a[84:87], v[244:247]
    v_mfma_f32_16x16x32_bf16 v[240:243], a[96:99], a[84:87], v[240:243]
    v_mfma_f32_16x16x32_bf16 v[236:239], a[92:95], a[84:87], v[236:239]
    v_mfma_f32_16x16x32_bf16 v[232:235], a[88:91], a[84:87], v[232:235]
    s_bitcmp0_b32 s101, 5
    s_cbranch_scc1 L_nocs_gu_5
    v_mfma_f32_16x16x32_bf16 a[176:179], a[200:203], a[88:91], a[176:179]
    v_mfma_f32_16x16x32_bf16 a[180:183], a[200:203], a[92:95], a[180:183]
    v_mfma_f32_16x16x32_bf16 a[184:187], a[200:203], a[96:99], a[184:187]
    v_mfma_f32_16x16x32_bf16 a[188:191], a[200:203], a[100:103], a[188:191]
    v_mfma_f32_16x16x32_bf16 a[192:195], a[200:203], a[104:107], a[192:195]
    v_mfma_f32_16x16x32_bf16 a[196:199], a[200:203], a[108:111], a[196:199]
L_nocs_gu_5:
    s_waitcnt vmcnt(12) lgkmcnt(0)
    s_barrier
    v_mfma_f32_16x16x32_bf16 v[64:67], a[32:35], a[0:3], v[64:67]
    s_add_u32 m0, s63, 131072
    ds_read_b128 a[56:59], v14 offset:0
    v_mfma_f32_16x16x32_bf16 v[68:71], a[36:39], a[0:3], v[68:71]
    v_mfma_f32_16x16x32_bf16 v[72:75], a[40:43], a[0:3], v[72:75]
    buffer_load_dwordx4 v10, s[8:11], s61 offen offset:2048 lds
    ds_read_b64_tr_b16 a[88:89], v18 offset:24576
    v_mfma_f32_16x16x32_bf16 v[76:79], a[44:47], a[0:3], v[76:79]
    v_mfma_f32_16x16x32_bf16 v[80:83], a[48:51], a[0:3], v[80:83]
    ds_read_b64_tr_b16 a[90:91], v18 offset:25088
    v_mfma_f32_16x16x32_bf16 v[84:87], a[52:55], a[0:3], v[84:87]
    v_mfma_f32_16x16x32_bf16 v[108:111], a[52:55], a[4:7], v[108:111]
    ds_read_b64_tr_b16 a[92:93], v18 offset:27648
    v_mfma_f32_16x16x32_bf16 v[104:107], a[48:51], a[4:7], v[104:107]
    buffer_load_dwordx4 v11, s[8:11], s61 offen offset:3072 lds
    s_bfe_u32 s59, s30, 0x40018
    v_mfma_f32_16x16x32_bf16 v[100:103], a[44:47], a[4:7], v[100:103]
    s_lshl_b32 s59, s59, 7
    ds_read_b64_tr_b16 a[94:95], v18 offset:28160
    v_mfma_f32_16x16x32_bf16 v[96:99], a[40:43], a[4:7], v[96:99]
    s_add_u32 s61, s58, s59
    v_mfma_f32_16x16x32_bf16 v[92:95], a[36:39], a[4:7], v[92:95]
    s_add_u32 m0, s62, 24576
    v_mfma_f32_16x16x32_bf16 v[88:91], a[32:35], a[4:7], v[88:91]
    ds_read_b64_tr_b16 a[96:97], v19 offset:24576
    v_mfma_f32_16x16x32_bf16 v[112:115], a[32:35], a[8:11], v[112:115]
    v_mfma_f32_16x16x32_bf16 v[116:119], a[36:39], a[8:11], v[116:119]
    ds_read_b64_tr_b16 a[98:99], v19 offset:25088
    v_mfma_f32_16x16x32_bf16 v[120:123], a[40:43], a[8:11], v[120:123]
    v_mfma_f32_16x16x32_bf16 v[124:127], a[44:47], a[8:11], v[124:127]
    ds_read_b64_tr_b16 a[100:101], v19 offset:27648
    v_mfma_f32_16x16x32_bf16 v[128:131], a[48:51], a[8:11], v[128:131]
    v_mfma_f32_16x16x32_bf16 v[132:135], a[52:55], a[8:11], v[132:135]
    ds_read_b64_tr_b16 a[102:103], v19 offset:28160
    v_mfma_f32_16x16x32_bf16 v[156:159], a[52:55], a[12:15], v[156:159]
    buffer_load_dwordx4 v4, s[12:15], s60 offen lds
    v_mfma_f32_16x16x32_bf16 v[152:155], a[48:51], a[12:15], v[152:155]
    ds_read_b64_tr_b16 a[104:105], v20 offset:24576
    v_mfma_f32_16x16x32_bf16 v[148:151], a[44:47], a[12:15], v[148:151]
    v_mfma_f32_16x16x32_bf16 v[144:147], a[40:43], a[12:15], v[144:147]
    v_mfma_f32_16x16x32_bf16 v[140:143], a[36:39], a[12:15], v[140:143]
    ds_read_b64_tr_b16 a[106:107], v20 offset:25088
    v_mfma_f32_16x16x32_bf16 v[136:139], a[32:35], a[12:15], v[136:139]
    buffer_load_dwordx4 v5, s[12:15], s60 offen offset:1024 lds
    v_mfma_f32_16x16x32_bf16 v[160:163], a[32:35], a[16:19], v[160:163]
    ds_read_b64_tr_b16 a[108:109], v20 offset:27648
    v_mfma_f32_16x16x32_bf16 v[164:167], a[36:39], a[16:19], v[164:167]
    v_mfma_f32_16x16x32_bf16 v[168:171], a[40:43], a[16:19], v[168:171]
    ds_read_b64_tr_b16 a[110:111], v20 offset:28160
    v_mfma_f32_16x16x32_bf16 v[172:175], a[44:47], a[16:19], v[172:175]
    v_mfma_f32_16x16x32_bf16 v[176:179], a[48:51], a[16:19], v[176:179]
    buffer_load_dwordx4 v6, s[12:15], s60 offen offset:2048 lds
    s_add_u32 m0, s43, 24576
    v_mfma_f32_16x16x32_bf16 v[180:183], a[52:55], a[16:19], v[180:183]
    ds_read_b128 a[60:63], v14 offset:2048
    v_mfma_f32_16x16x32_bf16 v[204:207], a[52:55], a[20:23], v[204:207]
    ds_read_b128 a[64:67], v14 offset:4096
    v_mfma_f32_16x16x32_bf16 v[200:203], a[48:51], a[20:23], v[200:203]
    v_mfma_f32_16x16x32_bf16 v[196:199], a[44:47], a[20:23], v[196:199]
    v_mfma_f32_16x16x32_bf16 v[192:195], a[40:43], a[20:23], v[192:195]
    buffer_load_dwordx4 v4, s[16:19], s60 offen lds
    ds_read_b128 a[68:71], v14 offset:6144
    v_mfma_f32_16x16x32_bf16 v[188:191], a[36:39], a[20:23], v[188:191]
    v_mfma_f32_16x16x32_bf16 v[184:187], a[32:35], a[20:23], v[184:187]
    ds_read_b128 a[72:75], v12 offset:8192
    v_mfma_f32_16x16x32_bf16 v[208:211], a[32:35], a[24:27], v[208:211]
    v_mfma_f32_16x16x32_bf16 v[212:215], a[36:39], a[24:27], v[212:215]
    ds_read_b128 a[76:79], v12 offset:10240
    v_mfma_f32_16x16x32_bf16 v[216:219], a[40:43], a[24:27], v[216:219]
    buffer_load_dwordx4 v5, s[16:19], s60 offen offset:1024 lds
    v_mfma_f32_16x16x32_bf16 v[220:223], a[44:47], a[24:27], v[220:223]
    ds_read_b128 a[80:83], v12 offset:12288
    v_mfma_f32_16x16x32_bf16 v[224:227], a[48:51], a[24:27], v[224:227]
    v_mfma_f32_16x16x32_bf16 v[228:231], a[52:55], a[24:27], v[228:231]
    ds_read_b128 a[84:87], v12 offset:14336
    v_mfma_f32_16x16x32_bf16 v[252:255], a[52:55], a[28:31], v[252:255]
    v_mfma_f32_16x16x32_bf16 v[248:251], a[48:51], a[28:31], v[248:251]
    buffer_load_dwordx4 v6, s[16:19], s60 offen offset:2048 lds
    s_bfe_u32 s59, s30, 0x40014
    v_mfma_f32_16x16x32_bf16 v[244:247], a[44:47], a[28:31], v[244:247]
    s_mul_i32 s59, s59, 221184
    s_add_u32 s60, s56, s59
    v_mfma_f32_16x16x32_bf16 v[240:243], a[40:43], a[28:31], v[240:243]
    v_mfma_f32_16x16x32_bf16 v[236:239], a[36:39], a[28:31], v[236:239]
    v_mfma_f32_16x16x32_bf16 v[232:235], a[32:35], a[28:31], v[232:235]
    s_waitcnt vmcnt(8) lgkmcnt(0)
    s_barrier
    v_cmp_eq_u32_e64 vcc, 0, v47
    v_mfma_f32_16x16x32_bf16 v[64:67], a[88:91], a[56:59], v[64:67]
    ds_read_b128 a[0:3], v13 offset:16384
    v_mfma_f32_16x16x32_bf16 v[68:71], a[92:95], a[56:59], v[68:71]
    s_cbranch_vccnz L_slow_rgu
L_ok_rgu:
    v_mfma_f32_16x16x32_bf16 v[72:75], a[96:99], a[56:59], v[72:75]
    s_add_u32 m0, s63, 98304
    ds_read_b64_tr_b16 a[32:33], v15 offset:0
    v_mfma_f32_16x16x32_bf16 v[76:79], a[100:103], a[56:59], v[76:79]
    v_mfma_f32_16x16x32_bf16 v[80:83], a[104:107], a[56:59], v[80:83]
    ds_read_b64_tr_b16 a[34:35], v15 offset:512
    v_mfma_f32_16x16x32_bf16 v[84:87], a[108:111], a[56:59], v[84:87]
    v_mfma_f32_16x16x32_bf16 v[108:111], a[108:111], a[60:63], v[108:111]
    buffer_load_dwordx4 v8, s[8:11], s61 offen lds
    v_or_b32 v1, s4, v0
    v_mfma_f32_16x16x32_bf16 v[104:107], a[104:107], a[60:63], v[104:107]
    ds_read_b64_tr_b16 a[36:37], v15 offset:3072
    v_mfma_f32_16x16x32_bf16 v[100:103], a[100:103], a[60:63], v[100:103]
    ds_read_b64_tr_b16 a[38:39], v15 offset:3584
    v_mfma_f32_16x16x32_bf16 v[96:99], a[96:99], a[60:63], v[96:99]
    v_mfma_f32_16x16x32_bf16 v[92:95], a[92:95], a[60:63], v[92:95]
    v_mfma_f32_16x16x32_bf16 v[88:91], a[88:91], a[60:63], v[88:91]
    buffer_load_dwordx4 v9, s[8:11], s61 offen offset:1024 lds
    ds_read_b64_tr_b16 a[40:41], v16 offset:0
    v_mfma_f32_16x16x32_bf16 v[112:115], a[88:91], a[64:67], v[112:115]
    s_add_u32 m0, s62, 49152
    v_cmp_eq_u32 s[70:71], 0, v1
    v_mfma_f32_16x16x32_bf16 v[116:119], a[92:95], a[64:67], v[116:119]
    s_lshl_b32 s3, s2, 4
    ds_read_b64_tr_b16 a[42:43], v16 offset:512
    v_mfma_f32_16x16x32_bf16 v[120:123], a[96:99], a[64:67], v[120:123]
    s_add_u32 s3, s3, 23134208
    v_mfma_f32_16x16x32_bf16 v[124:127], a[100:103], a[64:67], v[124:127]
    ds_read_b64_tr_b16 a[44:45], v16 offset:3072
    v_mfma_f32_16x16x32_bf16 v[128:131], a[104:107], a[64:67], v[128:131]
    v_mfma_f32_16x16x32_bf16 v[132:135], a[108:111], a[64:67], v[132:135]
    buffer_load_dwordx4 v4, s[12:15], s60 offen lds
    ds_read_b64_tr_b16 a[46:47], v16 offset:3584
    v_mfma_f32_16x16x32_bf16 v[156:159], a[108:111], a[68:71], v[156:159]
    v_mfma_f32_16x16x32_bf16 v[152:155], a[104:107], a[68:71], v[152:155]
    ds_read_b64_tr_b16 a[48:49], v17 offset:0
    v_mfma_f32_16x16x32_bf16 v[148:151], a[100:103], a[68:71], v[148:151]
    v_mfma_f32_16x16x32_bf16 v[144:147], a[96:99], a[68:71], v[144:147]
    v_mfma_f32_16x16x32_bf16 v[140:143], a[92:95], a[68:71], v[140:143]
    buffer_load_dwordx4 v5, s[12:15], s60 offen offset:1024 lds
    ds_read_b64_tr_b16 a[50:51], v17 offset:512
    v_mfma_f32_16x16x32_bf16 v[136:139], a[88:91], a[68:71], v[136:139]
    v_mfma_f32_16x16x32_bf16 v[160:163], a[88:91], a[72:75], v[160:163]
    ds_read_b64_tr_b16 a[52:53], v17 offset:3072
    v_mfma_f32_16x16x32_bf16 v[164:167], a[92:95], a[72:75], v[164:167]
    v_mfma_f32_16x16x32_bf16 v[168:171], a[96:99], a[72:75], v[168:171]
    ds_read_b64_tr_b16 a[54:55], v17 offset:3584
    v_mfma_f32_16x16x32_bf16 v[172:175], a[100:103], a[72:75], v[172:175]
    buffer_load_dwordx4 v6, s[12:15], s60 offen offset:2048 lds
    s_add_u32 m0, s43, 49152
    v_mfma_f32_16x16x32_bf16 v[176:179], a[104:107], a[72:75], v[176:179]
    ds_read_b128 a[4:7], v13 offset:18432
    v_mfma_f32_16x16x32_bf16 v[180:183], a[108:111], a[72:75], v[180:183]
    v_mfma_f32_16x16x32_bf16 v[204:207], a[108:111], a[76:79], v[204:207]
    v_mov_b32 v2, 1
    ds_read_b128 a[8:11], v13 offset:20480
    v_mfma_f32_16x16x32_bf16 v[200:203], a[104:107], a[76:79], v[200:203]
    v_mfma_f32_16x16x32_bf16 v[196:199], a[100:103], a[76:79], v[196:199]
    buffer_load_dwordx4 v4, s[16:19], s60 offen lds
    v_mfma_f32_16x16x32_bf16 v[192:195], a[96:99], a[76:79], v[192:195]
    ds_read_b128 a[12:15], v13 offset:22528
    v_mfma_f32_16x16x32_bf16 v[188:191], a[92:95], a[76:79], v[188:191]
    v_mfma_f32_16x16x32_bf16 v[184:187], a[88:91], a[76:79], v[184:187]
    ds_read_b128 a[16:19], v7 offset:24576
    v_mfma_f32_16x16x32_bf16 v[208:211], a[88:91], a[80:83], v[208:211]
    v_cndmask_b32 v1, v38, 0, s[70:71]
    v_mfma_f32_16x16x32_bf16 v[212:215], a[92:95], a[80:83], v[212:215]
    buffer_load_dwordx4 v5, s[16:19], s60 offen offset:1024 lds
    ds_read_b128 a[20:23], v7 offset:26624
    v_mfma_f32_16x16x32_bf16 v[216:219], a[96:99], a[80:83], v[216:219]
    v_mfma_f32_16x16x32_bf16 v[220:223], a[100:103], a[80:83], v[220:223]
    ds_read_b128 a[24:27], v7 offset:28672
    v_mfma_f32_16x16x32_bf16 v[224:227], a[104:107], a[80:83], v[224:227]
    v_mfma_f32_16x16x32_bf16 v[228:231], a[108:111], a[80:83], v[228:231]
    ds_read_b128 a[28:31], v7 offset:30720
    v_mfma_f32_16x16x32_bf16 v[252:255], a[108:111], a[84:87], v[252:255]
    buffer_load_dwordx4 v6, s[16:19], s60 offen offset:2048 lds
    s_add_u32 s60, s60, s0
    v_mfma_f32_16x16x32_bf16 v[248:251], a[104:107], a[84:87], v[248:251]
    v_mfma_f32_16x16x32_bf16 v[244:247], a[100:103], a[84:87], v[244:247]
    v_mfma_f32_16x16x32_bf16 v[240:243], a[96:99], a[84:87], v[240:243]
    v_mfma_f32_16x16x32_bf16 v[236:239], a[92:95], a[84:87], v[236:239]
    v_mfma_f32_16x16x32_bf16 v[232:235], a[88:91], a[84:87], v[232:235]
    buffer_store_dword v2, v1, s[20:23], s3 offen sc1
    s_waitcnt vmcnt(9) lgkmcnt(0)
    s_barrier
    v_mfma_f32_16x16x32_bf16 v[64:67], a[32:35], a[0:3], v[64:67]
    s_and_b32 s3, s2, 1
    ds_read_b128 a[56:59], v14 offset:16384
    s_add_u32 m0, s63, 98304
    v_mfma_f32_16x16x32_bf16 v[68:71], a[36:39], a[0:3], v[68:71]
    s_lshl_b32 s3, s3, 4
    v_mfma_f32_16x16x32_bf16 v[72:75], a[40:43], a[0:3], v[72:75]
    s_lshr_b32 s7, s2, 5
    ds_read_b64_tr_b16 a[88:89], v15 offset:24576
    v_mfma_f32_16x16x32_bf16 v[76:79], a[44:47], a[0:3], v[76:79]
    s_add_u32 s36, s3, s7
    v_mfma_f32_16x16x32_bf16 v[80:83], a[48:51], a[0:3], v[80:83]
    s_and_b32 s3, s2, 2
    buffer_load_dwordx4 v10, s[8:11], s61 offen offset:2048 lds
    ds_read_b64_tr_b16 a[90:91], v15 offset:25088
    v_mfma_f32_16x16x32_bf16 v[84:87], a[52:55], a[0:3], v[84:87]
    s_lshl_b32 s3, s3, 2
    v_mfma_f32_16x16x32_bf16 v[108:111], a[52:55], a[4:7], v[108:111]
    ds_read_b64_tr_b16 a[92:93], v15 offset:27648
    v_mfma_f32_16x16x32_bf16 v[104:107], a[48:51], a[4:7], v[104:107]
    s_add_u32 s36, s36, s3
    v_mfma_f32_16x16x32_bf16 v[100:103], a[44:47], a[4:7], v[100:103]
    ds_read_b64_tr_b16 a[94:95], v15 offset:28160
    v_mfma_f32_16x16x32_bf16 v[96:99], a[40:43], a[4:7], v[96:99]
    s_and_b32 s3, s2, 4
    buffer_load_dwordx4 v11, s[8:11], s61 offen offset:3072 lds
    s_bfe_u32 s59, s30, 0x4001c
    v_mfma_f32_16x16x32_bf16 v[92:95], a[36:39], a[4:7], v[92:95]
    s_lshl_b32 s59, s59, 7
    v_mfma_f32_16x16x32_bf16 v[88:91], a[32:35], a[4:7], v[88:91]
    s_add_u32 s61, s58, s59
    ds_read_b64_tr_b16 a[96:97], v16 offset:24576
    v_mfma_f32_16x16x32_bf16 v[112:115], a[32:35], a[8:11], v[112:115]
    s_bfe_u32 s7, s2, 0x20003
    v_mfma_f32_16x16x32_bf16 v[116:119], a[36:39], a[8:11], v[116:119]
    s_add_u32 m0, s62, 73728
    ds_read_b64_tr_b16 a[98:99], v16 offset:25088
    v_mfma_f32_16x16x32_bf16 v[120:123], a[40:43], a[8:11], v[120:123]
    s_add_u32 s37, s3, s7
    v_mfma_f32_16x16x32_bf16 v[124:127], a[44:47], a[8:11], v[124:127]
    s_and_b32 s3, s36, 1
    ds_read_b64_tr_b16 a[100:101], v16 offset:27648
    v_mfma_f32_16x16x32_bf16 v[128:131], a[48:51], a[8:11], v[128:131]
    v_mfma_f32_16x16x32_bf16 v[132:135], a[52:55], a[8:11], v[132:135]
    s_mul_i32 s69, s3, 27
    ds_read_b64_tr_b16 a[102:103], v16 offset:28160
    v_mfma_f32_16x16x32_bf16 v[156:159], a[52:55], a[12:15], v[156:159]
    buffer_load_dwordx4 v4, s[12:15], s60 offen lds
    v_mfma_f32_16x16x32_bf16 v[152:155], a[48:51], a[12:15], v[152:155]
    s_mul_i32 s7, s4, 7
    ds_read_b64_tr_b16 a[104:105], v17 offset:24576
    v_mfma_f32_16x16x32_bf16 v[148:151], a[44:47], a[12:15], v[148:151]
    v_mfma_f32_16x16x32_bf16 v[144:147], a[40:43], a[12:15], v[144:147]
    s_add_u32 s7, s7, 20
    v_mfma_f32_16x16x32_bf16 v[140:143], a[36:39], a[12:15], v[140:143]
    ds_read_b64_tr_b16 a[106:107], v17 offset:25088
    v_mfma_f32_16x16x32_bf16 v[136:139], a[32:35], a[12:15], v[136:139]
    s_add_u32 s48, s7, s69
    buffer_load_dwordx4 v5, s[12:15], s60 offen offset:1024 lds
    v_mfma_f32_16x16x32_bf16 v[160:163], a[32:35], a[16:19], v[160:163]
    s_sub_u32 s49, s7, s69
    ds_read_b64_tr_b16 a[108:109], v17 offset:27648
    v_mfma_f32_16x16x32_bf16 v[164:167], a[36:39], a[16:19], v[164:167]
    v_mfma_f32_16x16x32_bf16 v[168:171], a[40:43], a[16:19], v[168:171]
    s_add_u32 s49, s49, 27
    ds_read_b64_tr_b16 a[110:111], v17 offset:28160
    v_mfma_f32_16x16x32_bf16 v[172:175], a[44:47], a[16:19], v[172:175]
    v_mfma_f32_16x16x32_bf16 v[176:179], a[48:51], a[16:19], v[176:179]
    s_mul_i32 s57, s4, 5
    buffer_load_dwordx4 v6, s[12:15], s60 offen offset:2048 lds
    s_add_u32 m0, s43, 73728
    v_mfma_f32_16x16x32_bf16 v[180:183], a[52:55], a[16:19], v[180:183]
    ds_read_b128 a[60:63], v14 offset:18432
    v_mfma_f32_16x16x32_bf16 v[204:207], a[52:55], a[20:23], v[204:207]
    s_mul_i32 s7, s37, 5120
    ds_read_b128 a[64:67], v14 offset:20480
    v_mfma_f32_16x16x32_bf16 v[200:203], a[48:51], a[20:23], v[200:203]
    v_mfma_f32_16x16x32_bf16 v[196:199], a[44:47], a[20:23], v[196:199]
    s_add_u32 s7, s7, 16773120
    v_mfma_f32_16x16x32_bf16 v[192:195], a[40:43], a[20:23], v[192:195]
    buffer_load_dwordx4 v4, s[16:19], s60 offen lds
    ds_read_b128 a[68:71], v14 offset:22528
    v_mfma_f32_16x16x32_bf16 v[188:191], a[36:39], a[20:23], v[188:191]
    s_mul_i32 s69, s48, 40960
    v_mfma_f32_16x16x32_bf16 v[184:187], a[32:35], a[20:23], v[184:187]
    ds_read_b128 a[72:75], v12 offset:24576
    v_mfma_f32_16x16x32_bf16 v[208:211], a[32:35], a[24:27], v[208:211]
    s_add_u32 s38, s69, s7
    v_mfma_f32_16x16x32_bf16 v[212:215], a[36:39], a[24:27], v[212:215]
    ds_read_b128 a[76:79], v12 offset:26624
    v_mfma_f32_16x16x32_bf16 v[216:219], a[40:43], a[24:27], v[216:219]
    s_mul_i32 s69, s49, 40960
    buffer_load_dwordx4 v5, s[16:19], s60 offen offset:1024 lds
    v_mfma_f32_16x16x32_bf16 v[220:223], a[44:47], a[24:27], v[220:223]
    ds_read_b128 a[80:83], v12 offset:28672
    v_mfma_f32_16x16x32_bf16 v[224:227], a[48:51], a[24:27], v[224:227]
    s_add_u32 s39, s69, s7
    v_mfma_f32_16x16x32_bf16 v[228:231], a[52:55], a[24:27], v[228:231]
    ds_read_b128 a[84:87], v12 offset:30720
    v_mfma_f32_16x16x32_bf16 v[252:255], a[52:55], a[28:31], v[252:255]
    s_mul_i32 s69, s57, 40960
    v_mfma_f32_16x16x32_bf16 v[248:251], a[48:51], a[28:31], v[248:251]
    buffer_load_dwordx4 v6, s[16:19], s60 offen offset:2048 lds
    s_bfe_u32 s59, s30, 0x40018
    v_mfma_f32_16x16x32_bf16 v[244:247], a[44:47], a[28:31], v[244:247]
    s_mul_i32 s59, s59, 221184
    s_add_u32 s60, s56, s59
    v_mfma_f32_16x16x32_bf16 v[240:243], a[40:43], a[28:31], v[240:243]
    v_mfma_f32_16x16x32_bf16 v[236:239], a[36:39], a[28:31], v[236:239]
    v_mfma_f32_16x16x32_bf16 v[232:235], a[32:35], a[28:31], v[232:235]
    s_waitcnt vmcnt(9) lgkmcnt(0)
    s_barrier
    v_mfma_f32_16x16x32_bf16 v[64:67], a[88:91], a[56:59], v[64:67]
    s_add_u32 s40, s69, s7
    ds_read_b128 a[0:3], v13 offset:32768
    s_add_u32 m0, s63, 114688
    v_mfma_f32_16x16x32_bf16 v[68:71], a[92:95], a[56:59], v[68:71]
    s_mul_i32 s7, s36, 296
    v_mfma_f32_16x16x32_bf16 v[72:75], a[96:99], a[56:59], v[72:75]
L_isl_gu_2:
    s_cbranch_execz L_isl_gu_6
    s_add_u32 s7, s7, s48
    ds_read_b64_tr_b16 a[32:33], v18 offset:0
    v_mfma_f32_16x16x32_bf16 v[76:79], a[100:103], a[56:59], v[76:79]
    s_lshl_b32 s7, s7, 10
    buffer_load_dwordx4 v8, s[8:11], s61 offen lds
    v_mfma_f32_16x16x32_bf16 v[80:83], a[104:107], a[56:59], v[80:83]
    s_add_u32 s7, s7, 1048576
    ds_read_b64_tr_b16 a[34:35], v18 offset:512
    v_mfma_f32_16x16x32_bf16 v[84:87], a[108:111], a[56:59], v[84:87]
    s_add_u32 s69, s4, 0
    v_mfma_f32_16x16x32_bf16 v[108:111], a[108:111], a[60:63], v[108:111]
    ds_read_b64_tr_b16 a[36:37], v18 offset:3072
    v_mfma_f32_16x16x32_bf16 v[104:107], a[104:107], a[60:63], v[104:107]
    s_and_b32 s69, s69, 3
    v_mfma_f32_16x16x32_bf16 v[100:103], a[100:103], a[60:63], v[100:103]
    buffer_load_dwordx4 v9, s[8:11], s61 offen offset:1024 lds
    ds_read_b64_tr_b16 a[38:39], v18 offset:3584
    v_mfma_f32_16x16x32_bf16 v[96:99], a[96:99], a[60:63], v[96:99]
    s_add_u32 m0, s62, 0
    v_mfma_f32_16x16x32_bf16 v[92:95], a[92:95], a[60:63], v[92:95]
    s_mul_i32 s69, s69, 75776
    v_mfma_f32_16x16x32_bf16 v[88:91], a[88:91], a[60:63], v[88:91]
    s_add_u32 s44, s69, s7
    ds_read_b64_tr_b16 a[40:41], v19 offset:0
    v_mfma_f32_16x16x32_bf16 v[112:115], a[88:91], a[64:67], v[112:115]
    s_add_u32 s69, s4, 1
    v_mfma_f32_16x16x32_bf16 v[116:119], a[92:95], a[64:67], v[116:119]
    ds_read_b64_tr_b16 a[42:43], v19 offset:512
    v_mfma_f32_16x16x32_bf16 v[120:123], a[96:99], a[64:67], v[120:123]
    s_and_b32 s69, s69, 3
    v_mfma_f32_16x16x32_bf16 v[124:127], a[100:103], a[64:67], v[124:127]
    buffer_load_dwordx4 v4, s[12:15], s60 offen lds
    ds_read_b64_tr_b16 a[44:45], v19 offset:3072
    v_mfma_f32_16x16x32_bf16 v[128:131], a[104:107], a[64:67], v[128:131]
    s_mul_i32 s69, s69, 75776
    v_mfma_f32_16x16x32_bf16 v[132:135], a[108:111], a[64:67], v[132:135]
    ds_read_b64_tr_b16 a[46:47], v19 offset:3584
    v_mfma_f32_16x16x32_bf16 v[156:159], a[108:111], a[68:71], v[156:159]
    s_add_u32 s45, s69, s7
    v_mfma_f32_16x16x32_bf16 v[152:155], a[104:107], a[68:71], v[152:155]
    ds_read_b64_tr_b16 a[48:49], v20 offset:0
    v_mfma_f32_16x16x32_bf16 v[148:151], a[100:103], a[68:71], v[148:151]
    s_add_u32 s69, s4, 2
    buffer_load_dwordx4 v5, s[12:15], s60 offen offset:1024 lds
    v_mfma_f32_16x16x32_bf16 v[144:147], a[96:99], a[68:71], v[144:147]
    v_mfma_f32_16x16x32_bf16 v[140:143], a[92:95], a[68:71], v[140:143]
    s_and_b32 s69, s69, 3
    ds_read_b64_tr_b16 a[50:51], v20 offset:512
    v_mfma_f32_16x16x32_bf16 v[136:139], a[88:91], a[68:71], v[136:139]
    v_mfma_f32_16x16x32_bf16 v[160:163], a[88:91], a[72:75], v[160:163]
    s_mul_i32 s69, s69, 75776
    ds_read_b64_tr_b16 a[52:53], v20 offset:3072
    v_mfma_f32_16x16x32_bf16 v[164:167], a[92:95], a[72:75], v[164:167]
    s_add_u32 s46, s69, s7
    buffer_load_dwordx4 v6, s[12:15], s60 offen offset:2048 lds
    v_mfma_f32_16x16x32_bf16 v[168:171], a[96:99], a[72:75], v[168:171]
    s_add_u32 m0, s43, 0
    ds_read_b64_tr_b16 a[54:55], v20 offset:3584
    v_mfma_f32_16x16x32_bf16 v[172:175], a[100:103], a[72:75], v[172:175]
    s_add_u32 s69, s4, 3
    v_mfma_f32_16x16x32_bf16 v[176:179], a[104:107], a[72:75], v[176:179]
    ds_read_b128 a[4:7], v13 offset:34816
    v_mfma_f32_16x16x32_bf16 v[180:183], a[108:111], a[72:75], v[180:183]
    s_and_b32 s69, s69, 3
    v_mfma_f32_16x16x32_bf16 v[204:207], a[108:111], a[76:79], v[204:207]
    buffer_load_dwordx4 v4, s[16:19], s60 offen lds
    ds_read_b128 a[8:11], v13 offset:36864
    v_mfma_f32_16x16x32_bf16 v[200:203], a[104:107], a[76:79], v[200:203]
    s_mul_i32 s69, s69, 75776
    v_mfma_f32_16x16x32_bf16 v[196:199], a[100:103], a[76:79], v[196:199]
    v_mfma_f32_16x16x32_bf16 v[192:195], a[96:99], a[76:79], v[192:195]
    s_add_u32 s47, s69, s7
    ds_read_b128 a[12:15], v13 offset:38912
    v_mfma_f32_16x16x32_bf16 v[188:191], a[92:95], a[76:79], v[188:191]
    v_mfma_f32_16x16x32_bf16 v[184:187], a[88:91], a[76:79], v[184:187]
    s_sub_u32 s57, s57, s49
    buffer_load_dwordx4 v5, s[16:19], s60 offen offset:1024 lds
    ds_read_b128 a[16:19], v7 offset:40960
    v_mfma_f32_16x16x32_bf16 v[208:211], a[88:91], a[80:83], v[208:211]
    s_sub_u32 s48, s49, s48
    v_mfma_f32_16x16x32_bf16 v[212:215], a[92:95], a[80:83], v[212:215]
    ds_read_b128 a[20:23], v7 offset:43008
    v_mfma_f32_16x16x32_bf16 v[216:219], a[96:99], a[80:83], v[216:219]
    s_cmp_eq_u32 s4, 3
    s_cselect_b32 s41, 1, 0
    v_mfma_f32_16x16x32_bf16 v[220:223], a[100:103], a[80:83], v[220:223]
    ds_read_b128 a[24:27], v7 offset:45056
    v_mfma_f32_16x16x32_bf16 v[224:227], a[104:107], a[80:83], v[224:227]
    buffer_load_dwordx4 v6, s[16:19], s60 offen offset:2048 lds
    v_mfma_f32_16x16x32_bf16 v[228:231], a[108:111], a[80:83], v[228:231]
    s_add_u32 s60, s60, s0
    ds_read_b128 a[28:31], v7 offset:47104
    v_mfma_f32_16x16x32_bf16 v[252:255], a[108:111], a[84:87], v[252:255]
    s_add_u32 s48, s48, s41
    v_mfma_f32_16x16x32_bf16 v[248:251], a[104:107], a[84:87], v[248:251]
    v_mfma_f32_16x16x32_bf16 v[244:247], a[100:103], a[84:87], v[244:247]
    v_mfma_f32_16x16x32_bf16 v[240:243], a[96:99], a[84:87], v[240:243]
    v_mfma_f32_16x16x32_bf16 v[236:239], a[92:95], a[84:87], v[236:239]
    v_mfma_f32_16x16x32_bf16 v[232:235], a[88:91], a[84:87], v[232:235]
    s_waitcnt vmcnt(8) lgkmcnt(0)
    s_barrier
    v_mfma_f32_16x16x32_bf16 v[64:67], a[32:35], a[0:3], v[64:67]
    s_add_u32 m0, s63, 114688
    s_mul_i32 s48, s48, 1024
    ds_read_b128 a[56:59], v14 offset:32768
    v_mfma_f32_16x16x32_bf16 v[68:71], a[36:39], a[0:3], v[68:71]
    s_sub_u32 s48, s48, 4096
    buffer_load_dwordx4 v10, s[8:11], s61 offen offset:2048 lds
    v_mfma_f32_16x16x32_bf16 v[72:75], a[40:43], a[0:3], v[72:75]
    s_add_u32 s49, s57, s41
    ds_read_b64_tr_b16 a[88:89], v18 offset:24576
    v_mfma_f32_16x16x32_bf16 v[76:79], a[44:47], a[0:3], v[76:79]
    s_mul_i32 s49, s49, 1024
    v_mfma_f32_16x16x32_bf16 v[80:83], a[48:51], a[0:3], v[80:83]
    s_sub_u32 s49, s49, 4096
    buffer_load_dwordx4 v11, s[8:11], s61 offen offset:3072 lds
    ds_read_b64_tr_b16 a[90:91], v18 offset:25088
    v_mfma_f32_16x16x32_bf16 v[84:87], a[52:55], a[0:3], v[84:87]
    s_bfe_u32 s59, s31, 0x40000
    v_mfma_f32_16x16x32_bf16 v[108:111], a[52:55], a[4:7], v[108:111]
    s_lshl_b32 s59, s59, 7
    ds_read_b64_tr_b16 a[92:93], v18 offset:27648
    v_mfma_f32_16x16x32_bf16 v[104:107], a[48:51], a[4:7], v[104:107]
    s_lshl_b32 s41, s41, 10
    v_mfma_f32_16x16x32_bf16 v[100:103], a[44:47], a[4:7], v[100:103]
    s_add_u32 s61, s58, s59
    ds_read_b64_tr_b16 a[94:95], v18 offset:28160
    v_mfma_f32_16x16x32_bf16 v[96:99], a[40:43], a[4:7], v[96:99]
    s_lshr_b32 s7, s36, 1
    v_mfma_f32_16x16x32_bf16 v[92:95], a[36:39], a[4:7], v[92:95]
    s_add_u32 m0, s62, 24576
    v_mfma_f32_16x16x32_bf16 v[88:91], a[32:35], a[4:7], v[88:91]
    s_mul_i32 s7, s7, 9
    ds_read_b64_tr_b16 a[96:97], v19 offset:24576
    v_mfma_f32_16x16x32_bf16 v[112:115], a[32:35], a[8:11], v[112:115]
    s_mul_i32 s69, s4, 602
    buffer_load_dwordx4 v4, s[12:15], s60 offen lds
    v_mfma_f32_16x16x32_bf16 v[116:119], a[36:39], a[8:11], v[116:119]
    s_lshr_b32 s69, s69, 8
    ds_read_b64_tr_b16 a[98:99], v19 offset:25088
    v_mfma_f32_16x16x32_bf16 v[120:123], a[40:43], a[8:11], v[120:123]
    s_add_u32 s7, s7, s69
    v_mfma_f32_16x16x32_bf16 v[124:127], a[44:47], a[8:11], v[124:127]
    s_lshl_b32 s7, s7, 8
    buffer_load_dwordx4 v5, s[12:15], s60 offen offset:1024 lds
    ds_read_b64_tr_b16 a[100:101], v19 offset:27648
    v_mfma_f32_16x16x32_bf16 v[128:131], a[48:51], a[8:11], v[128:131]
    s_add_u32 s52, s7, 23068672
    v_mfma_f32_16x16x32_bf16 v[132:135], a[52:55], a[8:11], v[132:135]
    ds_read_b64_tr_b16 a[102:103], v19 offset:28160
    v_mfma_f32_16x16x32_bf16 v[156:159], a[52:55], a[12:15], v[156:159]
    s_add_u32 s53, s52, 128
    buffer_load_dwordx4 v6, s[12:15], s60 offen offset:2048 lds
    s_add_u32 m0, s43, 24576
    v_mfma_f32_16x16x32_bf16 v[152:155], a[48:51], a[12:15], v[152:155]
    s_lshl_b32 s54, s36, 6
    ds_read_b64_tr_b16 a[104:105], v20 offset:24576
    v_mfma_f32_16x16x32_bf16 v[148:151], a[44:47], a[12:15], v[148:151]
    v_mfma_f32_16x16x32_bf16 v[144:147], a[40:43], a[12:15], v[144:147]
    s_add_u32 s55, s54, 63
    buffer_load_dwordx4 v4, s[16:19], s60 offen lds
    v_mfma_f32_16x16x32_bf16 v[140:143], a[36:39], a[12:15], v[140:143]
    ds_read_b64_tr_b16 a[106:107], v20 offset:25088
    v_mfma_f32_16x16x32_bf16 v[136:139], a[32:35], a[12:15], v[136:139]
    s_max_u32 s54, s54, 14
    v_mfma_f32_16x16x32_bf16 v[160:163], a[32:35], a[16:19], v[160:163]
    s_sub_u32 s54, s54, 14
    buffer_load_dwordx4 v5, s[16:19], s60 offen offset:1024 lds
    ds_read_b64_tr_b16 a[108:109], v20 offset:27648
    v_mfma_f32_16x16x32_bf16 v[164:167], a[36:39], a[16:19], v[164:167]
    v_mfma_f32_16x16x32_bf16 v[168:171], a[40:43], a[16:19], v[168:171]
    s_mul_i32 s54, s54, 449
    ds_read_b64_tr_b16 a[110:111], v20 offset:28160
    v_mfma_f32_16x16x32_bf16 v[172:175], a[44:47], a[16:19], v[172:175]
    buffer_load_dwordx4 v6, s[16:19], s60 offen offset:2048 lds
    s_bfe_u32 s59, s30, 0x4001c
    v_mfma_f32_16x16x32_bf16 v[176:179], a[48:51], a[16:19], v[176:179]
    s_mul_i32 s59, s59, 221184
    s_add_u32 s60, s56, s59
    ds_read_b128 a[60:63], v14 offset:34816
    v_mfma_f32_16x16x32_bf16 v[180:183], a[52:55], a[16:19], v[180:183]
    s_add_u32 m0, s62, 49152
    v_mfma_f32_16x16x32_bf16 v[204:207], a[52:55], a[20:23], v[204:207]
    s_lshr_b32 s54, s54, 16
    ds_read_b128 a[64:67], v14 offset:36864
    v_mfma_f32_16x16x32_bf16 v[200:203], a[48:51], a[20:23], v[200:203]
    s_max_u32 s55, s55, 14
    buffer_load_dwordx4 v4, s[12:15], s60 offen lds
    v_mfma_f32_16x16x32_bf16 v[196:199], a[44:47], a[20:23], v[196:199]
    s_sub_u32 s55, s55, 14
    v_mfma_f32_16x16x32_bf16 v[192:195], a[40:43], a[20:23], v[192:195]
    s_mul_i32 s55, s55, 449
    ds_read_b128 a[68:71], v14 offset:38912
    v_mfma_f32_16x16x32_bf16 v[188:191], a[36:39], a[20:23], v[188:191]
    s_lshr_b32 s55, s55, 16
    buffer_load_dwordx4 v5, s[12:15], s60 offen offset:1024 lds
    v_mfma_f32_16x16x32_bf16 v[184:187], a[32:35], a[20:23], v[184:187]
    ds_read_b128 a[72:75], v12 offset:40960
    v_mfma_f32_16x16x32_bf16 v[208:211], a[32:35], a[24:27], v[208:211]
    s_cmp_eq_u32 s54, s55
    s_cselect_b32 s55, 7, 15
    v_mfma_f32_16x16x32_bf16 v[212:215], a[36:39], a[24:27], v[212:215]
    buffer_load_dwordx4 v6, s[12:15], s60 offen offset:2048 lds
    s_add_u32 m0, s43, 49152
    v_mfma_f32_16x16x32_bf16 v[216:219], a[40:43], a[24:27], v[216:219]
    ds_read_b128 a[76:79], v12 offset:43008
    v_mfma_f32_16x16x32_bf16 v[220:223], a[44:47], a[24:27], v[220:223]
    s_lshl_b32 s54, s54, 11
    ds_read_b128 a[80:83], v12 offset:45056
    v_mfma_f32_16x16x32_bf16 v[224:227], a[48:51], a[24:27], v[224:227]
    buffer_load_dwordx4 v4, s[16:19], s60 offen lds
    v_mfma_f32_16x16x32_bf16 v[228:231], a[52:55], a[24:27], v[228:231]
    s_add_u32 s54, s54, 23105664
    ds_read_b128 a[84:87], v12 offset:47104
    v_mfma_f32_16x16x32_bf16 v[252:255], a[52:55], a[28:31], v[252:255]
    v_mfma_f32_16x16x32_bf16 v[248:251], a[48:51], a[28:31], v[248:251]
    buffer_load_dwordx4 v5, s[16:19], s60 offen offset:1024 lds
    v_mfma_f32_16x16x32_bf16 v[244:247], a[44:47], a[28:31], v[244:247]
    buffer_load_dwordx4 v6, s[16:19], s60 offen offset:2048 lds
    s_add_u32 s60, s60, s0
    v_mfma_f32_16x16x32_bf16 v[240:243], a[40:43], a[28:31], v[240:243]
    v_mfma_f32_16x16x32_bf16 v[236:239], a[36:39], a[28:31], v[236:239]
    v_mfma_f32_16x16x32_bf16 v[232:235], a[32:35], a[28:31], v[232:235]
    buffer_load_dword v47, v46, s[20:23], 0 offen sc1
    s_bitcmp0_b32 s101, 10
    s_cbranch_scc1 L_nocs_gu_10
    v_mfma_f32_16x16x32_bf16 a[176:179], a[200:203], a[32:35], a[176:179]
    v_mfma_f32_16x16x32_bf16 a[180:183], a[200:203], a[36:39], a[180:183]
    v_mfma_f32_16x16x32_bf16 a[184:187], a[200:203], a[40:43], a[184:187]
    v_mfma_f32_16x16x32_bf16 a[188:191], a[200:203], a[44:47], a[188:191]
    v_mfma_f32_16x16x32_bf16 a[192:195], a[200:203], a[48:51], a[192:195]
    v_mfma_f32_16x16x32_bf16 a[196:199], a[200:203], a[52:55], a[196:199]
L_nocs_gu_10:
    s_waitcnt vmcnt(15) lgkmcnt(0)
    s_barrier
    v_mfma_f32_16x16x32_bf16 v[64:67], a[88:91], a[56:59], v[64:67]
    s_add_u32 m0, s62, 73728
    ds_read_b128 a[0:3], v13 offset:0
    v_mfma_f32_16x16x32_bf16 v[68:71], a[92:95], a[56:59], v[68:71]
    v_mfma_f32_16x16x32_bf16 v[72:75], a[96:99], a[56:59], v[72:75]
    ds_read_b64_tr_b16 a[32:33], v15 offset:0
    v_mfma_f32_16x16x32_bf16 v[76:79], a[100:103], a[56:59], v[76:79]
    v_mfma_f32_16x16x32_bf16 v[80:83], a[104:107], a[56:59], v[80:83]
    buffer_load_dwordx4 v4, s[12:15], s60 offen lds
    ds_read_b64_tr_b16 a[34:35], v15 offset:512
    v_mfma_f32_16x16x32_bf16 v[84:87], a[108:111], a[56:59], v[84:87]
    v_mfma_f32_16x16x32_bf16 v[108:111], a[108:111], a[60:63], v[108:111]
    ds_read_b64_tr_b16 a[36:37], v15 offset:3072
    v_mfma_f32_16x16x32_bf16 v[104:107], a[104:107], a[60:63], v[104:107]
    v_mfma_f32_16x16x32_bf16 v[100:103], a[100:103], a[60:63], v[100:103]
    ds_read_b64_tr_b16 a[38:39], v15 offset:3584
    v_mfma_f32_16x16x32_bf16 v[96:99], a[96:99], a[60:63], v[96:99]
    buffer_load_dwordx4 v5, s[12:15], s60 offen offset:1024 lds
    v_mfma_f32_16x16x32_bf16 v[92:95], a[92:95], a[60:63], v[92:95]
    v_mfma_f32_16x16x32_bf16 v[88:91], a[88:91], a[60:63], v[88:91]
    ds_read_b64_tr_b16 a[40:41], v16 offset:0
    v_mfma_f32_16x16x32_bf16 v[112:115], a[88:91], a[64:67], v[112:115]
    v_mfma_f32_16x16x32_bf16 v[116:119], a[92:95], a[64:67], v[116:119]
    ds_read_b64_tr_b16 a[42:43], v16 offset:512
    v_mfma_f32_16x16x32_bf16 v[120:123], a[96:99], a[64:67], v[120:123]
    buffer_load_dwordx4 v6, s[12:15], s60 offen offset:2048 lds
    s_add_u32 m0, s43, 73728
    v_mfma_f32_16x16x32_bf16 v[124:127], a[100:103], a[64:67], v[124:127]
    ds_read_b64_tr_b16 a[44:45], v16 offset:3072
    v_mfma_f32_16x16x32_bf16 v[128:131], a[104:107], a[64:67], v[128:131]
    v_mfma_f32_16x16x32_bf16 v[132:135], a[108:111], a[64:67], v[132:135]
    ds_read_b64_tr_b16 a[46:47], v16 offset:3584
    v_mfma_f32_16x16x32_bf16 v[156:159], a[108:111], a[68:71], v[156:159]
    v_mfma_f32_16x16x32_bf16 v[152:155], a[104:107], a[68:71], v[152:155]
    buffer_load_dwordx4 v4, s[16:19], s60 offen lds
    ds_read_b64_tr_b16 a[48:49], v17 offset:0
    v_mfma_f32_16x16x32_bf16 v[148:151], a[100:103], a[68:71], v[148:151]
    v_mfma_f32_16x16x32_bf16 v[144:147], a[96:99], a[68:71], v[144:147]
    v_mfma_f32_16x16x32_bf16 v[140:143], a[92:95], a[68:71], v[140:143]
    ds_read_b64_tr_b16 a[50:51], v17 offset:512
    v_mfma_f32_16x16x32_bf16 v[136:139], a[88:91], a[68:71], v[136:139]
    v_mfma_f32_16x16x32_bf16 v[160:163], a[88:91], a[72:75], v[160:163]
    buffer_load_dwordx4 v5, s[16:19], s60 offen offset:1024 lds
    ds_read_b64_tr_b16 a[52:53], v17 offset:3072
    v_mfma_f32_16x16x32_bf16 v[164:167], a[92:95], a[72:75], v[164:167]
    v_mfma_f32_16x16x32_bf16 v[168:171], a[96:99], a[72:75], v[168:171]
    ds_read_b64_tr_b16 a[54:55], v17 offset:3584
    v_mfma_f32_16x16x32_bf16 v[172:175], a[100:103], a[72:75], v[172:175]
    v_mfma_f32_16x16x32_bf16 v[176:179], a[104:107], a[72:75], v[176:179]
    ds_read_b128 a[4:7], v13 offset:2048
    v_mfma_f32_16x16x32_bf16 v[180:183], a[108:111], a[72:75], v[180:183]
    buffer_load_dwordx4 v6, s[16:19], s60 offen offset:2048 lds
    s_bfe_u32 s59, s31, 0x40000
    v_mfma_f32_16x16x32_bf16 v[204:207], a[108:111], a[76:79], v[204:207]
    s_mul_i32 s59, s59, 221184
    ds_read_b128 a[8:11], v13 offset:4096
    v_mfma_f32_16x16x32_bf16 v[200:203], a[104:107], a[76:79], v[200:203]
    s_add_u32 s60, s56, s59
    v_mfma_f32_16x16x32_bf16 v[196:199], a[100:103], a[76:79], v[196:199]
    s_add_u32 m0, s63, 131072
    v_mfma_f32_16x16x32_bf16 v[192:195], a[96:99], a[76:79], v[192:195]
    ds_read_b128 a[12:15], v13 offset:6144
    v_mfma_f32_16x16x32_bf16 v[188:191], a[92:95], a[76:79], v[188:191]
    v_mfma_f32_16x16x32_bf16 v[184:187], a[88:91], a[76:79], v[184:187]
    ds_read_b128 a[16:19], v7 offset:8192
    v_mfma_f32_16x16x32_bf16 v[208:211], a[88:91], a[80:83], v[208:211]
    v_mfma_f32_16x16x32_bf16 v[212:215], a[92:95], a[80:83], v[212:215]
    ds_read_b128 a[20:23], v7 offset:10240
    v_mfma_f32_16x16x32_bf16 v[216:219], a[96:99], a[80:83], v[216:219]
    buffer_load_dwordx4 v8, s[8:11], s61 offen lds
    v_mfma_f32_16x16x32_bf16 v[220:223], a[100:103], a[80:83], v[220:223]
    ds_read_b128 a[24:27], v7 offset:12288
    v_mfma_f32_16x16x32_bf16 v[224:227], a[104:107], a[80:83], v[224:227]
    v_mfma_f32_16x16x32_bf16 v[228:231], a[108:111], a[80:83], v[228:231]
    ds_read_b128 a[28:31], v7 offset:14336
    v_mfma_f32_16x16x32_bf16 v[252:255], a[108:111], a[84:87], v[252:255]
    v_mfma_f32_16x16x32_bf16 v[248:251], a[104:107], a[84:87], v[248:251]
    buffer_load_dwordx4 v9, s[8:11], s61 offen offset:1024 lds
    v_mfma_f32_16x16x32_bf16 v[244:247], a[100:103], a[84:87], v[244:247]
    v_mfma_f32_16x16x32_bf16 v[240:243], a[96:99], a[84:87], v[240:243]
    v_mfma_f32_16x16x32_bf16 v[236:239], a[92:95], a[84:87], v[236:239]
    v_mfma_f32_16x16x32_bf16 v[232:235], a[88:91], a[84:87], v[232:235]
    s_bitcmp0_b32 s101, 11
    s_cbranch_scc1 L_nocs_gu_11
    v_mfma_f32_16x16x32_bf16 a[176:179], a[200:203], a[88:91], a[176:179]
    v_mfma_f32_16x16x32_bf16 a[180:183], a[200:203], a[92:95], a[180:183]
    v_mfma_f32_16x16x32_bf16 a[184:187], a[200:203], a[96:99], a[184:187]
    v_mfma_f32_16x16x32_bf16 a[188:191], a[200:203], a[100:103], a[188:191]
    v_mfma_f32_16x16x32_bf16 a[192:195], a[200:203], a[104:107], a[192:195]
    v_mfma_f32_16x16x32_bf16 a[196:199], a[200:203], a[108:111], a[196:199]
L_nocs_gu_11:
    s_waitcnt vmcnt(8) lgkmcnt(0)
    s_barrier
    v_cmp_eq_u32_e64 vcc, 0, v47
    v_mfma_f32_16x16x32_bf16 v[64:67], a[32:35], a[0:3], v[64:67]
    ds_read_b128 a[56:59], v14 offset:0
    v_mfma_f32_16x16x32_bf16 v[68:71], a[36:39], a[0:3], v[68:71]
    s_cbranch_vccnz L_slow_s1gu
L_ok_s1gu:
    v_mfma_f32_16x16x32_bf16 v[72:75], a[40:43], a[0:3], v[72:75]
    s_mov_b32 s70, 0xffff0000
    ds_read_b64_tr_b16 a[88:89], v15 offset:24576
    s_add_u32 m0, s63, 131072
    v_mfma_f32_16x16x32_bf16 v[76:79], a[44:47], a[0:3], v[76:79]
    s_mov_b32 s71, 0xffff0000
    v_mfma_f32_16x16x32_bf16 v[80:83], a[48:51], a[0:3], v[80:83]
    s_mov_b32 s72, 0
    ds_read_b64_tr_b16 a[90:91], v15 offset:25088
    v_mfma_f32_16x16x32_bf16 v[84:87], a[52:55], a[0:3], v[84:87]
    s_mov_b32 s73, -1
    buffer_load_dwordx4 v10, s[8:11], s61 offen offset:2048 lds
    v_mfma_f32_16x16x32_bf16 v[108:111], a[52:55], a[4:7], v[108:111]
    ds_read_b64_tr_b16 a[92:93], v15 offset:27648
    v_mfma_f32_16x16x32_bf16 v[104:107], a[48:51], a[4:7], v[104:107]
    v_mfma_f32_16x16x32_bf16 v[100:103], a[44:47], a[4:7], v[100:103]
    v_accvgpr_read_b32 v48, a176
    ds_read_b64_tr_b16 a[94:95], v15 offset:28160
    v_mfma_f32_16x16x32_bf16 v[96:99], a[40:43], a[4:7], v[96:99]
    buffer_load_dwordx4 v11, s[8:11], s61 offen offset:3072 lds
    v_mfma_f32_16x16x32_bf16 v[92:95], a[36:39], a[4:7], v[92:95]
    s_bfe_u32 s59, s31, 0x40004
    v_accvgpr_read_b32 v49, a180
    v_mfma_f32_16x16x32_bf16 v[88:91], a[32:35], a[4:7], v[88:91]
    s_lshl_b32 s59, s59, 7
    ds_read_b64_tr_b16 a[96:97], v16 offset:24576
    v_mfma_f32_16x16x32_bf16 v[112:115], a[32:35], a[8:11], v[112:115]
    s_add_u32 s61, s58, s59
    v_accvgpr_read_b32 v50, a184
    v_mfma_f32_16x16x32_bf16 v[116:119], a[36:39], a[8:11], v[116:119]
    ds_read_b64_tr_b16 a[98:99], v16 offset:25088
    v_accvgpr_read_b32 v51, a188
    v_mfma_f32_16x16x32_bf16 v[120:123], a[40:43], a[8:11], v[120:123]
    s_add_u32 m0, s62, 0
    v_mfma_f32_16x16x32_bf16 v[124:127], a[44:47], a[8:11], v[124:127]
    v_accvgpr_read_b32 v52, a192
    ds_read_b64_tr_b16 a[100:101], v16 offset:27648
    v_mfma_f32_16x16x32_bf16 v[128:131], a[48:51], a[8:11], v[128:131]
    v_mfma_f32_16x16x32_bf16 v[132:135], a[52:55], a[8:11], v[132:135]
    v_accvgpr_read_b32 v53, a196
    ds_read_b64_tr_b16 a[102:103], v16 offset:28160
    v_mfma_f32_16x16x32_bf16 v[156:159], a[52:55], a[12:15], v[156:159]
    v_cndmask_b32 v48, v48, v49, s[70:71]
    v_mfma_f32_16x16x32_bf16 v[152:155], a[48:51], a[12:15], v[152:155]
    ds_read_b64_tr_b16 a[104:105], v17 offset:24576
    v_mfma_f32_16x16x32_bf16 v[148:151], a[44:47], a[12:15], v[148:151]
    v_cndmask_b32 v50, v50, v51, s[70:71]
    v_mfma_f32_16x16x32_bf16 v[144:147], a[40:43], a[12:15], v[144:147]
    v_mfma_f32_16x16x32_bf16 v[140:143], a[36:39], a[12:15], v[140:143]
    buffer_load_dwordx4 v4, s[12:15], s60 offen lds
    ds_read_b64_tr_b16 a[106:107], v17 offset:25088
    v_mfma_f32_16x16x32_bf16 v[136:139], a[32:35], a[12:15], v[136:139]
    v_cndmask_b32 v52, v52, v53, s[70:71]
    v_mfma_f32_16x16x32_bf16 v[160:163], a[32:35], a[16:19], v[160:163]
    v_cndmask_b32 v48, v48, v50, s[72:73]
    ds_read_b64_tr_b16 a[108:109], v17 offset:27648
    v_mfma_f32_16x16x32_bf16 v[164:167], a[36:39], a[16:19], v[164:167]
    v_cvt_pk_bf16_f32 v49, v48, v48
    v_mfma_f32_16x16x32_bf16 v[168:171], a[40:43], a[16:19], v[168:171]
    buffer_load_dwordx4 v5, s[12:15], s60 offen offset:1024 lds
    ds_read_b64_tr_b16 a[110:111], v17 offset:28160
    v_mfma_f32_16x16x32_bf16 v[172:175], a[44:47], a[16:19], v[172:175]
    v_lshlrev_b32_e64 v49, 16, v49
    v_mfma_f32_16x16x32_bf16 v[176:179], a[48:51], a[16:19], v[176:179]
    ds_read_b128 a[60:63], v14 offset:2048
    v_mfma_f32_16x16x32_bf16 v[180:183], a[52:55], a[16:19], v[180:183]
    v_sub_f32_e64 v49, v48, v49
    v_mfma_f32_16x16x32_bf16 v[204:207], a[52:55], a[20:23], v[204:207]
    buffer_load_dwordx4 v6, s[12:15], s60 offen offset:2048 lds
    ds_read_b128 a[64:67], v14 offset:4096
    v_mfma_f32_16x16x32_bf16 v[200:203], a[48:51], a[20:23], v[200:203]
    s_add_u32 m0, s43, 0
    v_cvt_pk_bf16_f32 v48, v48, v49
    v_mfma_f32_16x16x32_bf16 v[196:199], a[44:47], a[20:23], v[196:199]
    v_min_u32 v48, -2, v48
    v_mfma_f32_16x16x32_bf16 v[192:195], a[40:43], a[20:23], v[192:195]
    ds_read_b128 a[68:71], v14 offset:6144
    v_mfma_f32_16x16x32_bf16 v[188:191], a[36:39], a[20:23], v[188:191]
    buffer_load_dwordx4 v4, s[16:19], s60 offen lds
    v_mfma_f32_16x16x32_bf16 v[184:187], a[32:35], a[20:23], v[184:187]
    ds_read_b128 a[72:75], v12 offset:8192
    v_mfma_f32_16x16x32_bf16 v[208:211], a[32:35], a[24:27], v[208:211]
    v_mfma_f32_16x16x32_bf16 v[212:215], a[36:39], a[24:27], v[212:215]
    ds_read_b128 a[76:79], v12 offset:10240
    v_mfma_f32_16x16x32_bf16 v[216:219], a[40:43], a[24:27], v[216:219]
    buffer_store_dword v48, v44, s[20:23], 0 offen offset:0 sc1
    v_cvt_pk_bf16_f32 v53, v52, v52
    v_mfma_f32_16x16x32_bf16 v[220:223], a[44:47], a[24:27], v[220:223]
    v_lshlrev_b32 v53, 16, v53
    v_sub_f32 v53, v52, v53
    v_mfma_f32_16x16x32_bf16 v[224:227], a[48:51], a[24:27], v[224:227]
    ds_read_b128 a[80:83], v12 offset:12288
    v_mfma_f32_16x16x32_bf16 v[228:231], a[52:55], a[24:27], v[228:231]
    v_cvt_pk_bf16_f32 v52, v52, v53
    ds_read_b128 a[84:87], v12 offset:14336
    v_mfma_f32_16x16x32_bf16 v[252:255], a[52:55], a[28:31], v[252:255]
    buffer_load_dwordx4 v5, s[16:19], s60 offen offset:1024 lds
    v_min_u32_e64 v52, -2, v52
    v_mfma_f32_16x16x32_bf16 v[248:251], a[48:51], a[28:31], v[248:251]
    v_mfma_f32_16x16x32_bf16 v[244:247], a[44:47], a[28:31], v[244:247]
    buffer_load_dwordx4 v6, s[16:19], s60 offen offset:2048 lds
    s_add_u32 s60, s60, s0
    v_mfma_f32_16x16x32_bf16 v[240:243], a[40:43], a[28:31], v[240:243]
    v_mfma_f32_16x16x32_bf16 v[236:239], a[36:39], a[28:31], v[236:239]
    v_mfma_f32_16x16x32_bf16 v[232:235], a[32:35], a[28:31], v[232:235]
    buffer_store_dword v52, v45, s[20:23], 0 offen offset:2048 sc1
    global_load_dword v23, v22, s[28:29]
    s_waitcnt lgkmcnt(0)
    s_barrier
    v_mfma_f32_16x16x32_bf16 v[64:67], a[88:91], a[56:59], v[64:67]
    s_add_u32 m0, s62, 24576
    ds_read_b128 a[0:3], v13 offset:16384
    s_lshl_b32 s67, s5, 10
    v_mfma_f32_16x16x32_bf16 v[68:71], a[92:95], a[56:59], v[68:71]
    s_add_u32 s67, s67, 22017024
    buffer_load_dwordx4 v4, s[12:15], s60 offen lds
    v_mfma_f32_16x16x32_bf16 v[72:75], a[96:99], a[56:59], v[72:75]
    ds_read_b64_tr_b16 a[32:33], v18 offset:0
    v_mfma_f32_16x16x32_bf16 v[76:79], a[100:103], a[56:59], v[76:79]
    buffer_load_dwordx4 v5, s[12:15], s60 offen offset:1024 lds
    v_mfma_f32_16x16x32_bf16 v[80:83], a[104:107], a[56:59], v[80:83]
    ds_read_b64_tr_b16 a[34:35], v18 offset:512
    v_mfma_f32_16x16x32_bf16 v[84:87], a[108:111], a[56:59], v[84:87]
    buffer_load_dwordx4 v6, s[12:15], s60 offen offset:2048 lds
    v_mfma_f32_16x16x32_bf16 v[108:111], a[108:111], a[60:63], v[108:111]
    s_add_u32 m0, s43, 24576
    ds_read_b64_tr_b16 a[36:37], v18 offset:3072
    v_mfma_f32_16x16x32_bf16 v[104:107], a[104:107], a[60:63], v[104:107]
    v_mfma_f32_16x16x32_bf16 v[100:103], a[100:103], a[60:63], v[100:103]
    ds_read_b64_tr_b16 a[38:39], v18 offset:3584
    v_mfma_f32_16x16x32_bf16 v[96:99], a[96:99], a[60:63], v[96:99]
    buffer_load_dwordx4 v4, s[16:19], s60 offen lds
    v_mfma_f32_16x16x32_bf16 v[92:95], a[92:95], a[60:63], v[92:95]
    v_mfma_f32_16x16x32_bf16 v[88:91], a[88:91], a[60:63], v[88:91]
    buffer_load_dwordx4 v5, s[16:19], s60 offen offset:1024 lds
    ds_read_b64_tr_b16 a[40:41], v19 offset:0
    v_mfma_f32_16x16x32_bf16 v[112:115], a[88:91], a[64:67], v[112:115]
    v_mfma_f32_16x16x32_bf16 v[116:119], a[92:95], a[64:67], v[116:119]
    buffer_load_dwordx4 v6, s[16:19], s60 offen offset:2048 lds
    s_add_u32 m0, s79, 147456
    v_mfma_f32_16x16x32_bf16 v[120:123], a[96:99], a[64:67], v[120:123]
    s_add_u32 s3, s79, 147456
    ds_read_b64_tr_b16 a[42:43], v19 offset:512
    s_bfe_u32 s59, s31, 0x40004
    v_mfma_f32_16x16x32_bf16 v[124:127], a[100:103], a[64:67], v[124:127]
    s_mul_i32 s59, s59, 221184
    ds_read_b64_tr_b16 a[44:45], v19 offset:3072
    v_mfma_f32_16x16x32_bf16 v[128:131], a[104:107], a[64:67], v[128:131]
    s_add_u32 s60, s56, s59
    v_mfma_f32_16x16x32_bf16 v[132:135], a[108:111], a[64:67], v[132:135]
    buffer_load_dwordx4 v21, s[20:23], s67 offen offset:3072 sc1 lds
    ds_read_b64_tr_b16 a[46:47], v19 offset:3584
    v_mfma_f32_16x16x32_bf16 v[156:159], a[108:111], a[68:71], v[156:159]
    s_add_u32 m0, s63, 98304
    v_mfma_f32_16x16x32_bf16 v[152:155], a[104:107], a[68:71], v[152:155]
    ds_read_b64_tr_b16 a[48:49], v20 offset:0
    v_mfma_f32_16x16x32_bf16 v[148:151], a[100:103], a[68:71], v[148:151]
    v_mfma_f32_16x16x32_bf16 v[144:147], a[96:99], a[68:71], v[144:147]
    buffer_load_dwordx4 v8, s[8:11], s61 offen lds
    v_and_b32 v26, 15, v0
    v_mfma_f32_16x16x32_bf16 v[140:143], a[92:95], a[68:71], v[140:143]
    ds_read_b64_tr_b16 a[50:51], v20 offset:512
    v_mfma_f32_16x16x32_bf16 v[136:139], a[88:91], a[68:71], v[136:139]
    buffer_load_dwordx4 v9, s[8:11], s61 offen offset:1024 lds
    v_mfma_f32_16x16x32_bf16 v[160:163], a[88:91], a[72:75], v[160:163]
    s_add_u32 s78, s38, 4096
    ds_read_b64_tr_b16 a[52:53], v20 offset:3072
    v_mfma_f32_16x16x32_bf16 v[164:167], a[92:95], a[72:75], v[164:167]
    v_mfma_f32_16x16x32_bf16 v[168:171], a[96:99], a[72:75], v[168:171]
    ds_read_b64_tr_b16 a[54:55], v20 offset:3584
    v_lshl_add_u32 v26, v26, 3, s3
    v_mfma_f32_16x16x32_bf16 v[172:175], a[100:103], a[72:75], v[172:175]
    s_lshr_b32 s3, s4, 1
    buffer_load_dwordx4 a[144:147], v21, s[20:23], s78 offen sc1
    v_mfma_f32_16x16x32_bf16 v[176:179], a[104:107], a[72:75], v[176:179]
    s_lshl_b32 s3, s3, 9
    ds_read_b128 a[4:7], v13 offset:18432
    v_mfma_f32_16x16x32_bf16 v[180:183], a[108:111], a[72:75], v[180:183]
    buffer_load_dwordx4 a[148:151], v21, s[20:23], s78 offen offset:1024 sc1
    v_mfma_f32_16x16x32_bf16 v[204:207], a[108:111], a[76:79], v[204:207]
    ds_read_b128 a[8:11], v13 offset:20480
    v_mfma_f32_16x16x32_bf16 v[200:203], a[104:107], a[76:79], v[200:203]
    buffer_load_dwordx4 a[152:155], v21, s[20:23], s78 offen offset:2048 sc1
    v_mfma_f32_16x16x32_bf16 v[196:199], a[100:103], a[76:79], v[196:199]
    v_mfma_f32_16x16x32_bf16 v[192:195], a[96:99], a[76:79], v[192:195]
    buffer_load_dwordx4 a[156:159], v21, s[20:23], s78 offen offset:3072 sc1
    ds_read_b128 a[12:15], v13 offset:22528
    v_mfma_f32_16x16x32_bf16 v[188:191], a[92:95], a[76:79], v[188:191]
    s_add_u32 s78, s38, 8192
    v_mfma_f32_16x16x32_bf16 v[184:187], a[88:91], a[76:79], v[184:187]
    ds_read_b128 a[16:19], v7 offset:24576
    v_mfma_f32_16x16x32_bf16 v[208:211], a[88:91], a[80:83], v[208:211]
    buffer_load_dwordx4 a[160:163], v21, s[20:23], s78 offen sc1
    v_mfma_f32_16x16x32_bf16 v[212:215], a[92:95], a[80:83], v[212:215]
    s_add_u32 s78, s38, 44032
    ds_read_b128 a[20:23], v7 offset:26624
    v_mfma_f32_16x16x32_bf16 v[216:219], a[96:99], a[80:83], v[216:219]
    v_mfma_f32_16x16x32_bf16 v[220:223], a[100:103], a[80:83], v[220:223]
    buffer_load_dwordx4 a[164:167], v21, s[20:23], s78 offen offset:1024 sc1
    v_subrev_u32_e64 v27, s3, v26
    v_mfma_f32_16x16x32_bf16 v[224:227], a[104:107], a[80:83], v[224:227]
    ds_read_b128 a[24:27], v7 offset:28672
    v_mfma_f32_16x16x32_bf16 v[228:231], a[108:111], a[80:83], v[228:231]
    buffer_load_dwordx4 a[168:171], v21, s[20:23], s78 offen offset:2048 sc1
    ds_read_b128 a[28:31], v7 offset:30720
    v_mfma_f32_16x16x32_bf16 v[252:255], a[108:111], a[84:87], v[252:255]
    v_mfma_f32_16x16x32_bf16 v[248:251], a[104:107], a[84:87], v[248:251]
    buffer_load_dwordx4 a[172:175], v21, s[20:23], s78 offen offset:3072 sc1
    v_add_u32_e64 v26, s3, v26
    v_mfma_f32_16x16x32_bf16 v[244:247], a[100:103], a[84:87], v[244:247]
    v_mfma_f32_16x16x32_bf16 v[240:243], a[96:99], a[84:87], v[240:243]
    v_mfma_f32_16x16x32_bf16 v[236:239], a[92:95], a[84:87], v[236:239]
    v_mfma_f32_16x16x32_bf16 v[232:235], a[88:91], a[84:87], v[232:235]
    s_waitcnt vmcnt(30) lgkmcnt(0)
    s_barrier
    v_mfma_f32_16x16x32_bf16 v[64:67], a[32:35], a[0:3], v[64:67]
    s_add_u32 m0, s63, 98304
    ds_read_b128 a[56:59], v14 offset:16384
    s_waitcnt vmcnt(17)
    v_mfma_f32_16x16x32_bf16 v[68:71], a[36:39], a[0:3], v[68:71]
L_isl_gu_3:
    s_cbranch_execz L_warm_gu_0
    s_cmp_eq_u32 s4, 3
    s_cselect_b32 s3, 1073741824, 0
    s_cselect_b32 s7, 1, 2
    v_mfma_f32_16x16x32_bf16 v[72:75], a[40:43], a[0:3], v[72:75]
    buffer_load_dwordx4 v10, s[8:11], s61 offen offset:2048 lds
    ds_read_b64_tr_b16 a[88:89], v18 offset:24576
    v_mfma_f32_16x16x32_bf16 v[76:79], a[44:47], a[0:3], v[76:79]
    v_mfma_f32_16x16x32_bf16 v[80:83], a[48:51], a[0:3], v[80:83]
    ds_read_b64_tr_b16 a[90:91], v18 offset:25088
    v_mfma_f32_16x16x32_bf16 v[84:87], a[52:55], a[0:3], v[84:87]
    buffer_load_dwordx4 v11, s[8:11], s61 offen offset:3072 lds
    s_add_u32 m0, s62, 49152
    v_mfma_f32_16x16x32_bf16 v[108:111], a[52:55], a[4:7], v[108:111]
    ds_read_b64_tr_b16 a[92:93], v18 offset:27648
    v_mfma_f32_16x16x32_bf16 v[104:107], a[48:51], a[4:7], v[104:107]
    v_mfma_f32_16x16x32_bf16 v[100:103], a[44:47], a[4:7], v[100:103]
    buffer_load_dwordx4 v4, s[12:15], s60 offen lds
    ds_read_b64_tr_b16 a[94:95], v18 offset:28160
    v_mfma_f32_16x16x32_bf16 v[96:99], a[40:43], a[4:7], v[96:99]
    v_mfma_f32_16x16x32_bf16 v[92:95], a[36:39], a[4:7], v[92:95]
    v_mfma_f32_16x16x32_bf16 v[88:91], a[32:35], a[4:7], v[88:91]
    buffer_load_dwordx4 v5, s[12:15], s60 offen offset:1024 lds
    ds_read_b64_tr_b16 a[96:97], v19 offset:24576
    v_mfma_f32_16x16x32_bf16 v[112:115], a[32:35], a[8:11], v[112:115]
    v_mfma_f32_16x16x32_bf16 v[116:119], a[36:39], a[8:11], v[116:119]
    ds_read_b64_tr_b16 a[98:99], v19 offset:25088
    v_mfma_f32_16x16x32_bf16 v[120:123], a[40:43], a[8:11], v[120:123]
    buffer_load_dwordx4 v6, s[12:15], s60 offen offset:2048 lds
    s_add_u32 m0, s43, 49152
    v_mfma_f32_16x16x32_bf16 v[124:127], a[44:47], a[8:11], v[124:127]
    ds_read_b64_tr_b16 a[100:101], v19 offset:27648
    v_mfma_f32_16x16x32_bf16 v[128:131], a[48:51], a[8:11], v[128:131]
    v_mfma_f32_16x16x32_bf16 v[132:135], a[52:55], a[8:11], v[132:135]
    buffer_load_dwordx4 v4, s[16:19], s60 offen lds
    ds_read_b64_tr_b16 a[102:103], v19 offset:28160
    v_mfma_f32_16x16x32_bf16 v[156:159], a[52:55], a[12:15], v[156:159]
    v_mfma_f32_16x16x32_bf16 v[152:155], a[48:51], a[12:15], v[152:155]
    ds_read_b64_tr_b16 a[104:105], v20 offset:24576
    v_mfma_f32_16x16x32_bf16 v[148:151], a[44:47], a[12:15], v[148:151]
    buffer_load_dwordx4 v5, s[16:19], s60 offen offset:1024 lds
    v_mfma_f32_16x16x32_bf16 v[144:147], a[40:43], a[12:15], v[144:147]
    v_mfma_f32_16x16x32_bf16 v[140:143], a[36:39], a[12:15], v[140:143]
    ds_read_b64_tr_b16 a[106:107], v20 offset:25088
    v_mfma_f32_16x16x32_bf16 v[136:139], a[32:35], a[12:15], v[136:139]
    buffer_load_dwordx4 v6, s[16:19], s60 offen offset:2048 lds
    s_add_u32 s60, s60, s0
    v_mfma_f32_16x16x32_bf16 v[160:163], a[32:35], a[16:19], v[160:163]
    s_add_u32 s78, s38, 48128
    ds_read_b64_tr_b16 a[108:109], v20 offset:27648
    v_mfma_f32_16x16x32_bf16 v[164:167], a[36:39], a[16:19], v[164:167]
    v_mfma_f32_16x16x32_bf16 v[168:171], a[40:43], a[16:19], v[168:171]
    buffer_load_dwordx4 a[176:179], v21, s[20:23], s78 offen sc1
    ds_read_b64_tr_b16 a[110:111], v20 offset:28160
    v_mfma_f32_16x16x32_bf16 v[172:175], a[44:47], a[16:19], v[172:175]
    v_add_u32_e64 v22, s3, v21
    v_mfma_f32_16x16x32_bf16 v[176:179], a[48:51], a[16:19], v[176:179]
    ds_read_b128 a[60:63], v14 offset:18432
    v_mfma_f32_16x16x32_bf16 v[180:183], a[52:55], a[16:19], v[180:183]
    buffer_load_dwordx4 a[180:183], v21, s[20:23], s78 offen offset:1024 sc1
    s_add_u32 s78, s38, 83968
    v_mfma_f32_16x16x32_bf16 v[204:207], a[52:55], a[20:23], v[204:207]
    ds_read_b128 a[64:67], v14 offset:20480
    v_mfma_f32_16x16x32_bf16 v[200:203], a[48:51], a[20:23], v[200:203]
    v_mfma_f32_16x16x32_bf16 v[196:199], a[44:47], a[20:23], v[196:199]
    buffer_load_dwordx4 a[184:187], v21, s[20:23], s78 offen offset:2048 sc1
    v_mfma_f32_16x16x32_bf16 v[192:195], a[40:43], a[20:23], v[192:195]
    ds_read_b128 a[68:71], v14 offset:22528
    v_mfma_f32_16x16x32_bf16 v[188:191], a[36:39], a[20:23], v[188:191]
    v_min_u32_e64 v23, s7, v0
    v_mfma_f32_16x16x32_bf16 v[184:187], a[32:35], a[20:23], v[184:187]
    buffer_load_dwordx4 a[188:191], v21, s[20:23], s78 offen offset:3072 sc1
    s_add_u32 s78, s38, 88064
    v_mfma_f32_16x16x32_bf16 v[208:211], a[32:35], a[24:27], v[208:211]
    ds_read_b128 a[72:75], v12 offset:24576
    v_mfma_f32_16x16x32_bf16 v[212:215], a[36:39], a[24:27], v[212:215]
    ds_read_b128 a[76:79], v12 offset:26624
    v_mfma_f32_16x16x32_bf16 v[216:219], a[40:43], a[24:27], v[216:219]
    buffer_load_dwordx4 a[192:195], v21, s[20:23], s78 offen sc1
    v_mfma_f32_16x16x32_bf16 v[220:223], a[44:47], a[24:27], v[220:223]
    ds_read_b128 a[80:83], v12 offset:28672
    v_mfma_f32_16x16x32_bf16 v[224:227], a[48:51], a[24:27], v[224:227]
    v_mfma_f32_16x16x32_bf16 v[228:231], a[52:55], a[24:27], v[228:231]
    buffer_load_dwordx4 a[196:199], v21, s[20:23], s78 offen offset:1024 sc1
    v_lshlrev_b32_e64 v23, 8, v23
    v_mfma_f32_16x16x32_bf16 v[252:255], a[52:55], a[28:31], v[252:255]
    ds_read_b128 a[84:87], v12 offset:30720
    v_mfma_f32_16x16x32_bf16 v[248:251], a[48:51], a[28:31], v[248:251]
    v_mfma_f32_16x16x32_bf16 v[244:247], a[44:47], a[28:31], v[244:247]
    buffer_load_dwordx4 a[200:203], v21, s[20:23], s78 offen offset:2048 sc1
    s_add_u32 s78, s38, 123904
    buffer_load_dwordx4 a[204:207], v21, s[20:23], s78 offen offset:3072 sc1
    v_mfma_f32_16x16x32_bf16 v[240:243], a[40:43], a[28:31], v[240:243]
    v_mfma_f32_16x16x32_bf16 v[236:239], a[36:39], a[28:31], v[236:239]
    v_mfma_f32_16x16x32_bf16 v[232:235], a[32:35], a[28:31], v[232:235]
    s_waitcnt lgkmcnt(0)
    s_barrier
    v_mfma_f32_16x16x32_bf16 v[64:67], a[88:91], a[56:59], v[64:67]
    s_add_u32 m0, s62, 73728
    v_lshlrev_b32_e64 v60, 3, v0
    ds_read_b128 a[0:3], v13 offset:32768
    v_mfma_f32_16x16x32_bf16 v[68:71], a[92:95], a[56:59], v[68:71]
    buffer_load_dwordx2 v[48:49], v60, s[20:23], s42 offen offset:0 sc1
    v_mfma_f32_16x16x32_bf16 v[72:75], a[96:99], a[56:59], v[72:75]
    ds_read_b64_tr_b16 a[32:33], v15 offset:0
    v_mfma_f32_16x16x32_bf16 v[76:79], a[100:103], a[56:59], v[76:79]
    v_mfma_f32_16x16x32_bf16 v[80:83], a[104:107], a[56:59], v[80:83]
    buffer_load_dwordx2 v[50:51], v60, s[20:23], s42 offen offset:512 sc1
    ds_read_b64_tr_b16 a[34:35], v15 offset:512
    v_mfma_f32_16x16x32_bf16 v[84:87], a[108:111], a[56:59], v[84:87]
    v_mfma_f32_16x16x32_bf16 v[108:111], a[108:111], a[60:63], v[108:111]
    ds_read_b64_tr_b16 a[36:37], v15 offset:3072
    v_mfma_f32_16x16x32_bf16 v[104:107], a[104:107], a[60:63], v[104:107]
    buffer_load_dwordx4 v4, s[12:15], s60 offen lds
    v_mfma_f32_16x16x32_bf16 v[100:103], a[100:103], a[60:63], v[100:103]
    ds_read_b64_tr_b16 a[38:39], v15 offset:3584
    v_mfma_f32_16x16x32_bf16 v[96:99], a[96:99], a[60:63], v[96:99]
    v_mfma_f32_16x16x32_bf16 v[92:95], a[92:95], a[60:63], v[92:95]
    buffer_load_dwordx2 v[52:53], v60, s[20:23], s42 offen offset:1024 sc1
    v_mfma_f32_16x16x32_bf16 v[88:91], a[88:91], a[60:63], v[88:91]
    ds_read_b64_tr_b16 a[40:41], v16 offset:0
    v_mfma_f32_16x16x32_bf16 v[112:115], a[88:91], a[64:67], v[112:115]
    v_mfma_f32_16x16x32_bf16 v[116:119], a[92:95], a[64:67], v[116:119]
    buffer_load_dwordx2 v[54:55], v60, s[20:23], s42 offen offset:1536 sc1
    ds_read_b64_tr_b16 a[42:43], v16 offset:512
    v_mfma_f32_16x16x32_bf16 v[120:123], a[96:99], a[64:67], v[120:123]
    v_mfma_f32_16x16x32_bf16 v[124:127], a[100:103], a[64:67], v[124:127]
    ds_read_b64_tr_b16 a[44:45], v16 offset:3072
    v_mfma_f32_16x16x32_bf16 v[128:131], a[104:107], a[64:67], v[128:131]
    buffer_load_dwordx2 v[56:57], v60, s[20:23], s42 offen offset:2048 sc1
    v_mfma_f32_16x16x32_bf16 v[132:135], a[108:111], a[64:67], v[132:135]
    ds_read_b64_tr_b16 a[46:47], v16 offset:3584
    v_mfma_f32_16x16x32_bf16 v[156:159], a[108:111], a[68:71], v[156:159]
    v_mfma_f32_16x16x32_bf16 v[152:155], a[104:107], a[68:71], v[152:155]
    buffer_load_dwordx4 v5, s[12:15], s60 offen offset:1024 lds
    ds_read_b64_tr_b16 a[48:49], v17 offset:0
    v_mfma_f32_16x16x32_bf16 v[148:151], a[100:103], a[68:71], v[148:151]
    v_mfma_f32_16x16x32_bf16 v[144:147], a[96:99], a[68:71], v[144:147]
    v_mfma_f32_16x16x32_bf16 v[140:143], a[92:95], a[68:71], v[140:143]
    buffer_load_dwordx2 v[58:59], v60, s[20:23], s42 offen offset:2560 sc1
    s_lshr_b32 s65, s4, 1
    v_mfma_f32_16x16x32_bf16 v[136:139], a[88:91], a[68:71], v[136:139]
    s_mul_i32 s68, s65, 606208
    s_mul_i32 s65, s65, 323
    s_mul_i32 s64, s6, 3
    v_mfma_f32_16x16x32_bf16 v[160:163], a[88:91], a[72:75], v[160:163]
    s_add_u32 s64, s64, s65
    s_add_u32 s64, s64, 1044
    ds_read_b64_tr_b16 a[50:51], v17 offset:512
    v_mfma_f32_16x16x32_bf16 v[164:167], a[92:95], a[72:75], v[164:167]
    s_mul_i32 s65, s5, 592
    buffer_load_dwordx4 v6, s[12:15], s60 offen offset:2048 lds
    s_add_u32 m0, s43, 73728
    v_mfma_f32_16x16x32_bf16 v[168:171], a[96:99], a[72:75], v[168:171]
    s_add_u32 s64, s64, s65
    ds_read_b64_tr_b16 a[52:53], v17 offset:3072
    ds_read_b64_tr_b16 a[54:55], v17 offset:3584
    v_mfma_f32_16x16x32_bf16 v[172:175], a[100:103], a[72:75], v[172:175]
    s_lshl_b32 s64, s64, 10
    v_mfma_f32_16x16x32_bf16 v[176:179], a[104:107], a[72:75], v[176:179]
    s_sub_u32 s69, 151552, s68
    buffer_load_dwordx4 v4, s[16:19], s60 offen lds
    ds_read_b128 a[4:7], v13 offset:34816
    v_mfma_f32_16x16x32_bf16 v[180:183], a[108:111], a[72:75], v[180:183]
    s_sub_u32 s68, 75776, s68
    v_mfma_f32_16x16x32_bf16 v[204:207], a[108:111], a[76:79], v[204:207]
    s_and_b32 s66, s4, 1
    ds_read_b128 a[8:11], v13 offset:36864
    v_mfma_f32_16x16x32_bf16 v[200:203], a[104:107], a[76:79], v[200:203]
    s_lshl_b32 s67, s66, 9
    buffer_load_dwordx4 v5, s[16:19], s60 offen offset:1024 lds
    v_mfma_f32_16x16x32_bf16 v[196:199], a[100:103], a[76:79], v[196:199]
    s_add_u32 s65, s64, s67
    v_mfma_f32_16x16x32_bf16 v[192:195], a[96:99], a[76:79], v[192:195]
    s_add_u32 s65, s65, 2048
    ds_read_b128 a[12:15], v13 offset:38912
    v_mfma_f32_16x16x32_bf16 v[188:191], a[92:95], a[76:79], v[188:191]
    buffer_load_dwordx4 v6, s[16:19], s60 offen offset:2048 lds
    s_add_u32 s78, s38, 128000
    v_mfma_f32_16x16x32_bf16 v[184:187], a[88:91], a[76:79], v[184:187]
    s_lshl_b32 s66, s66, 10
    ds_read_b128 a[16:19], v7 offset:40960
    v_mfma_f32_16x16x32_bf16 v[208:211], a[88:91], a[80:83], v[208:211]
    v_mfma_f32_16x16x32_bf16 v[212:215], a[92:95], a[80:83], v[212:215]
    s_add_u32 s64, s64, s66
    buffer_load_dwordx4 a[208:211], v21, s[20:23], s78 offen sc1
    ds_read_b128 a[20:23], v7 offset:43008
    v_mfma_f32_16x16x32_bf16 v[216:219], a[96:99], a[80:83], v[216:219]
    v_mfma_f32_16x16x32_bf16 v[220:223], a[100:103], a[80:83], v[220:223]
    ds_read_b128 a[24:27], v7 offset:45056
    v_mfma_f32_16x16x32_bf16 v[224:227], a[104:107], a[80:83], v[224:227]
    buffer_load_dwordx4 a[212:215], v21, s[20:23], s78 offen offset:1024 sc1
    v_mfma_f32_16x16x32_bf16 v[228:231], a[108:111], a[80:83], v[228:231]
    ds_read_b128 a[28:31], v7 offset:47104
    v_mfma_f32_16x16x32_bf16 v[252:255], a[108:111], a[84:87], v[252:255]
    v_lshrrev_b32_e64 v24, 5, v0
    v_mfma_f32_16x16x32_bf16 v[248:251], a[104:107], a[84:87], v[248:251]
    buffer_load_dwordx4 a[216:219], v21, s[20:23], s78 offen offset:2048 sc1
    v_mfma_f32_16x16x32_bf16 v[244:247], a[100:103], a[84:87], v[244:247]
    v_mul_u32_u24 v24, 75264, v24
    buffer_load_dwordx4 a[220:223], v21, s[20:23], s78 offen offset:3072 sc1
    v_mfma_f32_16x16x32_bf16 v[240:243], a[96:99], a[84:87], v[240:243]
    v_mfma_f32_16x16x32_bf16 v[236:239], a[92:95], a[84:87], v[236:239]
    v_add_u32_e64 v24, v24, v21
    v_mfma_f32_16x16x32_bf16 v[232:235], a[88:91], a[84:87], v[232:235]
    s_waitcnt vmcnt(24) lgkmcnt(0)
    s_barrier
    v_mfma_f32_16x16x32_bf16 v[64:67], a[32:35], a[0:3], v[64:67]
    s_add_u32 s78, s38, 167936
    ds_read_b64_tr_b16 a[56:57], v15 offset:24576
    v_mfma_f32_16x16x32_bf16 v[68:71], a[36:39], a[0:3], v[68:71]
    ds_read_b64 a[124:125], v26 offset:3072
    v_mfma_f32_16x16x32_bf16 v[72:75], a[40:43], a[0:3], v[72:75]
    buffer_load_dwordx4 a[224:227], v21, s[20:23], s78 offen sc1
    ds_read_b64_tr_b16 a[58:59], v15 offset:25088
    v_mfma_f32_16x16x32_bf16 v[76:79], a[44:47], a[0:3], v[76:79]
    ds_read_b64 a[126:127], v26 offset:3200
    v_mfma_f32_16x16x32_bf16 v[80:83], a[48:51], a[0:3], v[80:83]
    ds_read_b64_tr_b16 a[60:61], v15 offset:27648
    v_mfma_f32_16x16x32_bf16 v[84:87], a[52:55], a[0:3], v[84:87]
    ds_read_b64 a[128:129], v26 offset:3328
    v_mfma_f32_16x16x32_bf16 v[108:111], a[52:55], a[4:7], v[108:111]
    buffer_load_dwordx4 a[228:231], v21, s[20:23], s78 offen offset:1024 sc1
    ds_read_b64_tr_b16 a[62:63], v15 offset:28160
    v_mfma_f32_16x16x32_bf16 v[104:107], a[48:51], a[4:7], v[104:107]
    ds_read_b64 a[130:131], v26 offset:3456
    v_mfma_f32_16x16x32_bf16 v[100:103], a[44:47], a[4:7], v[100:103]
    ds_read_b64_tr_b16 a[64:65], v16 offset:24576
    v_mfma_f32_16x16x32_bf16 v[96:99], a[40:43], a[4:7], v[96:99]
    ds_read_b64 a[132:133], v27 offset:3584
    v_mfma_f32_16x16x32_bf16 v[92:95], a[36:39], a[4:7], v[92:95]
    buffer_load_dwordx4 a[232:235], v21, s[20:23], s78 offen offset:2048 sc1
    ds_read_b64_tr_b16 a[66:67], v16 offset:25088
    v_mfma_f32_16x16x32_bf16 v[88:91], a[32:35], a[4:7], v[88:91]
    ds_read_b64 a[134:135], v27 offset:3712
    v_mfma_f32_16x16x32_bf16 v[112:115], a[32:35], a[8:11], v[112:115]
    ds_read_b64_tr_b16 a[68:69], v16 offset:27648
    v_mfma_f32_16x16x32_bf16 v[116:119], a[36:39], a[8:11], v[116:119]
    ds_read_b64 a[136:137], v27 offset:3840
    v_mfma_f32_16x16x32_bf16 v[120:123], a[40:43], a[8:11], v[120:123]
    buffer_load_dwordx4 a[236:239], v21, s[20:23], s78 offen offset:3072 sc1
    ds_read_b64_tr_b16 a[70:71], v16 offset:28160
    v_mfma_f32_16x16x32_bf16 v[124:127], a[44:47], a[8:11], v[124:127]
    s_add_u32 s78, s38, 172032
    ds_read_b64 a[138:139], v27 offset:3968
    s_waitcnt vmcnt(12)
    v_mfma_f32_16x16x32_bf16 v[128:131], a[48:51], a[8:11], v[128:131]
    ds_read_b64_tr_b16 a[72:73], v17 offset:24576
    v_max3_u32 v61, v48, v49, v50
    v_mfma_f32_16x16x32_bf16 v[132:135], a[52:55], a[8:11], v[132:135]
    ds_read_b64_tr_b16 a[74:75], v17 offset:25088
    v_max3_u32 v61, v61, v51, v52
    v_mfma_f32_16x16x32_bf16 v[156:159], a[52:55], a[12:15], v[156:159]
    buffer_load_dwordx4 a[240:243], v21, s[20:23], s78 offen sc1
    ds_read_b64_tr_b16 a[76:77], v17 offset:27648
    v_mfma_f32_16x16x32_bf16 v[152:155], a[48:51], a[12:15], v[152:155]
    s_add_u32 s78, s38, 207872
    v_max3_u32 v61, v61, v53, v54
    ds_read_b64_tr_b16 a[78:79], v17 offset:28160
    v_mfma_f32_16x16x32_bf16 v[148:151], a[44:47], a[12:15], v[148:151]
    v_max3_u32 v61, v61, v55, v56
    ds_read_b64_tr_b16 a[80:81], v18 offset:0
    v_mfma_f32_16x16x32_bf16 v[144:147], a[40:43], a[12:15], v[144:147]
    v_max3_u32 v61, v61, v57, v58
    v_mfma_f32_16x16x32_bf16 v[140:143], a[36:39], a[12:15], v[140:143]
    buffer_load_dwordx4 a[244:247], v21, s[20:23], s78 offen offset:1024 sc1
    ds_read_b64_tr_b16 a[82:83], v18 offset:512
    v_mfma_f32_16x16x32_bf16 v[136:139], a[32:35], a[12:15], v[136:139]
    v_max_u32 v61, v61, v59
    ds_read_b64_tr_b16 a[84:85], v18 offset:3072
    v_mfma_f32_16x16x32_bf16 v[160:163], a[32:35], a[16:19], v[160:163]
    v_cmp_eq_u32_e64 vcc, -1, v61
    v_mfma_f32_16x16x32_bf16 v[164:167], a[36:39], a[16:19], v[164:167]
    ds_read_b64_tr_b16 a[86:87], v18 offset:3584
    v_accvgpr_write_b32 a112, v48
    v_mfma_f32_16x16x32_bf16 v[168:171], a[40:43], a[16:19], v[168:171]
    buffer_load_dwordx4 a[248:251], v21, s[20:23], s78 offen offset:2048 sc1
    v_mfma_f32_16x16x32_bf16 v[172:175], a[44:47], a[16:19], v[172:175]
    ds_read_b64_tr_b16 a[88:89], v19 offset:0
    v_accvgpr_write_b32 a113, v49
    v_mfma_f32_16x16x32_bf16 v[176:179], a[48:51], a[16:19], v[176:179]
    ds_read_b64_tr_b16 a[90:91], v19 offset:512
    v_accvgpr_write_b32 a114, v50
    v_mfma_f32_16x16x32_bf16 v[180:183], a[52:55], a[16:19], v[180:183]
    v_mfma_f32_16x16x32_bf16 v[204:207], a[52:55], a[20:23], v[204:207]
    buffer_load_dwordx4 a[252:255], v21, s[20:23], s78 offen offset:3072 sc1
    s_add_u32 m0, s79, 114688
    v_mfma_f32_16x16x32_bf16 v[200:203], a[48:51], a[20:23], v[200:203]
    s_add_u32 s78, s38, 211968
    v_accvgpr_write_b32 a115, v51
    ds_read_b64_tr_b16 a[92:93], v19 offset:3072
    v_mfma_f32_16x16x32_bf16 v[196:199], a[44:47], a[20:23], v[196:199]
    v_accvgpr_write_b32 a116, v52
    ds_read_b64_tr_b16 a[94:95], v19 offset:3584
    v_mfma_f32_16x16x32_bf16 v[192:195], a[40:43], a[20:23], v[192:195]
    v_accvgpr_write_b32 a117, v53
    ds_read_b64_tr_b16 a[96:97], v20 offset:0
    v_mfma_f32_16x16x32_bf16 v[188:191], a[36:39], a[20:23], v[188:191]
    buffer_load_dwordx4 v21, s[20:23], s78 offen sc1 lds
    v_accvgpr_write_b32 a118, v54
    v_mfma_f32_16x16x32_bf16 v[184:187], a[32:35], a[20:23], v[184:187]
    ds_read_b64_tr_b16 a[98:99], v20 offset:512
    v_mfma_f32_16x16x32_bf16 v[208:211], a[32:35], a[24:27], v[208:211]
    v_accvgpr_write_b32 a119, v55
    v_mfma_f32_16x16x32_bf16 v[212:215], a[36:39], a[24:27], v[212:215]
    ds_read_b64_tr_b16 a[100:101], v20 offset:3072
    v_accvgpr_write_b32 a120, v56
    v_mfma_f32_16x16x32_bf16 v[216:219], a[40:43], a[24:27], v[216:219]
    buffer_load_dwordx4 v21, s[20:23], s78 offen offset:1024 sc1 lds
    s_add_u32 s78, s38, 247808
    v_mfma_f32_16x16x32_bf16 v[220:223], a[44:47], a[24:27], v[220:223]
    ds_read_b64_tr_b16 a[102:103], v20 offset:3584
    v_accvgpr_write_b32 a121, v57
    v_mfma_f32_16x16x32_bf16 v[224:227], a[48:51], a[24:27], v[224:227]
    ds_read_b128 a[104:107], v14 offset:32768
    v_accvgpr_write_b32 a122, v58
    v_mfma_f32_16x16x32_bf16 v[228:231], a[52:55], a[24:27], v[228:231]
    v_mfma_f32_16x16x32_bf16 v[252:255], a[52:55], a[28:31], v[252:255]
    buffer_load_dwordx4 v22, s[20:23], s78 offen offset:2048 sc1 lds
    ds_read_b128 a[108:111], v13 offset:0
    v_mfma_f32_16x16x32_bf16 v[248:251], a[48:51], a[28:31], v[248:251]
    v_accvgpr_write_b32 a123, v59
    v_mfma_f32_16x16x32_bf16 v[244:247], a[44:47], a[28:31], v[244:247]
    buffer_load_dwordx4 v22, s[20:23], s78 offen offset:3072 sc1 lds
    v_mfma_f32_16x16x32_bf16 v[240:243], a[40:43], a[28:31], v[240:243]
    v_mfma_f32_16x16x32_bf16 v[236:239], a[36:39], a[28:31], v[236:239]
    v_mfma_f32_16x16x32_bf16 v[232:235], a[32:35], a[28:31], v[232:235]
    s_waitcnt vmcnt(16) lgkmcnt(0)
    s_barrier
    s_cbranch_vccnz L_slow_csgu
L_ok_csgu:
    v_mfma_f32_16x16x16_bf16 v[64:67], a[112:113], a[124:125], v[64:67]
    ds_read_b64_tr_b16 a[0:1], v18 offset:24576
    s_add_u32 m0, s79, 0
    ds_read_b64_tr_b16 a[2:3], v18 offset:25088
    v_mfma_f32_16x16x16_bf16 v[68:71], a[114:115], a[124:125], v[68:71]
    s_add_u32 s78, s38, 251904
    ds_read_b64_tr_b16 a[4:5], v18 offset:27648
    v_mfma_f32_16x16x16_bf16 v[72:75], a[116:117], a[124:125], v[72:75]
    buffer_load_dwordx4 v22, s[20:23], s78 offen sc1 lds
    ds_read_b64_tr_b16 a[6:7], v18 offset:28160
    v_mfma_f32_16x16x16_bf16 v[76:79], a[118:119], a[124:125], v[76:79]
    ds_read_b64_tr_b16 a[8:9], v19 offset:24576
    v_mfma_f32_16x16x16_bf16 v[80:83], a[120:121], a[124:125], v[80:83]
    ds_read_b64_tr_b16 a[10:11], v19 offset:25088
    v_mfma_f32_16x16x16_bf16 v[84:87], a[122:123], a[124:125], v[84:87]
    buffer_load_dwordx4 v22, s[20:23], s78 offen offset:1024 sc1 lds
    ds_read_b64_tr_b16 a[12:13], v19 offset:27648
    v_mfma_f32_16x16x32_bf16 v[64:67], a[56:59], a[104:107], v[64:67]
    ds_read_b64_tr_b16 a[14:15], v19 offset:28160
    v_mfma_f32_16x16x32_bf16 v[68:71], a[60:63], a[104:107], v[68:71]
    ds_read_b64_tr_b16 a[16:17], v20 offset:24576
    v_mfma_f32_16x16x32_bf16 v[72:75], a[64:67], a[104:107], v[72:75]
    buffer_load_dwordx4 v22, s[20:23], s78 offen offset:2048 sc1 lds
    s_add_u32 s78, s39, 1024
    v_mfma_f32_16x16x32_bf16 v[76:79], a[68:71], a[104:107], v[76:79]
    ds_read_b64_tr_b16 a[18:19], v20 offset:25088
    v_mfma_f32_16x16x32_bf16 v[80:83], a[72:75], a[104:107], v[80:83]
    ds_read_b64_tr_b16 a[20:21], v20 offset:27648
    v_mfma_f32_16x16x32_bf16 v[84:87], a[76:79], a[104:107], v[84:87]
    buffer_load_dwordx4 v21, s[20:23], s78 offen offset:3072 sc1 lds
    ds_read_b64_tr_b16 a[22:23], v20 offset:28160
    v_mfma_f32_16x16x32_bf16 v[64:67], a[80:83], a[108:111], v[64:67]
    s_add_u32 m0, s79, 16384
    ds_read_b128 a[24:27], v14 offset:0
    s_add_u32 s78, s39, 5120
    v_mfma_f32_16x16x32_bf16 v[68:71], a[84:87], a[108:111], v[68:71]
    ds_read_b128 a[28:31], v14 offset:34816
    v_mfma_f32_16x16x32_bf16 v[72:75], a[88:91], a[108:111], v[72:75]
    buffer_load_dwordx4 v21, s[20:23], s78 offen sc1 lds
    ds_read_b128 a[32:35], v13 offset:2048
    v_mfma_f32_16x16x32_bf16 v[76:79], a[92:95], a[108:111], v[76:79]
    v_mfma_f32_16x16x32_bf16 v[80:83], a[96:99], a[108:111], v[80:83]
    v_mfma_f32_16x16x32_bf16 v[84:87], a[100:103], a[108:111], v[84:87]
    buffer_load_dwordx4 v21, s[20:23], s78 offen offset:1024 sc1 lds
    s_waitcnt lgkmcnt(2)
    v_mfma_f32_16x16x32_bf16 v[64:67], a[0:3], a[24:27], v[64:67]
    v_mfma_f32_16x16x32_bf16 v[68:71], a[4:7], a[24:27], v[68:71]
    v_mfma_f32_16x16x32_bf16 v[72:75], a[8:11], a[24:27], v[72:75]
    buffer_load_dwordx4 v21, s[20:23], s78 offen offset:2048 sc1 lds
    v_mfma_f32_16x16x32_bf16 v[76:79], a[12:15], a[24:27], v[76:79]
    buffer_load_dwordx4 v21, s[20:23], s78 offen offset:3072 sc1 lds
    v_min_u32 v16, 1, v0
    v_mfma_f32_16x16x32_bf16 v[80:83], a[16:19], a[24:27], v[80:83]
    v_lshlrev_b32 v16, 30, v16
    v_mov_b32 v17, 1
    v_mfma_f32_16x16x32_bf16 v[84:87], a[20:23], a[24:27], v[84:87]
    s_barrier
    v_mfma_f32_16x16x16_bf16 v[88:91], a[112:113], a[126:127], v[88:91]
    ds_read_b128 a[36:39], v14 offset:2048
    s_add_u32 m0, s79, 32768
    v_mfma_f32_16x16x16_bf16 v[92:95], a[114:115], a[126:127], v[92:95]
    v_max_f32 v64, 0, v64
    v_max_f32_e64 v65, 0, v65
    v_mfma_f32_16x16x16_bf16 v[96:99], a[116:117], a[126:127], v[96:99]
    v_max_f32 v66, 0, v66
    v_max_f32 v67, 0, v67
    v_mfma_f32_16x16x16_bf16 v[100:103], a[118:119], a[126:127], v[100:103]
    v_mul_f32 v68, v64, v68
    v_mul_f32 v69, v65, v69
    s_add_u32 s78, s39, 45056
    v_mfma_f32_16x16x16_bf16 v[104:107], a[120:121], a[126:127], v[104:107]
    v_mul_f32 v70, v66, v70
    v_mul_f32 v71, v67, v71
    ds_read_b128 a[40:43], v14 offset:36864
    v_mfma_f32_16x16x16_bf16 v[108:111], a[122:123], a[126:127], v[108:111]
    v_cvt_pk_bf16_f32 v64, v68, v69
    v_cvt_pk_bf16_f32 v65, v70, v71
    s_waitcnt lgkmcnt(3)
    v_mfma_f32_16x16x32_bf16 v[88:91], a[56:59], a[28:31], v[88:91]
    v_max_f32 v72, 0, v72
    v_max_f32_e64 v73, 0, v73
    v_mfma_f32_16x16x32_bf16 v[92:95], a[60:63], a[28:31], v[92:95]
    buffer_load_dwordx4 v21, s[20:23], s78 offen sc1 lds
    v_max_f32_e64 v74, 0, v74
    v_mfma_f32_16x16x32_bf16 v[96:99], a[64:67], a[28:31], v[96:99]
    v_max_f32 v75, 0, v75
    v_mul_f32 v76, v72, v76
    v_mfma_f32_16x16x32_bf16 v[100:103], a[68:71], a[28:31], v[100:103]
    v_mul_f32 v77, v73, v77
    v_mul_f32 v78, v74, v78
    v_mfma_f32_16x16x32_bf16 v[104:107], a[72:75], a[28:31], v[104:107]
    v_mul_f32_e64 v79, v75, v79
    v_cvt_pk_bf16_f32 v66, v76, v77
    v_cvt_pk_bf16_f32 v67, v78, v79
    v_mfma_f32_16x16x32_bf16 v[108:111], a[76:79], a[28:31], v[108:111]
    buffer_store_dwordx4 v[64:67], v21, s[20:23], s64 offen sc1
    s_add_u32 s64, s64, 75776
    s_waitcnt lgkmcnt(2)
    v_mfma_f32_16x16x32_bf16 v[88:91], a[80:83], a[32:35], v[88:91]
    ds_read_b128 a[44:47], v13 offset:4096
    v_max_f32 v80, 0, v80
    v_mfma_f32_16x16x32_bf16 v[92:95], a[84:87], a[32:35], v[92:95]
    v_max_f32 v81, 0, v81
    v_max_f32 v82, 0, v82
    v_max_f32_e64 v83, 0, v83
    v_mfma_f32_16x16x32_bf16 v[96:99], a[88:91], a[32:35], v[96:99]
    buffer_load_dwordx4 v21, s[20:23], s78 offen offset:1024 sc1 lds
    v_mul_f32 v84, v80, v84
    v_mul_f32 v85, v81, v85
    v_mfma_f32_16x16x32_bf16 v[100:103], a[92:95], a[32:35], v[100:103]
    v_mul_f32 v86, v82, v86
    v_mul_f32 v87, v83, v87
    v_mfma_f32_16x16x32_bf16 v[104:107], a[96:99], a[32:35], v[104:107]
    v_cvt_pk_bf16_f32 v80, v84, v85
    v_cvt_pk_bf16_f32 v81, v86, v87
    v_mfma_f32_16x16x32_bf16 v[108:111], a[100:103], a[32:35], v[108:111]
    buffer_load_dwordx4 v21, s[20:23], s78 offen offset:2048 sc1 lds
    s_waitcnt lgkmcnt(2)
    v_mfma_f32_16x16x32_bf16 v[88:91], a[0:3], a[36:39], v[88:91]
    v_mfma_f32_16x16x32_bf16 v[92:95], a[4:7], a[36:39], v[92:95]
    v_mfma_f32_16x16x32_bf16 v[96:99], a[8:11], a[36:39], v[96:99]
    buffer_load_dwordx4 v21, s[20:23], s78 offen offset:3072 sc1 lds
    v_mfma_f32_16x16x32_bf16 v[100:103], a[12:15], a[36:39], v[100:103]
    v_mfma_f32_16x16x32_bf16 v[104:107], a[16:19], a[36:39], v[104:107]
    v_mfma_f32_16x16x32_bf16 v[108:111], a[20:23], a[36:39], v[108:111]
    v_mfma_f32_16x16x16_bf16 v[112:115], a[112:113], a[128:129], v[112:115]
    ds_read_b128 a[48:51], v14 offset:4096
    s_add_u32 m0, s79, 49152
    v_mfma_f32_16x16x16_bf16 v[116:119], a[114:115], a[128:129], v[116:119]
    v_max_f32 v88, 0, v88
    v_max_f32 v89, 0, v89
    v_max_f32 v90, 0, v90
    v_mfma_f32_16x16x16_bf16 v[120:123], a[116:117], a[128:129], v[120:123]
    v_max_f32 v91, 0, v91
    v_mul_f32 v92, v88, v92
    v_mul_f32_e64 v93, v89, v93
    v_mfma_f32_16x16x16_bf16 v[124:127], a[118:119], a[128:129], v[124:127]
    s_add_u32 s78, s39, 49152
    v_mul_f32 v94, v90, v94
    v_mul_f32 v95, v91, v95
    v_mfma_f32_16x16x16_bf16 v[128:131], a[120:121], a[128:129], v[128:131]
    v_cvt_pk_bf16_f32 v88, v92, v93
    ds_read_b128 a[52:55], v14 offset:38912
    v_cvt_pk_bf16_f32 v89, v94, v95
    v_mfma_f32_16x16x16_bf16 v[132:135], a[122:123], a[128:129], v[132:135]
    v_max_f32 v96, 0, v96
    v_max_f32 v97, 0, v97
    s_waitcnt lgkmcnt(3)
    v_mfma_f32_16x16x32_bf16 v[112:115], a[56:59], a[40:43], v[112:115]
    buffer_load_dwordx4 v21, s[20:23], s78 offen sc1 lds
    v_max_f32 v98, 0, v98
    v_max_f32_e64 v99, 0, v99
    v_mfma_f32_16x16x32_bf16 v[116:119], a[60:63], a[40:43], v[116:119]
    s_add_u32 s78, s39, 84992
    v_mul_f32 v100, v96, v100
    v_mul_f32 v101, v97, v101
    v_mul_f32_e64 v102, v98, v102
    v_mfma_f32_16x16x32_bf16 v[120:123], a[64:67], a[40:43], v[120:123]
    v_mul_f32_e64 v103, v99, v103
    v_cvt_pk_bf16_f32 v90, v100, v101
    v_mfma_f32_16x16x32_bf16 v[124:127], a[68:71], a[40:43], v[124:127]
    v_cvt_pk_bf16_f32 v91, v102, v103
    buffer_store_dwordx4 v[88:91], v21, s[20:23], s64 offen sc1
    v_mfma_f32_16x16x32_bf16 v[128:131], a[72:75], a[40:43], v[128:131]
    s_add_u32 s64, s64, 75776
    ds_read_b128 a[104:107], v13 offset:6144
    v_max_f32_e64 v104, 0, v104
    v_mfma_f32_16x16x32_bf16 v[132:135], a[76:79], a[40:43], v[132:135]
    v_max_f32 v105, 0, v105
    v_max_f32 v106, 0, v106
    s_waitcnt lgkmcnt(3)
    v_mfma_f32_16x16x32_bf16 v[112:115], a[80:83], a[44:47], v[112:115]
    v_max_f32 v107, 0, v107
    v_mul_f32_e64 v108, v104, v108
    v_mfma_f32_16x16x32_bf16 v[116:119], a[84:87], a[44:47], v[116:119]
    buffer_load_dwordx4 v21, s[20:23], s78 offen offset:1024 sc1 lds
    v_mul_f32 v109, v105, v109
    v_mul_f32 v110, v106, v110
    v_mfma_f32_16x16x32_bf16 v[120:123], a[88:91], a[44:47], v[120:123]
    v_mul_f32_e64 v111, v107, v111
    v_cvt_pk_bf16_f32 v82, v108, v109
    v_cvt_pk_bf16_f32 v83, v110, v111
    v_mfma_f32_16x16x32_bf16 v[124:127], a[92:95], a[44:47], v[124:127]
    v_permlane32_swap_b32 v80, v82
    v_permlane32_swap_b32 v81, v83
    v_mfma_f32_16x16x32_bf16 v[128:131], a[96:99], a[44:47], v[128:131]
    buffer_store_dwordx4 v[80:83], v24, s[20:23], s65 offen sc1
    s_add_u32 s65, s65, 151552
    v_mfma_f32_16x16x32_bf16 v[132:135], a[100:103], a[44:47], v[132:135]
    s_waitcnt lgkmcnt(2)
    v_mfma_f32_16x16x32_bf16 v[112:115], a[0:3], a[48:51], v[112:115]
    v_mfma_f32_16x16x32_bf16 v[116:119], a[4:7], a[48:51], v[116:119]
    buffer_load_dwordx4 v21, s[20:23], s78 offen offset:2048 sc1 lds
    v_mfma_f32_16x16x32_bf16 v[120:123], a[8:11], a[48:51], v[120:123]
    v_mfma_f32_16x16x32_bf16 v[124:127], a[12:15], a[48:51], v[124:127]
    v_mfma_f32_16x16x32_bf16 v[128:131], a[16:19], a[48:51], v[128:131]
    buffer_load_dwordx4 v21, s[20:23], s78 offen offset:3072 sc1 lds
    v_mfma_f32_16x16x32_bf16 v[132:135], a[20:23], a[48:51], v[132:135]
    v_mfma_f32_16x16x16_bf16 v[136:139], a[112:113], a[130:131], v[136:139]
    ds_read_b128 a[108:111], v14 offset:6144
    s_add_u32 m0, s79, 65536
    v_mfma_f32_16x16x16_bf16 v[140:143], a[114:115], a[130:131], v[140:143]
    v_max_f32 v112, 0, v112
    v_max_f32_e64 v113, 0, v113
    v_mfma_f32_16x16x16_bf16 v[144:147], a[116:117], a[130:131], v[144:147]
    v_max_f32 v114, 0, v114
    v_max_f32 v115, 0, v115
    v_mfma_f32_16x16x16_bf16 v[148:151], a[118:119], a[130:131], v[148:151]
    v_mul_f32 v116, v112, v116
    v_mul_f32 v117, v113, v117
    s_add_u32 s78, s39, 89088
    v_mfma_f32_16x16x16_bf16 v[152:155], a[120:121], a[130:131], v[152:155]
    v_mul_f32 v118, v114, v118
    v_mul_f32 v119, v115, v119
    ds_read_b128 a[24:27], v12 offset:40960
    v_mfma_f32_16x16x16_bf16 v[156:159], a[122:123], a[130:131], v[156:159]
    v_cvt_pk_bf16_f32 v112, v116, v117
    v_cvt_pk_bf16_f32 v113, v118, v119
    s_waitcnt lgkmcnt(3)
    v_mfma_f32_16x16x32_bf16 v[136:139], a[56:59], a[52:55], v[136:139]
    buffer_load_dwordx4 v21, s[20:23], s78 offen sc1 lds
    v_max_f32 v120, 0, v120
    v_mfma_f32_16x16x32_bf16 v[140:143], a[60:63], a[52:55], v[140:143]
L_isl_gu_4:
    s_cbranch_execz L_warm_gu_0
    v_max_f32 v121, 0, v121
    v_max_f32_e64 v122, 0, v122
    v_mfma_f32_16x16x32_bf16 v[144:147], a[64:67], a[52:55], v[144:147]
    v_max_f32 v123, 0, v123
    v_mul_f32 v124, v120, v124
    v_mfma_f32_16x16x32_bf16 v[148:151], a[68:71], a[52:55], v[148:151]
    buffer_load_dwordx4 v21, s[20:23], s78 offen offset:1024 sc1 lds
    v_mul_f32 v125, v121, v125
    v_mul_f32 v126, v122, v126
    v_mfma_f32_16x16x32_bf16 v[152:155], a[72:75], a[52:55], v[152:155]
    s_add_u32 s78, s39, 124928
    v_mul_f32_e64 v127, v123, v127
    v_cvt_pk_bf16_f32 v114, v124, v125
    v_cvt_pk_bf16_f32 v115, v126, v127
    v_mfma_f32_16x16x32_bf16 v[156:159], a[76:79], a[52:55], v[156:159]
    ds_read_b128 a[28:31], v7 offset:8192
    buffer_store_dwordx4 v[112:115], v21, s[20:23], s64 offen sc1
    s_waitcnt lgkmcnt(3)
    v_mfma_f32_16x16x32_bf16 v[136:139], a[80:83], a[104:107], v[136:139]
    s_add_u32 s64, s64, 75776
    v_max_f32 v128, 0, v128
    v_max_f32_e64 v129, 0, v129
    v_mfma_f32_16x16x32_bf16 v[140:143], a[84:87], a[104:107], v[140:143]
    v_max_f32 v130, 0, v130
    v_max_f32 v131, 0, v131
    v_mfma_f32_16x16x32_bf16 v[144:147], a[88:91], a[104:107], v[144:147]
    v_mul_f32 v132, v128, v132
    v_mul_f32 v133, v129, v133
    v_mfma_f32_16x16x32_bf16 v[148:151], a[92:95], a[104:107], v[148:151]
    v_mul_f32 v134, v130, v134
    v_mul_f32 v135, v131, v135
    v_mfma_f32_16x16x32_bf16 v[152:155], a[96:99], a[104:107], v[152:155]
    buffer_load_dwordx4 v21, s[20:23], s78 offen offset:2048 sc1 lds
    v_cvt_pk_bf16_f32 v128, v132, v133
    v_cvt_pk_bf16_f32 v129, v134, v135
    v_mfma_f32_16x16x32_bf16 v[156:159], a[100:103], a[104:107], v[156:159]
    s_waitcnt lgkmcnt(2)
    v_mfma_f32_16x16x32_bf16 v[136:139], a[0:3], a[108:111], v[136:139]
    v_mfma_f32_16x16x32_bf16 v[140:143], a[4:7], a[108:111], v[140:143]
    buffer_load_dwordx4 v21, s[20:23], s78 offen offset:3072 sc1 lds
    v_mfma_f32_16x16x32_bf16 v[144:147], a[8:11], a[108:111], v[144:147]
    v_mfma_f32_16x16x32_bf16 v[148:151], a[12:15], a[108:111], v[148:151]
    v_mfma_f32_16x16x32_bf16 v[152:155], a[16:19], a[108:111], v[152:155]
    v_mfma_f32_16x16x32_bf16 v[156:159], a[20:23], a[108:111], v[156:159]
    v_mfma_f32_16x16x16_bf16 v[160:163], a[112:113], a[132:133], v[160:163]
    ds_read_b128 a[32:35], v12 offset:8192
    s_add_u32 m0, s79, 81920
    v_mfma_f32_16x16x16_bf16 v[164:167], a[114:115], a[132:133], v[164:167]
    v_max_f32 v136, 0, v136
    v_max_f32 v137, 0, v137
    v_max_f32 v138, 0, v138
    v_mfma_f32_16x16x16_bf16 v[168:171], a[116:117], a[132:133], v[168:171]
    v_max_f32 v139, 0, v139
    v_mul_f32 v140, v136, v140
    v_mul_f32_e64 v141, v137, v141
    v_mfma_f32_16x16x16_bf16 v[172:175], a[118:119], a[132:133], v[172:175]
    s_add_u32 s78, s39, 129024
    v_mul_f32 v142, v138, v142
    v_mul_f32 v143, v139, v143
    v_mfma_f32_16x16x16_bf16 v[176:179], a[120:121], a[132:133], v[176:179]
    v_cvt_pk_bf16_f32 v136, v140, v141
    ds_read_b128 a[36:39], v12 offset:43008
    v_cvt_pk_bf16_f32 v137, v142, v143
    v_mfma_f32_16x16x16_bf16 v[180:183], a[122:123], a[132:133], v[180:183]
    v_max_f32 v144, 0, v144
    v_max_f32 v145, 0, v145
    s_waitcnt lgkmcnt(3)
    v_mfma_f32_16x16x32_bf16 v[160:163], a[56:59], a[24:27], v[160:163]
    buffer_load_dwordx4 v21, s[20:23], s78 offen sc1 lds
    v_max_f32 v146, 0, v146
    v_max_f32_e64 v147, 0, v147
    v_mfma_f32_16x16x32_bf16 v[164:167], a[60:63], a[24:27], v[164:167]
    v_mul_f32 v148, v144, v148
    v_mul_f32 v149, v145, v149
    v_mul_f32_e64 v150, v146, v150
    v_mfma_f32_16x16x32_bf16 v[168:171], a[64:67], a[24:27], v[168:171]
    v_mul_f32_e64 v151, v147, v151
    v_cvt_pk_bf16_f32 v138, v148, v149
    v_mfma_f32_16x16x32_bf16 v[172:175], a[68:71], a[24:27], v[172:175]
    buffer_load_dwordx4 v21, s[20:23], s78 offen offset:1024 sc1 lds
    v_cvt_pk_bf16_f32 v139, v150, v151
    buffer_store_dwordx4 v[136:139], v21, s[20:23], s64 offen sc1
    v_mfma_f32_16x16x32_bf16 v[176:179], a[72:75], a[24:27], v[176:179]
    s_add_u32 s64, s64, s68
    ds_read_b128 a[40:43], v7 offset:10240
    v_max_f32 v152, 0, v152
    v_mfma_f32_16x16x32_bf16 v[180:183], a[76:79], a[24:27], v[180:183]
    v_max_f32 v153, 0, v153
    v_max_f32 v154, 0, v154
    s_waitcnt lgkmcnt(3)
    v_mfma_f32_16x16x32_bf16 v[160:163], a[80:83], a[28:31], v[160:163]
    v_max_f32 v155, 0, v155
    v_mul_f32_e64 v156, v152, v156
    v_mfma_f32_16x16x32_bf16 v[164:167], a[84:87], a[28:31], v[164:167]
    buffer_load_dwordx4 v21, s[20:23], s78 offen offset:2048 sc1 lds
    v_mul_f32 v157, v153, v157
    v_mul_f32 v158, v154, v158
    v_mfma_f32_16x16x32_bf16 v[168:171], a[88:91], a[28:31], v[168:171]
    s_add_u32 s78, s39, 164864
    v_mul_f32_e64 v159, v155, v159
    v_cvt_pk_bf16_f32 v130, v156, v157
    v_cvt_pk_bf16_f32 v131, v158, v159
    v_mfma_f32_16x16x32_bf16 v[172:175], a[92:95], a[28:31], v[172:175]
    v_permlane32_swap_b32 v128, v130
    v_permlane32_swap_b32 v129, v131
    v_mfma_f32_16x16x32_bf16 v[176:179], a[96:99], a[28:31], v[176:179]
    buffer_store_dwordx4 v[128:131], v24, s[20:23], s65 offen sc1
    s_add_u32 s65, s65, s69
    v_mfma_f32_16x16x32_bf16 v[180:183], a[100:103], a[28:31], v[180:183]
    s_waitcnt lgkmcnt(2)
    v_mfma_f32_16x16x32_bf16 v[160:163], a[0:3], a[32:35], v[160:163]
    v_mfma_f32_16x16x32_bf16 v[164:167], a[4:7], a[32:35], v[164:167]
    buffer_load_dwordx4 v21, s[20:23], s78 offen offset:3072 sc1 lds
    v_mfma_f32_16x16x32_bf16 v[168:171], a[8:11], a[32:35], v[168:171]
    v_mfma_f32_16x16x32_bf16 v[172:175], a[12:15], a[32:35], v[172:175]
    v_mfma_f32_16x16x32_bf16 v[176:179], a[16:19], a[32:35], v[176:179]
    v_mfma_f32_16x16x32_bf16 v[180:183], a[20:23], a[32:35], v[180:183]
    v_mfma_f32_16x16x16_bf16 v[184:187], a[112:113], a[134:135], v[184:187]
    ds_read_b128 a[44:47], v12 offset:10240
    s_add_u32 s78, s39, 212992
    v_mfma_f32_16x16x16_bf16 v[188:191], a[114:115], a[134:135], v[188:191]
    v_max_f32 v160, 0, v160
    v_max_f32 v161, 0, v161
    v_mfma_f32_16x16x16_bf16 v[192:195], a[116:117], a[134:135], v[192:195]
    v_max_f32 v162, 0, v162
    v_max_f32 v163, 0, v163
    v_mfma_f32_16x16x16_bf16 v[196:199], a[118:119], a[134:135], v[196:199]
    buffer_load_dwordx4 v[40:43], v21, s[20:23], s78 offen sc1
    v_mul_f32 v164, v160, v164
    v_mul_f32 v165, v161, v165
    v_mfma_f32_16x16x16_bf16 v[200:203], a[120:121], a[134:135], v[200:203]
    v_mul_f32 v166, v162, v166
    v_mul_f32 v167, v163, v167
    ds_read_b128 a[48:51], v12 offset:45056
    v_mfma_f32_16x16x16_bf16 v[204:207], a[122:123], a[134:135], v[204:207]
    v_cvt_pk_bf16_f32 v160, v164, v165
    v_cvt_pk_bf16_f32 v161, v166, v167
    s_waitcnt lgkmcnt(3)
    v_mfma_f32_16x16x32_bf16 v[184:187], a[56:59], a[36:39], v[184:187]
    s_add_u32 s78, s39, 248832
    v_max_f32 v168, 0, v168
    v_max_f32_e64 v169, 0, v169
    v_mfma_f32_16x16x32_bf16 v[188:191], a[60:63], a[36:39], v[188:191]
    v_max_f32 v170, 0, v170
    v_max_f32 v171, 0, v171
    v_mfma_f32_16x16x32_bf16 v[192:195], a[64:67], a[36:39], v[192:195]
    v_mul_f32 v172, v168, v172
    v_mul_f32 v173, v169, v173
    v_mfma_f32_16x16x32_bf16 v[196:199], a[68:71], a[36:39], v[196:199]
    v_mul_f32 v174, v170, v174
    v_mul_f32 v175, v171, v175
    v_mfma_f32_16x16x32_bf16 v[200:203], a[72:75], a[36:39], v[200:203]
    v_cvt_pk_bf16_f32 v162, v172, v173
    v_cvt_pk_bf16_f32 v163, v174, v175
    v_mfma_f32_16x16x32_bf16 v[204:207], a[76:79], a[36:39], v[204:207]
    buffer_store_dwordx4 v[160:163], v21, s[20:23], s64 offen sc1
    s_add_u32 s64, s64, 75776
    s_waitcnt lgkmcnt(2)
    v_mfma_f32_16x16x32_bf16 v[184:187], a[80:83], a[40:43], v[184:187]
    ds_read_b128 a[52:55], v7 offset:12288
    v_max_f32 v176, 0, v176
    v_mfma_f32_16x16x32_bf16 v[188:191], a[84:87], a[40:43], v[188:191]
    v_max_f32 v177, 0, v177
    v_max_f32 v178, 0, v178
    v_max_f32_e64 v179, 0, v179
    v_mfma_f32_16x16x32_bf16 v[192:195], a[88:91], a[40:43], v[192:195]
    buffer_load_dwordx4 v[44:47], v22, s[20:23], s78 offen offset:1024 sc1
    v_mul_f32 v180, v176, v180
    v_mul_f32 v181, v177, v181
    v_mfma_f32_16x16x32_bf16 v[196:199], a[92:95], a[40:43], v[196:199]
    v_mul_f32 v182, v178, v182
    v_mul_f32 v183, v179, v183
    v_mfma_f32_16x16x32_bf16 v[200:203], a[96:99], a[40:43], v[200:203]
    v_cvt_pk_bf16_f32 v176, v180, v181
    v_cvt_pk_bf16_f32 v177, v182, v183
    v_mfma_f32_16x16x32_bf16 v[204:207], a[100:103], a[40:43], v[204:207]
    buffer_load_dwordx4 v[48:51], v22, s[20:23], s78 offen offset:2048 sc1
    s_waitcnt lgkmcnt(2)
    v_mfma_f32_16x16x32_bf16 v[184:187], a[0:3], a[44:47], v[184:187]
    v_mfma_f32_16x16x32_bf16 v[188:191], a[4:7], a[44:47], v[188:191]
    v_mfma_f32_16x16x32_bf16 v[192:195], a[8:11], a[44:47], v[192:195]
    buffer_load_dwordx4 v[52:55], v22, s[20:23], s78 offen offset:3072 sc1
    v_mfma_f32_16x16x32_bf16 v[196:199], a[12:15], a[44:47], v[196:199]
    v_mfma_f32_16x16x32_bf16 v[200:203], a[16:19], a[44:47], v[200:203]
    v_mfma_f32_16x16x32_bf16 v[204:207], a[20:23], a[44:47], v[204:207]
    v_mfma_f32_16x16x16_bf16 v[208:211], a[112:113], a[136:137], v[208:211]
    ds_read_b128 a[104:107], v12 offset:12288
    s_add_u32 s78, s39, 252928
    v_mfma_f32_16x16x16_bf16 v[212:215], a[114:115], a[136:137], v[212:215]
    v_max_f32 v184, 0, v184
    v_max_f32 v185, 0, v185
    v_max_f32 v186, 0, v186
    v_mfma_f32_16x16x16_bf16 v[216:219], a[116:117], a[136:137], v[216:219]
    v_max_f32 v187, 0, v187
    v_mul_f32 v188, v184, v188
    v_mul_f32_e64 v189, v185, v189
    v_mfma_f32_16x16x16_bf16 v[220:223], a[118:119], a[136:137], v[220:223]
    buffer_load_dwordx4 v[56:59], v22, s[20:23], s78 offen sc1
    v_mul_f32 v190, v186, v190
    v_mul_f32 v191, v187, v191
    v_mfma_f32_16x16x16_bf16 v[224:227], a[120:121], a[136:137], v[224:227]
    v_cvt_pk_bf16_f32 v184, v188, v189
    ds_read_b128 a[108:111], v12 offset:47104
    v_cvt_pk_bf16_f32 v185, v190, v191
    v_mfma_f32_16x16x16_bf16 v[228:231], a[122:123], a[136:137], v[228:231]
    v_max_f32 v192, 0, v192
    v_max_f32 v193, 0, v193
    s_waitcnt lgkmcnt(3)
    v_mfma_f32_16x16x32_bf16 v[208:211], a[56:59], a[48:51], v[208:211]
    v_max_f32 v194, 0, v194
    v_max_f32_e64 v195, 0, v195
    v_mfma_f32_16x16x32_bf16 v[212:215], a[60:63], a[48:51], v[212:215]
    buffer_load_dwordx4 v[60:63], v22, s[20:23], s78 offen offset:1024 sc1
    v_mul_f32 v196, v192, v196
    v_mul_f32 v197, v193, v197
    v_mfma_f32_16x16x32_bf16 v[216:219], a[64:67], a[48:51], v[216:219]
    s_add_u32 s78, s40, 2048
    v_mul_f32 v198, v194, v198
    v_mul_f32 v199, v195, v199
    v_cvt_pk_bf16_f32 v186, v196, v197
    v_mfma_f32_16x16x32_bf16 v[220:223], a[68:71], a[48:51], v[220:223]
    v_cvt_pk_bf16_f32 v187, v198, v199
    ds_read_b128 a[24:27], v7 offset:14336
    v_mfma_f32_16x16x32_bf16 v[224:227], a[72:75], a[48:51], v[224:227]
    buffer_store_dwordx4 v[184:187], v21, s[20:23], s64 offen sc1
    s_add_u32 s64, s64, 75776
    v_max_f32_e64 v200, 0, v200
    v_mfma_f32_16x16x32_bf16 v[228:231], a[76:79], a[48:51], v[228:231]
    v_max_f32 v201, 0, v201
    v_max_f32 v202, 0, v202
    s_waitcnt lgkmcnt(3)
    v_mfma_f32_16x16x32_bf16 v[208:211], a[80:83], a[52:55], v[208:211]
    v_max_f32 v203, 0, v203
    v_mul_f32_e64 v204, v200, v204
    v_mfma_f32_16x16x32_bf16 v[212:215], a[84:87], a[52:55], v[212:215]
    v_mul_f32 v205, v201, v205
    v_mul_f32 v206, v202, v206
    v_mul_f32_e64 v207, v203, v207
    v_mfma_f32_16x16x32_bf16 v[216:219], a[88:91], a[52:55], v[216:219]
    v_cvt_pk_bf16_f32 v178, v204, v205
    v_cvt_pk_bf16_f32 v179, v206, v207
    v_mfma_f32_16x16x32_bf16 v[220:223], a[92:95], a[52:55], v[220:223]
    buffer_load_dwordx4 v[64:67], v21, s[20:23], s78 offen offset:2048 sc1
    v_permlane32_swap_b32 v176, v178
    v_permlane32_swap_b32 v177, v179
    v_mfma_f32_16x16x32_bf16 v[224:227], a[96:99], a[52:55], v[224:227]
    buffer_store_dwordx4 v[176:179], v24, s[20:23], s65 offen sc1
    s_add_u32 s65, s65, 151552
    v_mfma_f32_16x16x32_bf16 v[228:231], a[100:103], a[52:55], v[228:231]
    s_waitcnt lgkmcnt(2)
    v_mfma_f32_16x16x32_bf16 v[208:211], a[0:3], a[104:107], v[208:211]
    v_mfma_f32_16x16x32_bf16 v[212:215], a[4:7], a[104:107], v[212:215]
    buffer_load_dwordx4 v[68:71], v21, s[20:23], s78 offen offset:3072 sc1
    v_mfma_f32_16x16x32_bf16 v[216:219], a[8:11], a[104:107], v[216:219]
    v_mfma_f32_16x16x32_bf16 v[220:223], a[12:15], a[104:107], v[220:223]
    v_mfma_f32_16x16x32_bf16 v[224:227], a[16:19], a[104:107], v[224:227]
    v_mfma_f32_16x16x32_bf16 v[228:231], a[20:23], a[104:107], v[228:231]
    s_waitcnt vmcnt(12)
    s_barrier
    s_cmp_lg_u32 s4, 0
    s_cbranch_scc1 L_f1
    buffer_store_dword v17, v16, s[20:23], s77 offen offset:0 sc1
L_f1:
    v_mfma_f32_16x16x16_bf16 v[232:235], a[112:113], a[138:139], v[232:235]
    s_add_u32 s78, s40, 6144
    ds_read_b128 a[28:31], v12 offset:14336
    v_mfma_f32_16x16x16_bf16 v[236:239], a[114:115], a[138:139], v[236:239]
    v_max_f32 v208, 0, v208
    v_max_f32_e64 v209, 0, v209
    v_mfma_f32_16x16x16_bf16 v[240:243], a[116:117], a[138:139], v[240:243]
    v_max_f32 v210, 0, v210
    v_max_f32 v211, 0, v211
    v_mfma_f32_16x16x16_bf16 v[244:247], a[118:119], a[138:139], v[244:247]
    buffer_load_dwordx4 v[72:75], v21, s[20:23], s78 offen sc1
    v_mul_f32 v212, v208, v212
    v_mul_f32 v213, v209, v213
    v_mfma_f32_16x16x16_bf16 v[248:251], a[120:121], a[138:139], v[248:251]
    v_mul_f32 v214, v210, v214
    v_mul_f32 v215, v211, v215
    v_mfma_f32_16x16x16_bf16 v[252:255], a[122:123], a[138:139], v[252:255]
    v_cvt_pk_bf16_f32 v208, v212, v213
    v_cvt_pk_bf16_f32 v209, v214, v215
    s_waitcnt lgkmcnt(2)
    v_mfma_f32_16x16x32_bf16 v[232:235], a[56:59], a[108:111], v[232:235]
    v_max_f32 v216, 0, v216
    v_max_f32_e64 v217, 0, v217
    v_mfma_f32_16x16x32_bf16 v[236:239], a[60:63], a[108:111], v[236:239]
    buffer_load_dwordx4 v[76:79], v21, s[20:23], s78 offen offset:1024 sc1
    v_max_f32_e64 v218, 0, v218
    v_mfma_f32_16x16x32_bf16 v[240:243], a[64:67], a[108:111], v[240:243]
    v_max_f32 v219, 0, v219
    v_mul_f32 v220, v216, v220
    v_mfma_f32_16x16x32_bf16 v[244:247], a[68:71], a[108:111], v[244:247]
    v_mul_f32 v221, v217, v221
    v_mul_f32 v222, v218, v222
    v_mfma_f32_16x16x32_bf16 v[248:251], a[72:75], a[108:111], v[248:251]
    v_mul_f32_e64 v223, v219, v223
    v_cvt_pk_bf16_f32 v210, v220, v221
    v_mfma_f32_16x16x32_bf16 v[252:255], a[76:79], a[108:111], v[252:255]
    buffer_load_dwordx4 v[80:83], v21, s[20:23], s78 offen offset:2048 sc1
    v_cvt_pk_bf16_f32 v211, v222, v223
    s_waitcnt lgkmcnt(1)
    v_mfma_f32_16x16x32_bf16 v[232:235], a[80:83], a[24:27], v[232:235]
    s_add_u32 s78, s40, 41984
    buffer_store_dwordx4 v[208:211], v21, s[20:23], s64 offen sc1
    v_mfma_f32_16x16x32_bf16 v[236:239], a[84:87], a[24:27], v[236:239]
    s_add_u32 s64, s64, 75776
    v_max_f32 v224, 0, v224
    v_max_f32 v225, 0, v225
    v_max_f32 v226, 0, v226
    v_mfma_f32_16x16x32_bf16 v[240:243], a[88:91], a[24:27], v[240:243]
    v_max_f32 v227, 0, v227
    v_mul_f32 v228, v224, v228
    v_mul_f32_e64 v229, v225, v229
    v_mfma_f32_16x16x32_bf16 v[244:247], a[92:95], a[24:27], v[244:247]
    v_mul_f32 v230, v226, v230
    v_mul_f32 v231, v227, v231
    v_mfma_f32_16x16x32_bf16 v[248:251], a[96:99], a[24:27], v[248:251]
    v_cvt_pk_bf16_f32 v224, v228, v229
    v_cvt_pk_bf16_f32 v225, v230, v231
    v_mfma_f32_16x16x32_bf16 v[252:255], a[100:103], a[24:27], v[252:255]
    s_waitcnt lgkmcnt(0)
    v_mfma_f32_16x16x32_bf16 v[232:235], a[0:3], a[28:31], v[232:235]
    buffer_load_dwordx4 v[84:87], v21, s[20:23], s78 offen offset:3072 sc1
    v_mfma_f32_16x16x32_bf16 v[236:239], a[4:7], a[28:31], v[236:239]
    v_mfma_f32_16x16x32_bf16 v[240:243], a[8:11], a[28:31], v[240:243]
    v_mfma_f32_16x16x32_bf16 v[244:247], a[12:15], a[28:31], v[244:247]
    v_mfma_f32_16x16x32_bf16 v[248:251], a[16:19], a[28:31], v[248:251]
    v_mfma_f32_16x16x32_bf16 v[252:255], a[20:23], a[28:31], v[252:255]
    s_nop 1
    v_max_f32 v232, 0, v232
    v_max_f32 v233, 0, v233
    v_max_f32 v234, 0, v234
    v_max_f32 v235, 0, v235
    v_pk_mul_f32 v[236:237], v[232:233], v[236:237]
    v_pk_mul_f32 v[238:239], v[234:235], v[238:239]
    v_cvt_pk_bf16_f32 v232, v236, v237
    v_cvt_pk_bf16_f32 v233, v238, v239
    v_max_f32 v240, 0, v240
    v_max_f32 v241, 0, v241
    v_max_f32 v242, 0, v242
    v_max_f32 v243, 0, v243
    v_pk_mul_f32 v[244:245], v[240:241], v[244:245]
    v_pk_mul_f32 v[246:247], v[242:243], v[246:247]
    v_cvt_pk_bf16_f32 v234, v244, v245
    v_cvt_pk_bf16_f32 v235, v246, v247
    buffer_store_dwordx4 v[232:235], v21, s[20:23], s64 offen sc1
    s_add_u32 s64, s64, 75776
    v_max_f32 v248, 0, v248
    v_max_f32 v249, 0, v249
    v_max_f32 v250, 0, v250
    v_max_f32 v251, 0, v251
    v_pk_mul_f32 v[252:253], v[248:249], v[252:253]
    v_pk_mul_f32 v[254:255], v[250:251], v[254:255]
    v_cvt_pk_bf16_f32 v226, v252, v253
    v_cvt_pk_bf16_f32 v227, v254, v255
    s_nop 0
    v_permlane32_swap_b32 v224, v226
    v_permlane32_swap_b32_e64 v225, v227
    buffer_store_dwordx4 v[224:227], v24, s[20:23], s65 offen sc1
    s_add_u32 s65, s65, 151552
    s_barrier
    s_nop 0
    s_add_u32 m0, s79, 131072
    s_add_u32 s78, s39, 168960
    buffer_load_dwordx4 v21, s[20:23], s78 offen sc1 lds
    buffer_load_dwordx4 v21, s[20:23], s78 offen offset:1024 sc1 lds
    buffer_load_dwordx4 v21, s[20:23], s78 offen offset:2048 sc1 lds
    buffer_load_dwordx4 v21, s[20:23], s78 offen offset:3072 sc1 lds
    s_add_u32 m0, s79, 98304
    s_add_u32 s78, s39, 208896
    buffer_load_dwordx4 v21, s[20:23], s78 offen sc1 lds
    buffer_load_dwordx4 v21, s[20:23], s78 offen offset:1024 sc1 lds
    buffer_load_dwordx4 v21, s[20:23], s78 offen offset:2048 sc1 lds
    buffer_load_dwordx4 v21, s[20:23], s78 offen offset:3072 sc1 lds
    s_add_u32 s78, s40, 46080
    buffer_load_dwordx4 v[88:91], v21, s[20:23], s78 offen sc1
    buffer_load_dwordx4 v[92:95], v21, s[20:23], s78 offen offset:1024 sc1
    buffer_load_dwordx4 v[96:99], v21, s[20:23], s78 offen offset:2048 sc1
    buffer_load_dwordx4 v[100:103], v21, s[20:23], s78 offen offset:3072 sc1
    buffer_load_dword v15, v23, s[20:23], s52 offen sc1
    s_add_u32 s78, s40, 86016
    buffer_load_dwordx4 v[104:107], v21, s[20:23], s78 offen sc1
    buffer_load_dwordx4 v[108:111], v21, s[20:23], s78 offen offset:1024 sc1
    buffer_load_dwordx4 v[112:115], v21, s[20:23], s78 offen offset:2048 sc1
    buffer_load_dwordx4 v[116:119], v21, s[20:23], s78 offen offset:3072 sc1
    s_waitcnt vmcnt(4)
    s_mov_b32 s7, 0
L_spin_egu:
    v_cmp_eq_u32 vcc, 0, v15
    s_nop 3
    s_cbranch_vccz L_ok_egu
    s_add_u32 s7, s7, 1
    s_cmp_ge_u32 s7, 0x40000
    s_cbranch_scc1 L_ok_egu
    s_sleep 1
    buffer_load_dword v15, v23, s[20:23], s52 offen sc1
    s_waitcnt vmcnt(0)
    s_branch L_spin_egu
L_ok_egu:
    buffer_load_dwordx4 a[0:3], v21, s[20:23], s44 offen offset:0 sc1
    buffer_load_dwordx4 a[4:7], v21, s[20:23], s45 offen offset:0 sc1
    buffer_load_dwordx4 a[8:11], v21, s[20:23], s46 offen offset:0 sc1
    buffer_load_dwordx4 a[12:15], v21, s[20:23], s47 offen offset:0 sc1
    s_barrier
    s_cmp_lg_u32 s4, 0
    s_cbranch_scc1 L_f2gu
    s_nop 0
    buffer_store_dword v17, v16, s[20:23], s77 offen offset:128 sc1
L_f2gu:
    buffer_load_dwordx4 a[16:19], v21, s[20:23], s44 offen offset:1024 sc1
    buffer_load_dwordx4 a[20:23], v21, s[20:23], s45 offen offset:1024 sc1
    buffer_load_dwordx4 a[24:27], v21, s[20:23], s46 offen offset:1024 sc1
    buffer_load_dwordx4 a[28:31], v21, s[20:23], s47 offen offset:1024 sc1
    buffer_load_dwordx4 a[32:35], v21, s[20:23], s44 offen offset:2048 sc1
    buffer_load_dwordx4 a[36:39], v21, s[20:23], s45 offen offset:2048 sc1
    buffer_load_dwordx4 a[40:43], v21, s[20:23], s46 offen offset:2048 sc1
    buffer_load_dwordx4 a[44:47], v21, s[20:23], s47 offen offset:2048 sc1
    s_waitcnt vmcnt(8)
    v_mfma_f32_16x16x32_bf16 v[176:179], a[144:147], a[0:3], 0
    buffer_load_dwordx4 a[48:51], v21, s[20:23], s44 offen offset:3072 sc1
    v_add_u32 v8, s79, v21
    v_mfma_f32_16x16x32_bf16 v[180:183], a[148:151], a[0:3], 0
    v_add_u32 v9, 65536, v8
    v_mfma_f32_16x16x32_bf16 v[184:187], a[152:155], a[0:3], 0
    v_add_u32 v10, 131072, v8
    v_mfma_f32_16x16x32_bf16 v[188:191], a[156:159], a[0:3], 0
    v_min_u32_e64 v1, s55, v0
    v_mfma_f32_16x16x32_bf16 v[192:195], a[160:163], a[0:3], 0
    v_lshlrev_b32_e64 v24, 8, v1
    v_mfma_f32_16x16x32_bf16 v[212:215], a[160:163], a[4:7], 0
    s_mov_b32 s28, s50
    buffer_load_dwordx4 a[52:55], v21, s[20:23], s45 offen offset:3072 sc1
    v_mfma_f32_16x16x32_bf16 v[208:211], a[156:159], a[4:7], 0
    s_and_b32 s29, s51, 0xffff
    v_mfma_f32_16x16x32_bf16 v[204:207], a[152:155], a[4:7], 0
    s_mov_b32 s30, 2621440
    v_mfma_f32_16x16x32_bf16 v[200:203], a[148:151], a[4:7], 0
    s_mov_b32 s31, 0x20000
    v_mfma_f32_16x16x32_bf16 v[196:199], a[144:147], a[4:7], 0
    s_lshl_b32 s64, s36, 2
    v_mfma_f32_16x16x32_bf16 v[216:219], a[144:147], a[8:11], 0
    s_add_u32 s64, s64, s4
    buffer_load_dwordx4 a[56:59], v21, s[20:23], s46 offen offset:3072 sc1
    v_mfma_f32_16x16x32_bf16 v[220:223], a[148:151], a[8:11], 0
    s_lshl_b32 s65, s64, 6
    v_mfma_f32_16x16x32_bf16 v[224:227], a[152:155], a[8:11], 0
    s_add_u32 s65, s65, 22085632
    v_mfma_f32_16x16x32_bf16 v[228:231], a[156:159], a[8:11], 0
    s_mul_i32 s66, s64, 20480
    v_mfma_f32_16x16x32_bf16 v[232:235], a[160:163], a[8:11], 0
    s_mul_i32 s3, s37, 160
    v_mfma_f32_16x16x32_bf16 v[252:255], a[160:163], a[12:15], 0
    s_add_u32 s66, s66, s3
    buffer_load_dwordx4 a[60:63], v21, s[20:23], s47 offen offset:3072 sc1
    v_mfma_f32_16x16x32_bf16 v[248:251], a[156:159], a[12:15], 0
    v_mfma_f32_16x16x32_bf16 v[244:247], a[152:155], a[12:15], 0
    v_and_b32 v1, 15, v0
    v_mfma_f32_16x16x32_bf16 v[240:243], a[148:151], a[12:15], 0
    v_lshrrev_b32_e64 v2, 4, v0
    v_mfma_f32_16x16x32_bf16 v[236:239], a[144:147], a[12:15], 0
    s_waitcnt vmcnt(8)
    v_mfma_f32_16x16x32_bf16 v[176:179], a[164:167], a[16:19], v[176:179]
    s_add_u32 s44, s44, 4096
    v_mul_u32_u24 v37, 160, v1
    v_mfma_f32_16x16x32_bf16 v[180:183], a[168:171], a[16:19], v[180:183]
    v_lshl_add_u32 v37, v2, 3, v37
    v_mfma_f32_16x16x32_bf16 v[184:187], a[172:175], a[16:19], v[184:187]
    buffer_load_dwordx4 a[64:67], v21, s[20:23], s44 offen offset:0 sc1
    v_lshlrev_b32 v38, 2, v1
    v_mfma_f32_16x16x32_bf16 v[188:191], a[176:179], a[16:19], v[188:191]
    s_add_u32 s68, s79, 147456
    v_mfma_f32_16x16x32_bf16 v[192:195], a[180:183], a[16:19], v[192:195]
    s_add_u32 s45, s45, 4096
    v_add_u32_e64 v35, s68, v37
    v_mfma_f32_16x16x32_bf16 v[212:215], a[180:183], a[20:23], v[212:215]
    v_add_u32_e64 v37, s79, v37
    v_mfma_f32_16x16x32_bf16 v[208:211], a[176:179], a[20:23], v[208:211]
    v_add_u32_e64 v1, 0, v0
    v_mfma_f32_16x16x32_bf16 v[204:207], a[172:175], a[20:23], v[204:207]
    buffer_load_dwordx4 a[68:71], v21, s[20:23], s45 offen offset:0 sc1
    v_mul_u32_u24 v2, 205, v1
    v_mfma_f32_16x16x32_bf16 v[200:203], a[168:171], a[20:23], v[200:203]
    s_add_u32 s46, s46, 4096
    v_lshrrev_b32_e64 v2, 11, v2
    v_mfma_f32_16x16x32_bf16 v[196:199], a[164:167], a[20:23], v[196:199]
    v_mfma_f32_16x16x32_bf16 v[216:219], a[164:167], a[24:27], v[216:219]
    v_mul_u32_u24 v3, 1120, v2
    v_mfma_f32_16x16x32_bf16 v[220:223], a[168:171], a[24:27], v[220:223]
    v_lshl_add_u32 v18, v1, 4, v3
    v_mfma_f32_16x16x32_bf16 v[224:227], a[172:175], a[24:27], v[224:227]
    buffer_load_dwordx4 a[72:75], v21, s[20:23], s46 offen offset:0 sc1
    v_add_u32_e64 v1, 64, v0
    v_mfma_f32_16x16x32_bf16 v[228:231], a[176:179], a[24:27], v[228:231]
    s_add_u32 s47, s47, 4096
    v_mul_u32_u24 v2, 205, v1
    v_mfma_f32_16x16x32_bf16 v[232:235], a[180:183], a[24:27], v[232:235]
    v_lshrrev_b32_e64 v2, 11, v2
    v_mfma_f32_16x16x32_bf16 v[252:255], a[180:183], a[28:31], v[252:255]
    v_mul_u32_u24 v3, 1120, v2
    v_mfma_f32_16x16x32_bf16 v[248:251], a[176:179], a[28:31], v[248:251]
    v_lshl_add_u32 v19, v1, 4, v3
    v_mfma_f32_16x16x32_bf16 v[244:247], a[172:175], a[28:31], v[244:247]
    buffer_load_dwordx4 a[76:79], v21, s[20:23], s47 offen offset:0 sc1
    v_add_u32 v1, 128, v0
    v_mfma_f32_16x16x32_bf16 v[240:243], a[168:171], a[28:31], v[240:243]
    v_mul_u32_u24 v2, 205, v1
    v_mfma_f32_16x16x32_bf16 v[236:239], a[164:167], a[28:31], v[236:239]
    s_waitcnt vmcnt(8)
    v_mfma_f32_16x16x32_bf16 v[176:179], a[184:187], a[32:35], v[176:179]
    v_lshrrev_b32 v2, 11, v2
    v_mfma_f32_16x16x32_bf16 v[180:183], a[188:191], a[32:35], v[180:183]
    buffer_load_dword v15, v23, s[20:23], s53 offen sc1
    v_mul_u32_u24 v3, 1120, v2
    v_mfma_f32_16x16x32_bf16 v[184:187], a[192:195], a[32:35], v[184:187]
    v_lshl_add_u32 v20, v1, 4, v3
    v_mfma_f32_16x16x32_bf16 v[188:191], a[196:199], a[32:35], v[188:191]
    v_lshrrev_b32_e64 v2, 4, v2
    v_mfma_f32_16x16x32_bf16 v[192:195], a[200:203], a[32:35], v[192:195]
    v_lshl_add_u32 v20, v2, 30, v20
    v_mfma_f32_16x16x32_bf16 v[212:215], a[200:203], a[36:39], v[212:215]
    s_sub_u32 s3, s4, 1
    buffer_load_dwordx4 a[80:83], v21, s[20:23], s44 offen offset:1024 sc1
    v_mfma_f32_16x16x32_bf16 v[208:211], a[196:199], a[36:39], v[208:211]
    s_and_b32 s3, s3, 3
    v_mfma_f32_16x16x32_bf16 v[204:207], a[192:195], a[36:39], v[204:207]
    s_lshl_b32 s3, s3, 12
    v_mfma_f32_16x16x32_bf16 v[200:203], a[188:191], a[36:39], v[200:203]
    s_add_u32 s3, s3, 0
    v_mfma_f32_16x16x32_bf16 v[196:199], a[184:187], a[36:39], v[196:199]
    buffer_load_dwordx4 a[84:87], v21, s[20:23], s45 offen offset:1024 sc1
    v_mfma_f32_16x16x32_bf16 v[216:219], a[184:187], a[40:43], v[216:219]
    v_add_u32_e64 v4, s3, v21
    v_mfma_f32_16x16x32_bf16 v[220:223], a[188:191], a[40:43], v[220:223]
    s_sub_u32 s3, s4, 2
    v_mfma_f32_16x16x32_bf16 v[224:227], a[192:195], a[40:43], v[224:227]
    s_and_b32 s3, s3, 3
    v_mfma_f32_16x16x32_bf16 v[228:231], a[196:199], a[40:43], v[228:231]
    s_lshl_b32 s3, s3, 12
    buffer_load_dwordx4 a[88:91], v21, s[20:23], s46 offen offset:1024 sc1
    v_mfma_f32_16x16x32_bf16 v[232:235], a[200:203], a[40:43], v[232:235]
    s_add_u32 s3, s3, 1024
    v_mfma_f32_16x16x32_bf16 v[252:255], a[200:203], a[44:47], v[252:255]
    v_add_u32 v5, s3, v21
    v_mfma_f32_16x16x32_bf16 v[248:251], a[196:199], a[44:47], v[248:251]
    s_sub_u32 s3, s4, 3
    v_mfma_f32_16x16x32_bf16 v[244:247], a[192:195], a[44:47], v[244:247]
    s_and_b32 s3, s3, 3
    buffer_load_dwordx4 a[92:95], v21, s[20:23], s47 offen offset:1024 sc1
    v_mfma_f32_16x16x32_bf16 v[240:243], a[188:191], a[44:47], v[240:243]
    s_lshl_b32 s3, s3, 12
    v_mfma_f32_16x16x32_bf16 v[236:239], a[184:187], a[44:47], v[236:239]
    s_waitcnt vmcnt(9)
    v_mfma_f32_16x16x32_bf16 v[176:179], a[204:207], a[48:51], v[176:179]
    s_add_u32 s3, s3, 2048
    s_sub_u32 s44, s44, s41
    v_mfma_f32_16x16x32_bf16 v[180:183], a[208:211], a[48:51], v[180:183]
    buffer_load_dwordx4 a[0:3], v21, s[20:23], s44 offen offset:2048 sc1
    v_add_u32 v6, s3, v21
    v_mfma_f32_16x16x32_bf16 v[184:187], a[212:215], a[48:51], v[184:187]
    s_mul_i32 s3, s4, 15360
    s_sub_u32 s45, s45, s41
    v_mfma_f32_16x16x32_bf16 v[188:191], a[216:219], a[48:51], v[188:191]
    s_add_u32 s3, s3, 81920
    v_mfma_f32_16x16x32_bf16 v[192:195], a[220:223], a[48:51], v[192:195]
    buffer_load_dwordx4 a[4:7], v21, s[20:23], s45 offen offset:2048 sc1
    v_add_u32 v11, s3, v21
    v_mfma_f32_16x16x32_bf16 v[212:215], a[220:223], a[52:55], v[212:215]
    s_sub_u32 s3, s4, 1
    s_sub_u32 s46, s46, s41
    v_mfma_f32_16x16x32_bf16 v[208:211], a[216:219], a[52:55], v[208:211]
    s_and_b32 s3, s3, 3
    buffer_load_dwordx4 a[8:11], v21, s[20:23], s46 offen offset:2048 sc1
    v_mfma_f32_16x16x32_bf16 v[204:207], a[212:215], a[52:55], v[204:207]
    s_mul_i32 s3, s3, 15360
    v_mfma_f32_16x16x32_bf16 v[200:203], a[208:211], a[52:55], v[200:203]
    s_add_u32 s3, s3, 81920
    s_sub_u32 s47, s47, s41
    v_mfma_f32_16x16x32_bf16 v[196:199], a[204:207], a[52:55], v[196:199]
    buffer_load_dwordx4 a[12:15], v21, s[20:23], s47 offen offset:2048 sc1
    v_add_u32_e64 v7, s3, v21
    v_mfma_f32_16x16x32_bf16 v[216:219], a[204:207], a[56:59], v[216:219]
    s_sub_u32 s3, s4, 2
    s_add_u32 s78, s40, 90112
    v_mfma_f32_16x16x32_bf16 v[220:223], a[208:211], a[56:59], v[220:223]
    s_and_b32 s3, s3, 3
    v_mfma_f32_16x16x32_bf16 v[224:227], a[212:215], a[56:59], v[224:227]
    s_mul_i32 s3, s3, 15360
    buffer_load_dwordx4 v[120:123], v21, s[20:23], s78 offen sc1
    v_mfma_f32_16x16x32_bf16 v[228:231], a[216:219], a[56:59], v[228:231]
    s_add_u32 s3, s3, 87040
    s_add_u32 s78, s40, 125952
    v_mfma_f32_16x16x32_bf16 v[232:235], a[220:223], a[56:59], v[232:235]
    buffer_load_dwordx4 v[124:127], v21, s[20:23], s78 offen offset:1024 sc1
    v_add_u32_e64 v25, s3, v21
    v_mfma_f32_16x16x32_bf16 v[252:255], a[220:223], a[60:63], v[252:255]
    s_sub_u32 s3, s4, 3
    v_mfma_f32_16x16x32_bf16 v[248:251], a[216:219], a[60:63], v[248:251]
    s_and_b32 s3, s3, 3
    buffer_load_dwordx4 v[128:131], v21, s[20:23], s78 offen offset:2048 sc1
    v_mfma_f32_16x16x32_bf16 v[244:247], a[212:215], a[60:63], v[244:247]
    s_mul_i32 s3, s3, 15360
    v_mfma_f32_16x16x32_bf16 v[240:243], a[208:211], a[60:63], v[240:243]
    s_add_u32 s3, s3, 92160
    buffer_load_dwordx4 v[132:135], v21, s[20:23], s78 offen offset:3072 sc1
    v_mfma_f32_16x16x32_bf16 v[236:239], a[204:207], a[60:63], v[236:239]
L_isl_gu_5:
    s_cbranch_execz L_warm_gu_0
    v_add_u32 v34, s3, v21
    s_waitcnt vmcnt(12)
    v_cmp_eq_u32 vcc, 0, v15
    v_mfma_f32_16x16x32_bf16 v[176:179], a[224:227], a[64:67], v[176:179]
    v_mfma_f32_16x16x32_bf16 v[180:183], a[228:231], a[64:67], v[180:183]
    ds_read_b128 v[168:171], v9 offset:49152
    s_cbranch_vccnz L_slow_lgu
L_ok_lgu:
    v_mfma_f32_16x16x32_bf16 v[184:187], a[232:235], a[64:67], v[184:187]
    s_add_u32 s44, s44, s48
    v_mfma_f32_16x16x32_bf16 v[188:191], a[236:239], a[64:67], v[188:191]
    v_mfma_f32_16x16x32_bf16 v[192:195], a[240:243], a[64:67], v[192:195]
    buffer_load_dwordx4 a[16:19], v21, s[20:23], s44 offen offset:0 sc1
    v_mfma_f32_16x16x32_bf16 v[212:215], a[240:243], a[68:71], v[212:215]
    s_add_u32 s45, s45, s48
    v_mfma_f32_16x16x32_bf16 v[208:211], a[236:239], a[68:71], v[208:211]
    v_mfma_f32_16x16x32_bf16 v[204:207], a[232:235], a[68:71], v[204:207]
    ds_read_b128 v[172:175], v9 offset:50176
    v_mfma_f32_16x16x32_bf16 v[200:203], a[228:231], a[68:71], v[200:203]
    v_mfma_f32_16x16x32_bf16 v[196:199], a[224:227], a[68:71], v[196:199]
    buffer_load_dwordx4 a[20:23], v21, s[20:23], s45 offen offset:0 sc1
    v_mfma_f32_16x16x32_bf16 v[216:219], a[224:227], a[72:75], v[216:219]
    s_add_u32 s46, s46, s48
    v_mfma_f32_16x16x32_bf16 v[220:223], a[228:231], a[72:75], v[220:223]
    v_mfma_f32_16x16x32_bf16 v[224:227], a[232:235], a[72:75], v[224:227]
    v_mfma_f32_16x16x32_bf16 v[228:231], a[236:239], a[72:75], v[228:231]
    v_mfma_f32_16x16x32_bf16 v[232:235], a[240:243], a[72:75], v[232:235]
    buffer_load_dwordx4 a[24:27], v21, s[20:23], s46 offen offset:0 sc1
    s_add_u32 s47, s47, s48
    v_mfma_f32_16x16x32_bf16 v[252:255], a[240:243], a[76:79], v[252:255]
    v_mfma_f32_16x16x32_bf16 v[248:251], a[236:239], a[76:79], v[248:251]
    v_mfma_f32_16x16x32_bf16 v[244:247], a[232:235], a[76:79], v[244:247]
    v_mfma_f32_16x16x32_bf16 v[240:243], a[228:231], a[76:79], v[240:243]
    buffer_load_dwordx4 a[28:31], v21, s[20:23], s47 offen offset:0 sc1
    v_mfma_f32_16x16x32_bf16 v[236:239], a[224:227], a[76:79], v[236:239]
    s_waitcnt vmcnt(12) lgkmcnt(0)
    v_mfma_f32_16x16x32_bf16 v[176:179], a[244:247], a[80:83], v[176:179]
    v_mfma_f32_16x16x32_bf16 v[180:183], a[248:251], a[80:83], v[180:183]
    ds_read_b128 v[136:139], v9 offset:51200
    v_mfma_f32_16x16x32_bf16 v[184:187], a[252:255], a[80:83], v[184:187]
    v_mfma_f32_16x16x32_bf16 v[188:191], v[168:171], a[80:83], v[188:191]
    buffer_load_dwordx4 a[32:35], v21, s[20:23], s44 offen offset:1024 sc1
    ds_read_b128 v[140:143], v9 offset:52224
    v_mfma_f32_16x16x32_bf16 v[192:195], v[172:175], a[80:83], v[192:195]
    v_mfma_f32_16x16x32_bf16 v[212:215], v[172:175], a[84:87], v[212:215]
    v_mfma_f32_16x16x32_bf16 v[208:211], v[168:171], a[84:87], v[208:211]
    ds_read_b128 v[144:147], v8 offset:0
    v_mfma_f32_16x16x32_bf16 v[204:207], a[252:255], a[84:87], v[204:207]
    v_mfma_f32_16x16x32_bf16 v[200:203], a[248:251], a[84:87], v[200:203]
    buffer_load_dwordx4 a[36:39], v21, s[20:23], s45 offen offset:1024 sc1
    ds_read_b128 v[148:151], v8 offset:1024
    v_mfma_f32_16x16x32_bf16 v[196:199], a[244:247], a[84:87], v[196:199]
    v_mfma_f32_16x16x32_bf16 v[216:219], a[244:247], a[88:91], v[216:219]
    v_mfma_f32_16x16x32_bf16 v[220:223], a[248:251], a[88:91], v[220:223]
    ds_read_b128 v[152:155], v8 offset:2048
    v_mfma_f32_16x16x32_bf16 v[224:227], a[252:255], a[88:91], v[224:227]
    v_mfma_f32_16x16x32_bf16 v[228:231], v[168:171], a[88:91], v[228:231]
    buffer_load_dwordx4 a[40:43], v21, s[20:23], s46 offen offset:1024 sc1
    v_mfma_f32_16x16x32_bf16 v[232:235], v[172:175], a[88:91], v[232:235]
    v_mfma_f32_16x16x32_bf16 v[252:255], v[172:175], a[92:95], v[252:255]
    v_mfma_f32_16x16x32_bf16 v[248:251], v[168:171], a[92:95], v[248:251]
    v_mfma_f32_16x16x32_bf16 v[244:247], a[252:255], a[92:95], v[244:247]
    v_mfma_f32_16x16x32_bf16 v[240:243], a[248:251], a[92:95], v[240:243]
    buffer_load_dwordx4 a[44:47], v21, s[20:23], s47 offen offset:1024 sc1
    v_mfma_f32_16x16x32_bf16 v[236:239], a[244:247], a[92:95], v[236:239]
    s_waitcnt vmcnt(12) lgkmcnt(0)
    v_mfma_f32_16x16x32_bf16 v[176:179], v[136:139], a[0:3], v[176:179]
    buffer_load_dwordx4 a[48:51], v21, s[20:23], s44 offen offset:2048 sc1
    v_mfma_f32_16x16x32_bf16 v[180:183], v[140:143], a[0:3], v[180:183]
    ds_read_b128 v[156:159], v8 offset:3072
    v_mfma_f32_16x16x32_bf16 v[184:187], v[144:147], a[0:3], v[184:187]
    buffer_load_dwordx4 a[52:55], v21, s[20:23], s45 offen offset:2048 sc1
    v_mfma_f32_16x16x32_bf16 v[188:191], v[148:151], a[0:3], v[188:191]
    ds_read_b128 v[160:163], v8 offset:16384
    v_mfma_f32_16x16x32_bf16 v[192:195], v[152:155], a[0:3], v[192:195]
    buffer_load_dwordx4 a[56:59], v21, s[20:23], s46 offen offset:2048 sc1
    v_mfma_f32_16x16x32_bf16 v[212:215], v[152:155], a[4:7], v[212:215]
    v_mfma_f32_16x16x32_bf16 v[208:211], v[148:151], a[4:7], v[208:211]
    buffer_load_dwordx4 a[60:63], v21, s[20:23], s47 offen offset:2048 sc1
    ds_read_b128 v[164:167], v8 offset:17408
    v_mfma_f32_16x16x32_bf16 v[204:207], v[144:147], a[4:7], v[204:207]
    s_add_u32 s78, s40, 130048
    v_mfma_f32_16x16x32_bf16 v[200:203], v[140:143], a[4:7], v[200:203]
    ds_read_b128 v[168:171], v8 offset:18432
    v_mfma_f32_16x16x32_bf16 v[196:199], v[136:139], a[4:7], v[196:199]
    buffer_load_dwordx4 a[96:99], v21, s[20:23], s78 offen sc1
    v_mfma_f32_16x16x32_bf16 v[216:219], v[136:139], a[8:11], v[216:219]
    v_mfma_f32_16x16x32_bf16 v[220:223], v[140:143], a[8:11], v[220:223]
    buffer_load_dwordx4 a[100:103], v21, s[20:23], s78 offen offset:1024 sc1
    ds_read_b128 v[172:175], v8 offset:19456
    v_mfma_f32_16x16x32_bf16 v[224:227], v[144:147], a[8:11], v[224:227]
    s_add_u32 s78, s40, 165888
    v_mfma_f32_16x16x32_bf16 v[228:231], v[148:151], a[8:11], v[228:231]
    v_mfma_f32_16x16x32_bf16 v[232:235], v[152:155], a[8:11], v[232:235]
    v_mfma_f32_16x16x32_bf16 v[252:255], v[152:155], a[12:15], v[252:255]
    buffer_load_dwordx4 a[104:107], v21, s[20:23], s78 offen offset:2048 sc1
    v_mfma_f32_16x16x32_bf16 v[248:251], v[148:151], a[12:15], v[248:251]
    v_mfma_f32_16x16x32_bf16 v[244:247], v[144:147], a[12:15], v[244:247]
    buffer_load_dwordx4 a[108:111], v21, s[20:23], s78 offen offset:3072 sc1
    v_mfma_f32_16x16x32_bf16 v[240:243], v[140:143], a[12:15], v[240:243]
    v_mfma_f32_16x16x32_bf16 v[236:239], v[136:139], a[12:15], v[236:239]
    s_waitcnt vmcnt(12) lgkmcnt(0)
    v_mfma_f32_16x16x32_bf16 v[176:179], v[156:159], a[16:19], v[176:179]
    v_mfma_f32_16x16x32_bf16 v[180:183], v[160:163], a[16:19], v[180:183]
    ds_read_b128 v[136:139], v8 offset:32768
    v_mfma_f32_16x16x32_bf16 v[184:187], v[164:167], a[16:19], v[184:187]
    buffer_load_dwordx4 a[64:67], v21, s[20:23], s44 offen offset:3072 sc1
    v_mfma_f32_16x16x32_bf16 v[188:191], v[168:171], a[16:19], v[188:191]
    ds_read_b128 v[140:143], v8 offset:33792
    v_mfma_f32_16x16x32_bf16 v[192:195], v[172:175], a[16:19], v[192:195]
    v_mfma_f32_16x16x32_bf16 v[212:215], v[172:175], a[20:23], v[212:215]
    v_mfma_f32_16x16x32_bf16 v[208:211], v[168:171], a[20:23], v[208:211]
    ds_read_b128 v[144:147], v8 offset:34816
    v_mfma_f32_16x16x32_bf16 v[204:207], v[164:167], a[20:23], v[204:207]
    buffer_load_dwordx4 a[68:71], v21, s[20:23], s45 offen offset:3072 sc1
    v_mfma_f32_16x16x32_bf16 v[200:203], v[160:163], a[20:23], v[200:203]
    ds_read_b128 v[148:151], v8 offset:35840
    v_mfma_f32_16x16x32_bf16 v[196:199], v[156:159], a[20:23], v[196:199]
    v_mfma_f32_16x16x32_bf16 v[216:219], v[156:159], a[24:27], v[216:219]
    v_mfma_f32_16x16x32_bf16 v[220:223], v[160:163], a[24:27], v[220:223]
    ds_read_b128 v[152:155], v8 offset:49152
    v_mfma_f32_16x16x32_bf16 v[224:227], v[164:167], a[24:27], v[224:227]
    buffer_load_dwordx4 a[72:75], v21, s[20:23], s46 offen offset:3072 sc1
    v_mfma_f32_16x16x32_bf16 v[228:231], v[168:171], a[24:27], v[228:231]
    v_mfma_f32_16x16x32_bf16 v[232:235], v[172:175], a[24:27], v[232:235]
    v_mfma_f32_16x16x32_bf16 v[252:255], v[172:175], a[28:31], v[252:255]
    v_mfma_f32_16x16x32_bf16 v[248:251], v[168:171], a[28:31], v[248:251]
    v_mfma_f32_16x16x32_bf16 v[244:247], v[164:167], a[28:31], v[244:247]
    buffer_load_dwordx4 a[76:79], v21, s[20:23], s47 offen offset:3072 sc1
    v_mfma_f32_16x16x32_bf16 v[240:243], v[160:163], a[28:31], v[240:243]
    v_mfma_f32_16x16x32_bf16 v[236:239], v[156:159], a[28:31], v[236:239]
    s_waitcnt vmcnt(12) lgkmcnt(0)
    v_mfma_f32_16x16x32_bf16 v[176:179], v[136:139], a[32:35], v[176:179]
    s_add_u32 s45, s45, 4096
    v_mfma_f32_16x16x32_bf16 v[180:183], v[140:143], a[32:35], v[180:183]
    ds_read_b128 v[156:159], v8 offset:50176
    v_mfma_f32_16x16x32_bf16 v[184:187], v[144:147], a[32:35], v[184:187]
    buffer_load_dwordx4 a[80:83], v21, s[20:23], s45 offen offset:0 sc1
    v_mfma_f32_16x16x32_bf16 v[188:191], v[148:151], a[32:35], v[188:191]
    ds_read_b128 v[160:163], v8 offset:51200
    v_mfma_f32_16x16x32_bf16 v[192:195], v[152:155], a[32:35], v[192:195]
    v_mfma_f32_16x16x32_bf16 v[212:215], v[152:155], a[36:39], v[212:215]
    v_mfma_f32_16x16x32_bf16 v[208:211], v[148:151], a[36:39], v[208:211]
    ds_read_b128 v[164:167], v8 offset:52224
    v_mfma_f32_16x16x32_bf16 v[204:207], v[144:147], a[36:39], v[204:207]
    buffer_load_dwordx4 a[84:87], v21, s[20:23], s45 offen offset:1024 sc1
    v_mfma_f32_16x16x32_bf16 v[200:203], v[140:143], a[36:39], v[200:203]
    s_sub_u32 s45, s45, s41
    ds_read_b128 v[168:171], v9 offset:0
    v_mfma_f32_16x16x32_bf16 v[196:199], v[136:139], a[36:39], v[196:199]
    v_mfma_f32_16x16x32_bf16 v[216:219], v[136:139], a[40:43], v[216:219]
    v_mfma_f32_16x16x32_bf16 v[220:223], v[140:143], a[40:43], v[220:223]
    ds_read_b128 v[172:175], v9 offset:1024
    v_mfma_f32_16x16x32_bf16 v[224:227], v[144:147], a[40:43], v[224:227]
    buffer_load_dwordx4 a[88:91], v21, s[20:23], s45 offen offset:2048 sc1
    v_mfma_f32_16x16x32_bf16 v[228:231], v[148:151], a[40:43], v[228:231]
    s_add_u32 s46, s46, 4096
    v_mfma_f32_16x16x32_bf16 v[232:235], v[152:155], a[40:43], v[232:235]
    v_mfma_f32_16x16x32_bf16 v[252:255], v[152:155], a[44:47], v[252:255]
    v_mfma_f32_16x16x32_bf16 v[248:251], v[148:151], a[44:47], v[248:251]
    v_mfma_f32_16x16x32_bf16 v[244:247], v[144:147], a[44:47], v[244:247]
    buffer_load_dwordx4 a[92:95], v21, s[20:23], s46 offen offset:0 sc1
    v_mfma_f32_16x16x32_bf16 v[240:243], v[140:143], a[44:47], v[240:243]
    v_mfma_f32_16x16x32_bf16 v[236:239], v[136:139], a[44:47], v[236:239]
    s_waitcnt vmcnt(12) lgkmcnt(0)
    v_mfma_f32_16x16x32_bf16 v[176:179], v[156:159], a[48:51], v[176:179]
    buffer_load_dword v15, v24, s[20:23], s54 offen sc1
    v_mfma_f32_16x16x32_bf16 v[180:183], v[160:163], a[48:51], v[180:183]
    ds_read_b128 v[136:139], v9 offset:2048
    v_mfma_f32_16x16x32_bf16 v[184:187], v[164:167], a[48:51], v[184:187]
    buffer_load_dwordx4 a[0:3], v21, s[20:23], s46 offen offset:1024 sc1
    v_mfma_f32_16x16x32_bf16 v[188:191], v[168:171], a[48:51], v[188:191]
    s_sub_u32 s46, s46, s41
    ds_read_b128 v[140:143], v9 offset:3072
    v_mfma_f32_16x16x32_bf16 v[192:195], v[172:175], a[48:51], v[192:195]
    buffer_load_dwordx4 a[4:7], v21, s[20:23], s46 offen offset:2048 sc1
    v_mfma_f32_16x16x32_bf16 v[212:215], v[172:175], a[52:55], v[212:215]
    s_add_u32 s47, s47, 4096
    v_mfma_f32_16x16x32_bf16 v[208:211], v[168:171], a[52:55], v[208:211]
    ds_read_b128 v[144:147], v9 offset:16384
    v_mfma_f32_16x16x32_bf16 v[204:207], v[164:167], a[52:55], v[204:207]
    buffer_load_dwordx4 a[8:11], v21, s[20:23], s47 offen offset:0 sc1
    v_mfma_f32_16x16x32_bf16 v[200:203], v[160:163], a[52:55], v[200:203]
    ds_read_b128 v[148:151], v9 offset:17408
    v_mfma_f32_16x16x32_bf16 v[196:199], v[156:159], a[52:55], v[196:199]
    buffer_load_dwordx4 a[12:15], v21, s[20:23], s47 offen offset:1024 sc1
    v_mfma_f32_16x16x32_bf16 v[216:219], v[156:159], a[56:59], v[216:219]
    s_add_u32 s78, s40, 169984
    v_mfma_f32_16x16x32_bf16 v[220:223], v[160:163], a[56:59], v[220:223]
    ds_read_b128 v[152:155], v9 offset:18432
    v_mfma_f32_16x16x32_bf16 v[224:227], v[164:167], a[56:59], v[224:227]
    buffer_load_dwordx4 a[112:115], v21, s[20:23], s78 offen sc1
    v_mfma_f32_16x16x32_bf16 v[228:231], v[168:171], a[56:59], v[228:231]
    v_mfma_f32_16x16x32_bf16 v[232:235], v[172:175], a[56:59], v[232:235]
    buffer_load_dwordx4 a[116:119], v21, s[20:23], s78 offen offset:1024 sc1
    v_mfma_f32_16x16x32_bf16 v[252:255], v[172:175], a[60:63], v[252:255]
    v_mfma_f32_16x16x32_bf16 v[248:251], v[168:171], a[60:63], v[248:251]
    buffer_load_dwordx4 a[120:123], v21, s[20:23], s78 offen offset:2048 sc1
    v_mfma_f32_16x16x32_bf16 v[244:247], v[164:167], a[60:63], v[244:247]
    v_mfma_f32_16x16x32_bf16 v[240:243], v[160:163], a[60:63], v[240:243]
    buffer_load_dword v36, v38, s[20:23], s65 offen sc1
    v_mfma_f32_16x16x32_bf16 v[236:239], v[156:159], a[60:63], v[236:239]
    s_waitcnt vmcnt(13) lgkmcnt(0)
    v_mfma_f32_16x16x32_bf16 v[176:179], v[136:139], a[64:67], v[176:179]
    s_sub_u32 s47, s47, s41
    v_mfma_f32_16x16x32_bf16 v[180:183], v[140:143], a[64:67], v[180:183]
    ds_read_b128 v[156:159], v9 offset:19456
    v_mfma_f32_16x16x32_bf16 v[184:187], v[144:147], a[64:67], v[184:187]
    v_mfma_f32_16x16x32_bf16 v[188:191], v[148:151], a[64:67], v[188:191]
    buffer_load_dwordx4 a[16:19], v21, s[20:23], s47 offen offset:2048 sc1
    ds_read_b128 v[160:163], v10 offset:0
    v_mfma_f32_16x16x32_bf16 v[192:195], v[152:155], a[64:67], v[192:195]
    s_add_u32 s44, s44, 4096
    v_mfma_f32_16x16x32_bf16 v[212:215], v[152:155], a[68:71], v[212:215]
    v_mfma_f32_16x16x32_bf16 v[208:211], v[148:151], a[68:71], v[208:211]
    ds_read_b128 v[164:167], v10 offset:1024
    v_mfma_f32_16x16x32_bf16 v[204:207], v[144:147], a[68:71], v[204:207]
    v_mfma_f32_16x16x32_bf16 v[200:203], v[140:143], a[68:71], v[200:203]
    buffer_load_dwordx4 a[20:23], v21, s[20:23], s44 offen offset:0 sc1
    ds_read_b128 v[168:171], v10 offset:2048
    v_mfma_f32_16x16x32_bf16 v[196:199], v[136:139], a[68:71], v[196:199]
    v_mfma_f32_16x16x32_bf16 v[216:219], v[136:139], a[72:75], v[216:219]
    v_mfma_f32_16x16x32_bf16 v[220:223], v[140:143], a[72:75], v[220:223]
    ds_read_b128 v[172:175], v10 offset:3072
    v_mfma_f32_16x16x32_bf16 v[224:227], v[144:147], a[72:75], v[224:227]
    v_mfma_f32_16x16x32_bf16 v[228:231], v[148:151], a[72:75], v[228:231]
    buffer_load_dwordx4 a[24:27], v21, s[20:23], s44 offen offset:1024 sc1
    s_sub_u32 s44, s44, s41
    v_mfma_f32_16x16x32_bf16 v[232:235], v[152:155], a[72:75], v[232:235]
    v_mfma_f32_16x16x32_bf16 v[252:255], v[152:155], a[76:79], v[252:255]
    v_mfma_f32_16x16x32_bf16 v[248:251], v[148:151], a[76:79], v[248:251]
    v_mfma_f32_16x16x32_bf16 v[244:247], v[144:147], a[76:79], v[244:247]
    v_mfma_f32_16x16x32_bf16 v[240:243], v[140:143], a[76:79], v[240:243]
    buffer_load_dwordx4 a[28:31], v21, s[20:23], s44 offen offset:2048 sc1
    v_mfma_f32_16x16x32_bf16 v[236:239], v[136:139], a[76:79], v[236:239]
    s_waitcnt vmcnt(12) lgkmcnt(0)
    v_cmp_eq_u32_e64 vcc, 0, v15
    v_mfma_f32_16x16x32_bf16 v[196:199], v[156:159], a[80:83], v[196:199]
    ds_read_b128 v[136:139], v9 offset:32768
    v_mfma_f32_16x16x32_bf16 v[200:203], v[160:163], a[80:83], v[200:203]
    ds_read_b128 v[140:143], v9 offset:33792
    s_cbranch_vccnz L_slow_ogu
L_ok_ogu:
    v_mfma_f32_16x16x32_bf16 v[204:207], v[164:167], a[80:83], v[204:207]
    s_add_u32 s45, s45, s49
    ds_read_b128 v[144:147], v9 offset:34816
    v_mfma_f32_16x16x32_bf16 v[208:211], v[168:171], a[80:83], v[208:211]
    ds_read_b128 v[148:151], v9 offset:35840
    v_mfma_f32_16x16x32_bf16 v[212:215], v[172:175], a[80:83], v[212:215]
    buffer_load_dwordx4 a[32:35], v21, s[20:23], s45 offen offset:0 sc1
    v_mfma_f32_16x16x32_bf16 v[196:199], v[44:47], a[88:91], v[196:199]
    v_mfma_f32_16x16x32_bf16 v[200:203], v[48:51], a[88:91], v[200:203]
    v_mfma_f32_16x16x32_bf16 v[204:207], v[52:55], a[88:91], v[204:207]
    buffer_load_dwordx4 a[36:39], v21, s[20:23], s45 offen offset:1024 sc1
    v_mfma_f32_16x16x32_bf16 v[208:211], v[56:59], a[88:91], v[208:211]
    v_mfma_f32_16x16x32_bf16 v[212:215], v[60:63], a[88:91], v[212:215]
    s_waitcnt lgkmcnt(0)
    v_mfma_f32_16x16x32_bf16 v[196:199], v[136:139], a[84:87], v[196:199]
    buffer_load_dwordx4 a[40:43], v21, s[20:23], s45 offen offset:2048 sc1
    v_mfma_f32_16x16x32_bf16 v[200:203], v[140:143], a[84:87], v[200:203]
    v_mfma_f32_16x16x32_bf16 v[204:207], v[144:147], a[84:87], v[204:207]
    v_mfma_f32_16x16x32_bf16 v[208:211], v[148:151], a[84:87], v[208:211]
    buffer_load_dwordx4 a[44:47], v21, s[20:23], s45 offen offset:3072 sc1
    v_mfma_f32_16x16x32_bf16 v[212:215], v[40:43], a[84:87], v[212:215]
    v_mfma_f32_16x16x32_bf16 v[216:219], v[156:159], a[92:95], v[216:219]
    s_add_u32 s45, s45, 4096
    v_mfma_f32_16x16x32_bf16 v[220:223], v[160:163], a[92:95], v[220:223]
    ds_write_b128 v8, v[196:199] offset:0
    v_mfma_f32_16x16x32_bf16 v[224:227], v[164:167], a[92:95], v[224:227]
    buffer_load_dwordx4 a[48:51], v21, s[20:23], s45 offen offset:0 sc1
    v_mfma_f32_16x16x32_bf16 v[228:231], v[168:171], a[92:95], v[228:231]
    s_add_u32 s46, s46, s49
    ds_write_b128 v8, v[200:203] offset:16384
    v_mfma_f32_16x16x32_bf16 v[232:235], v[172:175], a[92:95], v[232:235]
    s_waitcnt vmcnt(13)
    v_mfma_f32_16x16x32_bf16 v[216:219], v[136:139], a[0:3], v[216:219]
    v_mfma_f32_16x16x32_bf16 v[220:223], v[140:143], a[0:3], v[220:223]
    ds_write_b128 v8, v[204:207] offset:32768
    v_mfma_f32_16x16x32_bf16 v[224:227], v[144:147], a[0:3], v[224:227]
    buffer_load_dwordx4 a[52:55], v21, s[20:23], s46 offen offset:0 sc1
    v_mfma_f32_16x16x32_bf16 v[228:231], v[148:151], a[0:3], v[228:231]
    ds_write_b128 v8, v[208:211] offset:49152
    v_mfma_f32_16x16x32_bf16 v[232:235], v[40:43], a[0:3], v[232:235]
    v_mfma_f32_16x16x32_bf16 v[216:219], v[44:47], a[4:7], v[216:219]
    buffer_load_dwordx4 a[56:59], v21, s[20:23], s46 offen offset:1024 sc1
    v_mfma_f32_16x16x32_bf16 v[220:223], v[48:51], a[4:7], v[220:223]
    ds_write_b128 v9, v[212:215] offset:0
    v_mfma_f32_16x16x32_bf16 v[224:227], v[52:55], a[4:7], v[224:227]
    v_mfma_f32_16x16x32_bf16 v[228:231], v[56:59], a[4:7], v[228:231]
    buffer_load_dwordx4 a[60:63], v21, s[20:23], s46 offen offset:2048 sc1
    v_mfma_f32_16x16x32_bf16 v[232:235], v[60:63], a[4:7], v[232:235]
    v_mfma_f32_16x16x32_bf16 v[236:239], v[156:159], a[8:11], v[236:239]
    s_waitcnt vmcnt(12)
    v_mfma_f32_16x16x32_bf16 v[240:243], v[160:163], a[8:11], v[240:243]
    buffer_load_dwordx4 a[64:67], v21, s[20:23], s46 offen offset:3072 sc1
    ds_write_b128 v8, v[216:219] offset:1024
    v_mfma_f32_16x16x32_bf16 v[244:247], v[164:167], a[8:11], v[244:247]
    s_add_u32 s46, s46, 4096
    v_mfma_f32_16x16x32_bf16 v[248:251], v[168:171], a[8:11], v[248:251]
    v_mul_f32_e64 v36, v36, v36
    ds_write_b128 v8, v[220:223] offset:17408
    v_mfma_f32_16x16x32_bf16 v[252:255], v[172:175], a[8:11], v[252:255]
    buffer_load_dwordx4 a[68:71], v21, s[20:23], s46 offen offset:0 sc1
    v_mfma_f32_16x16x32_bf16 v[236:239], v[136:139], a[12:15], v[236:239]
    s_add_u32 s47, s47, s49
    v_mfma_f32_16x16x32_bf16 v[240:243], v[140:143], a[12:15], v[240:243]
    ds_write_b128 v8, v[224:227] offset:33792
    v_mfma_f32_16x16x32_bf16 v[244:247], v[144:147], a[12:15], v[244:247]
    v_mul_f32 v38, 0xbfb8aa3b, v36
    v_mfma_f32_16x16x32_bf16 v[248:251], v[148:151], a[12:15], v[248:251]
    ds_write_b128 v8, v[228:231] offset:50176
    v_mfma_f32_16x16x32_bf16 v[252:255], v[40:43], a[12:15], v[252:255]
    buffer_load_dwordx4 a[72:75], v21, s[20:23], s47 offen offset:0 sc1
    s_waitcnt vmcnt(11)
    v_mfma_f32_16x16x32_bf16 v[236:239], v[44:47], a[16:19], v[236:239]
    v_mfma_f32_16x16x32_bf16 v[240:243], v[48:51], a[16:19], v[240:243]
    ds_write_b128 v9, v[232:235] offset:1024
    v_mfma_f32_16x16x32_bf16 v[244:247], v[52:55], a[16:19], v[244:247]
    buffer_load_dwordx4 a[76:79], v21, s[20:23], s47 offen offset:1024 sc1
    v_mfma_f32_16x16x32_bf16 v[248:251], v[56:59], a[16:19], v[248:251]
    v_rcp_f32_e64 v36, v36
    v_mfma_f32_16x16x32_bf16 v[252:255], v[60:63], a[16:19], v[252:255]
    v_mfma_f32_16x16x32_bf16 v[176:179], v[156:159], a[20:23], v[176:179]
    buffer_load_dwordx4 a[80:83], v21, s[20:23], s47 offen offset:2048 sc1
    v_mfma_f32_16x16x32_bf16 v[180:183], v[160:163], a[20:23], v[180:183]
    ds_write_b128 v8, v[236:239] offset:2048
    v_mfma_f32_16x16x32_bf16 v[184:187], v[164:167], a[20:23], v[184:187]
    v_mfma_f32_16x16x32_bf16 v[188:191], v[168:171], a[20:23], v[188:191]
    buffer_load_dwordx4 a[84:87], v21, s[20:23], s47 offen offset:3072 sc1
    ds_write_b128 v8, v[240:243] offset:18432
    v_mfma_f32_16x16x32_bf16 v[192:195], v[172:175], a[20:23], v[192:195]
    s_add_u32 s47, s47, 4096
    v_mfma_f32_16x16x32_bf16 v[176:179], v[136:139], a[24:27], v[176:179]
    v_mfma_f32_16x16x32_bf16 v[180:183], v[140:143], a[24:27], v[180:183]
    ds_write_b128 v8, v[244:247] offset:34816
    v_mfma_f32_16x16x32_bf16 v[184:187], v[144:147], a[24:27], v[184:187]
    buffer_load_dwordx4 a[88:91], v21, s[20:23], s47 offen offset:0 sc1
    v_mfma_f32_16x16x32_bf16 v[188:191], v[148:151], a[24:27], v[188:191]
    s_add_u32 s44, s44, s49
    ds_write_b128 v8, v[248:251] offset:51200
    v_mfma_f32_16x16x32_bf16 v[192:195], v[40:43], a[24:27], v[192:195]
    v_mfma_f32_16x16x32_bf16 v[176:179], v[44:47], a[28:31], v[176:179]
    v_mfma_f32_16x16x32_bf16 v[180:183], v[48:51], a[28:31], v[180:183]
    buffer_load_dwordx4 a[92:95], v21, s[20:23], s44 offen offset:0 sc1
    ds_write_b128 v9, v[252:255] offset:2048
    v_mfma_f32_16x16x32_bf16 v[184:187], v[52:55], a[28:31], v[184:187]
    v_mfma_f32_16x16x32_bf16 v[188:191], v[56:59], a[28:31], v[188:191]
    v_mfma_f32_16x16x32_bf16 v[192:195], v[60:63], a[28:31], v[192:195]
    s_waitcnt vmcnt(12)
    v_mfma_f32_16x16x32_bf16 a[144:147], v[64:67], a[32:35], 0
    v_mfma_f32_16x16x32_bf16 a[148:151], v[68:71], a[32:35], 0
    v_mfma_f32_16x16x32_bf16 a[152:155], v[72:75], a[32:35], 0
    v_mfma_f32_16x16x32_bf16 a[156:159], v[76:79], a[32:35], 0
    v_mfma_f32_16x16x32_bf16 a[160:163], v[80:83], a[32:35], 0
    v_mfma_f32_16x16x32_bf16 a[160:163], v[100:103], a[36:39], a[160:163]
    s_waitcnt lgkmcnt(0)
    s_barrier
    v_mfma_f32_16x16x32_bf16 a[156:159], v[96:99], a[36:39], a[156:159]
    buffer_load_dwordx4 a[0:3], v21, s[20:23], s44 offen offset:1024 sc1
    ds_read_b128 v[196:199], v4 offset:0
    v_mfma_f32_16x16x32_bf16 a[152:155], v[92:95], a[36:39], a[152:155]
    ds_read_b128 v[216:219], v5 offset:0
    v_mfma_f32_16x16x32_bf16 a[148:151], v[88:91], a[36:39], a[148:151]
    ds_read_b128 v[236:239], v6 offset:0
    v_mfma_f32_16x16x32_bf16 a[144:147], v[84:87], a[36:39], a[144:147]
    ds_read_b128 v[200:203], v4 offset:16384
    v_mfma_f32_16x16x32_bf16 a[144:147], v[104:107], a[40:43], a[144:147]
    buffer_load_dwordx4 a[4:7], v21, s[20:23], s44 offen offset:2048 sc1
    ds_read_b128 v[220:223], v5 offset:16384
    v_mfma_f32_16x16x32_bf16 a[148:151], v[108:111], a[40:43], a[148:151]
    ds_read_b128 v[240:243], v6 offset:16384
    v_mfma_f32_16x16x32_bf16 a[152:155], v[112:115], a[40:43], a[152:155]
    ds_read_b128 v[204:207], v4 offset:32768
    v_mfma_f32_16x16x32_bf16 a[156:159], v[116:119], a[40:43], a[156:159]
    ds_read_b128 v[224:227], v5 offset:32768
    v_mfma_f32_16x16x32_bf16 a[160:163], v[120:123], a[40:43], a[160:163]
    buffer_load_dwordx4 a[8:11], v21, s[20:23], s44 offen offset:3072 sc1
    v_mfma_f32_16x16x32_bf16 a[160:163], a[100:103], a[44:47], a[160:163]
    s_add_u32 s44, s44, 4096
    ds_read_b128 v[244:247], v6 offset:32768
    ds_read_b128 v[208:211], v4 offset:49152
    v_mfma_f32_16x16x32_bf16 a[156:159], a[96:99], a[44:47], a[156:159]
    ds_read_b128 v[228:231], v5 offset:49152
    v_mfma_f32_16x16x32_bf16 a[152:155], v[132:135], a[44:47], a[152:155]
    ds_read_b128 v[248:251], v6 offset:49152
    v_add_u32 v4, 65536, v4
    v_mfma_f32_16x16x32_bf16 a[148:151], v[128:131], a[44:47], a[148:151]
    v_add_u32 v5, 65536, v5
    v_add_u32 v6, 65536, v6
    v_mfma_f32_16x16x32_bf16 a[144:147], v[124:127], a[44:47], a[144:147]
    buffer_load_dwordx4 a[12:15], v21, s[20:23], s44 offen offset:0 sc1
    s_waitcnt vmcnt(12)
    v_mfma_f32_16x16x32_bf16 a[144:147], a[104:107], a[48:51], a[144:147]
    ds_read_b128 v[212:215], v4 offset:0
    v_mfma_f32_16x16x32_bf16 a[148:151], a[108:111], a[48:51], a[148:151]
    ds_read_b128 v[232:235], v5 offset:0
    v_mfma_f32_16x16x32_bf16 a[152:155], a[112:115], a[48:51], a[152:155]
    ds_read_b128 v[252:255], v6 offset:0
    s_waitcnt lgkmcnt(12)
    v_mfma_f32_16x16x32_bf16 a[156:159], a[116:119], a[48:51], a[156:159]
    v_add_f32 v176, v176, v196
    v_add_f32 v177, v177, v197
    v_mfma_f32_16x16x32_bf16 a[160:163], a[120:123], a[48:51], a[160:163]
    v_add_f32 v178, v178, v198
    v_add_f32 v179, v179, v199
    v_mfma_f32_16x16x32_bf16 a[164:167], v[64:67], a[52:55], 0
    s_add_u32 m0, s68, 0
    v_add_f32 v216, v216, v236
    v_add_f32_e64 v217, v217, v237
    v_mfma_f32_16x16x32_bf16 a[168:171], v[68:71], a[52:55], 0
    v_add_f32_e64 v218, v218, v238
    v_mfma_f32_16x16x32_bf16 a[172:175], v[72:75], a[52:55], 0
    v_add_f32 v219, v219, v239
    v_add_f32 v176, v176, v216
    v_mfma_f32_16x16x32_bf16 a[176:179], v[76:79], a[52:55], 0
    buffer_load_dwordx4 v18, s[8:11], s66 offen lds
    ds_write_b128 v11, a[144:147] offset:0
    v_mfma_f32_16x16x32_bf16 a[180:183], v[80:83], a[52:55], 0
    s_add_u32 m0, s68, 1024
    v_add_f32_e64 v177, v177, v217
    v_mfma_f32_16x16x32_bf16 a[180:183], v[100:103], a[56:59], a[180:183]
    v_add_f32 v178, v178, v218
    v_add_f32 v179, v179, v219
    v_mfma_f32_16x16x32_bf16 a[176:179], v[96:99], a[56:59], a[176:179]
    s_waitcnt lgkmcnt(10)
    v_add_f32 v180, v180, v200
    v_add_f32_e64 v181, v181, v201
    v_mfma_f32_16x16x32_bf16 a[172:175], v[92:95], a[56:59], a[172:175]
    ds_write_b128 v11, a[148:151] offset:1024
    v_add_f32_e64 v182, v182, v202
    v_mfma_f32_16x16x32_bf16 a[168:171], v[88:91], a[56:59], a[168:171]
    v_add_f32 v183, v183, v203
    v_add_f32 v220, v220, v240
    v_mfma_f32_16x16x32_bf16 a[164:167], v[84:87], a[56:59], a[164:167]
    v_add_f32_e64 v221, v221, v241
    v_mfma_f32_16x16x32_bf16 a[164:167], v[104:107], a[60:63], a[164:167]
    v_add_f32_e64 v222, v222, v242
    ds_write_b128 v11, a[152:155] offset:2048
    v_mfma_f32_16x16x32_bf16 a[168:171], v[108:111], a[60:63], a[168:171]
    buffer_load_dwordx4 v19, s[8:11], s66 offen lds
    v_add_f32_e64 v223, v223, v243
    v_mfma_f32_16x16x32_bf16 a[172:175], v[112:115], a[60:63], a[172:175]
    s_add_u32 m0, s68, 2048
    v_add_f32 v180, v180, v220
    v_add_f32 v181, v181, v221
    v_mfma_f32_16x16x32_bf16 a[176:179], v[116:119], a[60:63], a[176:179]
    v_add_f32 v182, v182, v222
    v_add_f32 v183, v183, v223
    v_mfma_f32_16x16x32_bf16 a[180:183], v[120:123], a[60:63], a[180:183]
    s_waitcnt lgkmcnt(9)
    ds_write_b128 v11, a[156:159] offset:3072
    s_waitcnt vmcnt(10)
    v_mfma_f32_16x16x32_bf16 a[180:183], a[100:103], a[64:67], a[180:183]
    v_add_f32 v184, v184, v204
    v_add_f32 v185, v185, v205
    v_mfma_f32_16x16x32_bf16 a[176:179], a[96:99], a[64:67], a[176:179]
    v_add_f32 v186, v186, v206
    v_add_f32 v187, v187, v207
    v_mfma_f32_16x16x32_bf16 a[172:175], v[132:135], a[64:67], a[172:175]
    v_add_f32_e64 v224, v224, v244
    v_mfma_f32_16x16x32_bf16 a[168:171], v[128:131], a[64:67], a[168:171]
    buffer_load_dwordx4 v20, s[8:11], s66 offen lds
    v_add_f32_e64 v225, v225, v245
    v_mfma_f32_16x16x32_bf16 a[164:167], v[124:127], a[64:67], a[164:167]
    v_add_f32_e64 v226, v226, v246
    v_mfma_f32_16x16x32_bf16 a[164:167], a[104:107], a[68:71], a[164:167]
    v_add_f32_e64 v227, v227, v247
    ds_write_b128 v11, a[160:163] offset:4096
    v_mfma_f32_16x16x32_bf16 a[168:171], a[108:111], a[68:71], a[168:171]
    v_add_f32 v184, v184, v224
    v_add_f32 v185, v185, v225
    v_mfma_f32_16x16x32_bf16 a[172:175], a[112:115], a[68:71], a[172:175]
    v_add_f32 v186, v186, v226
    v_add_f32 v187, v187, v227
    v_mfma_f32_16x16x32_bf16 a[176:179], a[116:119], a[68:71], a[176:179]
    s_waitcnt lgkmcnt(8)
    v_add_f32 v188, v188, v208
    v_mfma_f32_16x16x32_bf16 a[180:183], a[120:123], a[68:71], a[180:183]
    v_add_f32_e64 v189, v189, v209
    v_mfma_f32_16x16x32_bf16 a[184:187], v[64:67], a[72:75], 0
    v_add_f32 v190, v190, v210
    v_add_f32 v191, v191, v211
    v_mfma_f32_16x16x32_bf16 a[188:191], v[68:71], a[72:75], 0
    v_add_f32_e64 v228, v228, v248
    v_mfma_f32_16x16x32_bf16 a[192:195], v[72:75], a[72:75], 0
    v_add_f32_e64 v229, v229, v249
    ds_write_b128 v11, a[164:167] offset:5120
    v_mfma_f32_16x16x32_bf16 a[196:199], v[76:79], a[72:75], 0
    v_add_f32 v230, v230, v250
    v_add_f32 v231, v231, v251
    v_mfma_f32_16x16x32_bf16 a[200:203], v[80:83], a[72:75], 0
    v_add_f32_e64 v188, v188, v228
    v_mfma_f32_16x16x32_bf16 a[200:203], v[100:103], a[76:79], a[200:203]
    v_add_f32 v189, v189, v229
    v_add_f32 v190, v190, v230
    v_mfma_f32_16x16x32_bf16 a[196:199], v[96:99], a[76:79], a[196:199]
    v_add_f32_e64 v191, v191, v231
    ds_write_b128 v11, a[168:171] offset:6144
    v_mfma_f32_16x16x32_bf16 a[192:195], v[92:95], a[76:79], a[192:195]
    s_waitcnt lgkmcnt(7)
    v_add_f32 v192, v192, v212
    v_mfma_f32_16x16x32_bf16 a[188:191], v[88:91], a[76:79], a[188:191]
    v_add_f32_e64 v193, v193, v213
    v_mfma_f32_16x16x32_bf16 a[184:187], v[84:87], a[76:79], a[184:187]
    v_add_f32 v194, v194, v214
    s_waitcnt vmcnt(7)
    v_mfma_f32_16x16x32_bf16 a[184:187], v[104:107], a[80:83], a[184:187]
    v_add_f32 v195, v195, v215
    v_add_f32 v232, v232, v252
    v_mfma_f32_16x16x32_bf16 a[188:191], v[108:111], a[80:83], a[188:191]
    v_add_f32_e64 v233, v233, v253
    ds_write_b128 v11, a[172:175] offset:7168
    v_mfma_f32_16x16x32_bf16 a[192:195], v[112:115], a[80:83], a[192:195]
    v_add_f32 v234, v234, v254
    v_add_f32 v235, v235, v255
    v_mfma_f32_16x16x32_bf16 a[196:199], v[116:119], a[80:83], a[196:199]
    v_add_f32 v192, v192, v232
    v_add_f32 v193, v193, v233
    v_mfma_f32_16x16x32_bf16 a[200:203], v[120:123], a[80:83], a[200:203]
    v_add_f32_e64 v194, v194, v234
    v_mfma_f32_16x16x32_bf16 a[200:203], a[100:103], a[84:87], a[200:203]
    v_add_f32_e64 v195, v195, v235
    ds_write_b128 v11, a[176:179] offset:8192
    v_mfma_f32_16x16x32_bf16 a[196:199], a[96:99], a[84:87], a[196:199]
    v_mul_f32 v26, v38, v176
    v_mul_f32 v27, v38, v177
    v_mfma_f32_16x16x32_bf16 a[192:195], v[132:135], a[84:87], a[192:195]
    v_mul_f32_e64 v28, v38, v178
    v_mfma_f32_16x16x32_bf16 a[188:191], v[128:131], a[84:87], a[188:191]
    v_mul_f32_e64 v29, v38, v179
    ds_write_b128 v11, a[180:183] offset:9216
    v_mfma_f32_16x16x32_bf16 a[184:187], v[124:127], a[84:87], a[184:187]
    v_mfma_f32_16x16x32_bf16 a[184:187], a[104:107], a[88:91], a[184:187]
    v_exp_f32_e64 v26, v26
    v_mfma_f32_16x16x32_bf16 a[188:191], a[108:111], a[88:91], a[188:191]
    v_exp_f32_e64 v27, v27
    v_mfma_f32_16x16x32_bf16 a[192:195], a[112:115], a[88:91], a[192:195]
    v_exp_f32 v28, v28
    v_exp_f32 v29, v29
    v_mfma_f32_16x16x32_bf16 a[196:199], a[116:119], a[88:91], a[196:199]
    v_fma_f32 v26, v26, v36, v36
    v_fma_f32 v27, v27, v36, v36
    v_fma_f32 v28, v28, v36, v36
    v_mfma_f32_16x16x32_bf16 a[200:203], a[120:123], a[88:91], a[200:203]
    v_fma_f32 v29, v29, v36, v36
    v_rcp_f32_e64 v26, v26
    v_mfma_f32_16x16x32_bf16 v[136:139], v[64:67], a[92:95], 0
    v_rcp_f32_e64 v27, v27
    v_mfma_f32_16x16x32_bf16 v[140:143], v[68:71], a[92:95], 0
    v_rcp_f32_e64 v28, v28
    v_mfma_f32_16x16x32_bf16 v[144:147], v[72:75], a[92:95], 0
    v_rcp_f32_e64 v29, v29
    v_mfma_f32_16x16x32_bf16 v[148:151], v[76:79], a[92:95], 0
L_isl_gu_6:
    s_cbranch_execz L_warm_gu_0
    ds_write_b128 v11, a[184:187] offset:10240
    v_mul_f32 v176, v176, v26
    v_mfma_f32_16x16x32_bf16 v[152:155], v[80:83], a[92:95], 0
    v_mul_f32 v177, v177, v27
    s_waitcnt vmcnt(3)
    v_mfma_f32_16x16x32_bf16 v[152:155], v[100:103], a[0:3], v[152:155]
    s_waitcnt vmcnt(0)
    ds_write_b128 v11, a[188:191] offset:11264
    v_mul_f32 v178, v178, v28
    v_mfma_f32_16x16x32_bf16 v[148:151], v[96:99], a[0:3], v[148:151]
    v_mul_f32_e64 v179, v179, v29
    ds_write_b128 v11, a[192:195] offset:12288
    v_mfma_f32_16x16x32_bf16 v[144:147], v[92:95], a[0:3], v[144:147]
    v_mul_f32_e64 v30, v38, v180
    ds_read_b64 v[158:159], v35 offset:0
    v_mfma_f32_16x16x32_bf16 v[140:143], v[88:91], a[0:3], v[140:143]
    v_mul_f32 v31, v38, v181
    v_mul_f32 v32, v38, v182
    v_mfma_f32_16x16x32_bf16 v[136:139], v[84:87], a[0:3], v[136:139]
    ds_write_b128 v11, a[196:199] offset:13312
    v_mfma_f32_16x16x32_bf16 v[136:139], v[104:107], a[4:7], v[136:139]
    ds_read_b64 v[162:163], v35 offset:32
    v_mul_f32_e64 v33, v38, v183
    v_mfma_f32_16x16x32_bf16 v[140:143], v[108:111], a[4:7], v[140:143]
    v_exp_f32_e64 v30, v30
    v_mfma_f32_16x16x32_bf16 v[144:147], v[112:115], a[4:7], v[144:147]
    v_exp_f32_e64 v31, v31
    v_mfma_f32_16x16x32_bf16 v[148:151], v[116:119], a[4:7], v[148:151]
    ds_read_b64 v[166:167], v35 offset:64
    ds_read_b64 v[170:171], v35 offset:96
    ds_write_b128 v11, a[200:203] offset:14336
    v_mfma_f32_16x16x32_bf16 v[152:155], v[120:123], a[4:7], v[152:155]
    ds_read_b64 v[174:175], v35 offset:128
    v_mfma_f32_16x16x32_bf16 v[152:155], a[100:103], a[8:11], v[152:155]
    v_exp_f32 v32, v32
    v_exp_f32 v33, v33
    v_fma_f32 v30, v30, v36, v36
    v_mfma_f32_16x16x32_bf16 v[148:151], a[96:99], a[8:11], v[148:151]
    v_fma_f32 v31, v31, v36, v36
    v_fma_f32 v32, v32, v36, v36
    s_waitcnt lgkmcnt(0)
    s_barrier
    v_mfma_f32_16x16x32_bf16 v[144:147], v[132:135], a[8:11], v[144:147]
    ds_read_b128 v[196:199], v7 offset:0
    v_fma_f32 v33, v33, v36, v36
    ds_read_b128 v[216:219], v25 offset:0
    v_rcp_f32_e64 v30, v30
    v_mfma_f32_16x16x32_bf16 v[140:143], v[128:131], a[8:11], v[140:143]
    ds_read_b128 v[236:239], v34 offset:0
    ds_read_b128 v[200:203], v7 offset:1024
    v_rcp_f32_e64 v31, v31
    v_mfma_f32_16x16x32_bf16 v[136:139], v[124:127], a[8:11], v[136:139]
    ds_read_b128 v[220:223], v25 offset:1024
    ds_read_b128 v[240:243], v34 offset:1024
    v_rcp_f32_e64 v32, v32
    v_mfma_f32_16x16x32_bf16 v[136:139], a[104:107], a[12:15], v[136:139]
    ds_read_b128 v[204:207], v7 offset:2048
    ds_read_b128 v[224:227], v25 offset:2048
    v_rcp_f32_e64 v33, v33
    v_mfma_f32_16x16x32_bf16 v[140:143], a[108:111], a[12:15], v[140:143]
    ds_read_b128 v[244:247], v34 offset:2048
    v_mul_f32_e64 v180, v180, v30
    ds_read_b128 v[208:211], v7 offset:3072
    v_mul_f32_e64 v181, v181, v31
    v_mfma_f32_16x16x32_bf16 v[144:147], a[112:115], a[12:15], v[144:147]
    ds_read_b128 v[228:231], v25 offset:3072
    ds_read_b128 v[248:251], v34 offset:3072
    v_mfma_f32_16x16x32_bf16 v[148:151], a[116:119], a[12:15], v[148:151]
    v_mul_f32_e64 v182, v182, v32
    ds_read_b128 v[212:215], v7 offset:4096
    ds_read_b128 v[232:235], v25 offset:4096
    v_mfma_f32_16x16x32_bf16 v[152:155], a[120:123], a[12:15], v[152:155]
    v_mul_f32_e64 v183, v183, v33
    ds_read_b128 v[252:255], v34 offset:4096
    v_lshlrev_b32_e64 v156, 16, v158
    v_and_b32 v157, 0xffff0000, v158
    v_lshlrev_b32_e64 v158, 16, v159
    v_and_b32 v159, 0xffff0000, v159
    v_lshlrev_b32_e64 v160, 16, v162
    v_and_b32 v161, 0xffff0000, v162
    v_lshlrev_b32_e64 v162, 16, v163
    v_and_b32 v163, 0xffff0000, v163
    v_lshlrev_b32_e64 v164, 16, v166
    v_and_b32 v165, 0xffff0000, v166
    v_lshlrev_b32_e64 v166, 16, v167
    v_and_b32 v167, 0xffff0000, v167
    v_lshlrev_b32_e64 v168, 16, v170
    v_and_b32 v169, 0xffff0000, v170
    v_lshlrev_b32_e64 v170, 16, v171
    v_and_b32 v171, 0xffff0000, v171
    v_lshlrev_b32_e64 v172, 16, v174
    v_and_b32 v173, 0xffff0000, v174
    v_lshlrev_b32_e64 v174, 16, v175
    v_and_b32 v175, 0xffff0000, v175
    v_pk_mul_f32 v[12:13], v[184:185], v[38:39] op_sel_hi:[1,0]
    v_pk_mul_f32 v[26:27], v[188:189], v[38:39] op_sel_hi:[1,0]
    v_pk_mul_f32 v[30:31], v[192:193], v[38:39] op_sel_hi:[1,0]
    v_pk_mul_f32 v[14:15], v[186:187], v[38:39] op_sel_hi:[1,0]
    v_pk_mul_f32 v[28:29], v[190:191], v[38:39] op_sel_hi:[1,0]
    v_pk_mul_f32 v[32:33], v[194:195], v[38:39] op_sel_hi:[1,0]
    v_exp_f32 v12, v12
    v_exp_f32 v26, v26
    v_exp_f32 v30, v30
    v_exp_f32 v13, v13
    v_exp_f32 v27, v27
    v_exp_f32 v31, v31
    v_exp_f32 v14, v14
    v_exp_f32 v28, v28
    v_exp_f32 v32, v32
    v_exp_f32 v15, v15
    v_exp_f32 v29, v29
    v_exp_f32 v33, v33
    v_pk_fma_f32 v[12:13], v[12:13], v[36:37], v[36:37] op_sel_hi:[1,0,0]
    v_pk_fma_f32 v[26:27], v[26:27], v[36:37], v[36:37] op_sel_hi:[1,0,0]
    v_pk_fma_f32 v[30:31], v[30:31], v[36:37], v[36:37] op_sel_hi:[1,0,0]
    v_pk_fma_f32 v[14:15], v[14:15], v[36:37], v[36:37] op_sel_hi:[1,0,0]
    v_pk_fma_f32 v[28:29], v[28:29], v[36:37], v[36:37] op_sel_hi:[1,0,0]
    v_pk_fma_f32 v[32:33], v[32:33], v[36:37], v[36:37] op_sel_hi:[1,0,0]
    v_rcp_f32 v12, v12
    v_rcp_f32 v26, v26
    v_rcp_f32 v30, v30
    v_rcp_f32 v13, v13
    v_rcp_f32 v27, v27
    v_rcp_f32 v31, v31
    v_rcp_f32 v14, v14
    v_rcp_f32 v28, v28
    v_rcp_f32 v32, v32
    v_rcp_f32 v15, v15
    v_rcp_f32 v29, v29
    v_rcp_f32 v33, v33
    v_pk_mul_f32 v[184:185], v[184:185], v[12:13]
    v_pk_mul_f32 v[188:189], v[188:189], v[26:27]
    v_pk_mul_f32 v[192:193], v[192:193], v[30:31]
    v_pk_mul_f32 v[186:187], v[186:187], v[14:15]
    v_pk_mul_f32 v[190:191], v[190:191], v[28:29]
    v_pk_mul_f32 v[194:195], v[194:195], v[32:33]
    s_waitcnt lgkmcnt(12)
    s_nop 0
    v_pk_add_f32 v[136:137], v[136:137], v[196:197]
    v_pk_add_f32 v[138:139], v[138:139], v[198:199]
    v_pk_add_f32 v[216:217], v[216:217], v[236:237]
    v_pk_add_f32 v[218:219], v[218:219], v[238:239]
    v_pk_add_f32 v[136:137], v[136:137], v[216:217]
    v_pk_add_f32 v[138:139], v[138:139], v[218:219]
    v_pk_fma_f32 v[136:137], v[136:137], v[176:177], v[156:157]
    v_pk_fma_f32 v[138:139], v[138:139], v[178:179], v[158:159]
    v_cvt_pk_bf16_f32 v136, v136, v137
    v_cvt_pk_bf16_f32 v137, v138, v139
    ds_write_b64 v37, v[136:137] offset:0
    s_waitcnt lgkmcnt(10)
    s_nop 0
    v_pk_add_f32 v[140:141], v[140:141], v[200:201]
    v_pk_add_f32 v[142:143], v[142:143], v[202:203]
    v_pk_add_f32 v[220:221], v[220:221], v[240:241]
    v_pk_add_f32 v[222:223], v[222:223], v[242:243]
    v_pk_add_f32 v[140:141], v[140:141], v[220:221]
    v_pk_add_f32 v[142:143], v[142:143], v[222:223]
    v_pk_fma_f32 v[140:141], v[140:141], v[180:181], v[160:161]
    v_pk_fma_f32 v[142:143], v[142:143], v[182:183], v[162:163]
    v_cvt_pk_bf16_f32 v140, v140, v141
    v_cvt_pk_bf16_f32 v141, v142, v143
    ds_write_b64 v37, v[140:141] offset:32
    s_waitcnt lgkmcnt(8)
    s_nop 0
    v_pk_add_f32 v[144:145], v[144:145], v[204:205]
    v_pk_add_f32 v[146:147], v[146:147], v[206:207]
    v_pk_add_f32 v[224:225], v[224:225], v[244:245]
    v_pk_add_f32 v[226:227], v[226:227], v[246:247]
    v_pk_add_f32 v[144:145], v[144:145], v[224:225]
    v_pk_add_f32 v[146:147], v[146:147], v[226:227]
    v_pk_fma_f32 v[144:145], v[144:145], v[184:185], v[164:165]
    v_pk_fma_f32 v[146:147], v[146:147], v[186:187], v[166:167]
    v_cvt_pk_bf16_f32 v144, v144, v145
    v_cvt_pk_bf16_f32 v145, v146, v147
    ds_write_b64 v37, v[144:145] offset:64
    s_waitcnt lgkmcnt(6)
    s_nop 0
    v_pk_add_f32 v[148:149], v[148:149], v[208:209]
    v_pk_add_f32 v[150:151], v[150:151], v[210:211]
    v_pk_add_f32 v[228:229], v[228:229], v[248:249]
    v_pk_add_f32 v[230:231], v[230:231], v[250:251]
    v_pk_add_f32 v[148:149], v[148:149], v[228:229]
    v_pk_add_f32 v[150:151], v[150:151], v[230:231]
    v_pk_fma_f32 v[148:149], v[148:149], v[188:189], v[168:169]
    v_pk_fma_f32 v[150:151], v[150:151], v[190:191], v[170:171]
    v_cvt_pk_bf16_f32 v148, v148, v149
    v_cvt_pk_bf16_f32 v149, v150, v151
    ds_write_b64 v37, v[148:149] offset:96
    s_waitcnt lgkmcnt(4)
    s_nop 0
    v_pk_add_f32 v[152:153], v[152:153], v[212:213]
    v_pk_add_f32 v[154:155], v[154:155], v[214:215]
    v_pk_add_f32 v[232:233], v[232:233], v[252:253]
    v_pk_add_f32 v[234:235], v[234:235], v[254:255]
    v_pk_add_f32 v[152:153], v[152:153], v[232:233]
    v_pk_add_f32 v[154:155], v[154:155], v[234:235]
    v_pk_fma_f32 v[152:153], v[152:153], v[192:193], v[172:173]
    v_pk_fma_f32 v[154:155], v[154:155], v[194:195], v[174:175]
    v_cvt_pk_bf16_f32 v152, v152, v153
    v_cvt_pk_bf16_f32 v153, v154, v155
    ds_write_b64 v37, v[152:153] offset:128
    ds_read_b128 v[196:199], v8 offset:0
    ds_read_b128 v[200:203], v8 offset:1024
    ds_read_b128 v[204:207], v8 offset:2048
    s_waitcnt lgkmcnt(2)
    buffer_store_dwordx4 v[196:199], v18, s[28:31], s66 offen nt
    s_waitcnt lgkmcnt(1)
    buffer_store_dwordx4 v[200:203], v19, s[28:31], s66 offen nt
    s_waitcnt lgkmcnt(0)
    buffer_store_dwordx4 v[204:207], v20, s[28:31], s66 offen nt
    s_endpgm
L_slow_csgu:
    s_mov_b32 s7, 0
L_spin_csgu:
    s_sleep 1
    buffer_load_dwordx2 v[48:49], v60, s[20:23], s42 offen offset:0 sc1
    buffer_load_dwordx2 v[50:51], v60, s[20:23], s42 offen offset:512 sc1
    buffer_load_dwordx2 v[52:53], v60, s[20:23], s42 offen offset:1024 sc1
    buffer_load_dwordx2 v[54:55], v60, s[20:23], s42 offen offset:1536 sc1
    buffer_load_dwordx2 v[56:57], v60, s[20:23], s42 offen offset:2048 sc1
    buffer_load_dwordx2 v[58:59], v60, s[20:23], s42 offen offset:2560 sc1
    s_waitcnt vmcnt(0)
    s_nop 0
    v_max3_u32 v61, v48, v49, v50
    v_max3_u32 v61, v61, v51, v52
    v_max3_u32 v61, v61, v53, v54
    v_max3_u32 v61, v61, v55, v56
    v_max3_u32 v61, v61, v57, v58
    v_max_u32 v61, v61, v59
    v_cmp_eq_u32 vcc, -1, v61
    v_accvgpr_write_b32 a112, v48
    v_accvgpr_write_b32 a113, v49
    v_accvgpr_write_b32 a114, v50
    v_accvgpr_write_b32 a115, v51
    v_accvgpr_write_b32 a116, v52
    v_accvgpr_write_b32 a117, v53
    v_accvgpr_write_b32 a118, v54
    v_accvgpr_write_b32 a119, v55
    v_accvgpr_write_b32 a120, v56
    v_accvgpr_write_b32 a121, v57
    v_accvgpr_write_b32 a122, v58
    v_accvgpr_write_b32 a123, v59
    s_add_u32 s7, s7, 1
    s_cmp_ge_u32 s7, 0x40000
    s_cbranch_scc1 L_ok_csgu
    s_cbranch_vccnz L_spin_csgu
    s_branch L_ok_csgu
L_slow_rgu:
    s_mov_b32 s7, 0
L_spin_rgu:
    s_sleep 1
    buffer_load_dword v47, off, s[32:35], 0 sc1
    s_waitcnt vmcnt(0)
    v_cmp_eq_u32 vcc, 0, v47
    s_add_u32 s7, s7, 1
    s_cmp_ge_u32 s7, 0x40000
    s_cbranch_scc1 L_ok_rgu
    s_nop 1
    s_cbranch_vccnz L_spin_rgu
    s_branch L_ok_rgu
L_slow_s1gu:
    s_mov_b32 s7, 0
L_spin_s1gu:
    s_sleep 1
    buffer_load_dword v47, v46, s[20:23], 0 offen sc1
    s_waitcnt vmcnt(0)
    v_cmp_eq_u32 vcc, 0, v47
    s_add_u32 s7, s7, 1
    s_cmp_ge_u32 s7, 0x40000
    s_cbranch_scc1 L_ok_s1gu
    s_nop 1
    s_cbranch_vccnz L_spin_s1gu
    s_branch L_ok_s1gu
L_slow_lgu:
    s_mov_b32 s7, 0
L_spin_lgu:
    s_sleep 1
    buffer_load_dword v15, v23, s[20:23], s53 offen sc1
    s_waitcnt vmcnt(0)
    v_cmp_eq_u32 vcc, 0, v15
    s_add_u32 s7, s7, 1
    s_cmp_ge_u32 s7, 0x40000
    s_cbranch_scc1 L_ok_lgu
    s_nop 1
    s_cbranch_vccnz L_spin_lgu
    s_branch L_ok_lgu
L_slow_ogu:
    s_mov_b32 s7, 0
L_spin_ogu:
    s_sleep 1
    buffer_load_dword v15, v24, s[20:23], s54 offen sc1
    s_waitcnt vmcnt(0)
    v_cmp_eq_u32 vcc, 0, v15
    s_add_u32 s7, s7, 1
    s_cmp_ge_u32 s7, 0x40000
    s_cbranch_scc1 L_ok_ogu
    s_nop 1
    s_cbranch_vccnz L_spin_ogu
    s_branch L_ok_ogu
.p2align 12
L_main_qkv:
L_isl_qkv_0:
    s_cbranch_execz L_isl_qkv_4
    s_waitcnt vmcnt(13)
    s_barrier
    s_nop 0
    ds_read_b128 a[0:3], v13 offset:40960
    ds_read_b64_tr_b16 a[40:41], v15 offset:0
    ds_read_b64_tr_b16 a[42:43], v15 offset:3840
    ds_read_b64_tr_b16 a[44:45], v15 offset:160
    ds_read_b64_tr_b16 a[46:47], v15 offset:4000
    ds_read_b64_tr_b16 a[48:49], v15 offset:320
    ds_read_b64_tr_b16 a[50:51], v15 offset:4160
    ds_read_b64_tr_b16 a[52:53], v16 offset:0
    ds_read_b64_tr_b16 a[54:55], v17 offset:0
    ds_read_b128 a[4:7], v13 offset:43008
    ds_read_b128 a[8:11], v13 offset:45056
    ds_read_b128 a[12:15], v13 offset:47104
    ds_read_b128 a[16:19], v13 offset:49152
    ds_read_b128 a[20:23], v13 offset:51200
    ds_read_b128 a[24:27], v13 offset:53248
    ds_read_b128 a[28:31], v13 offset:55296
    ds_read_b128 a[32:35], v13 offset:57344
    ds_read_b128 a[36:39], v13 offset:59392
    s_waitcnt vmcnt(9) lgkmcnt(0)
    s_barrier
    v_mfma_f32_16x16x32_bf16 v[240:243], a[40:43], a[0:3], 0
    s_mov_b32 s20, s54
    ds_read_b128 a[56:59], v14 offset:40960
    s_and_b32 s21, s55, 0xffff
    s_mov_b32 s22, 33554432
    v_mfma_f32_16x16x32_bf16 v[244:247], a[44:47], a[0:3], 0
    s_add_u32 m0, s62, 49152
    s_mov_b32 s23, 0x20000
    s_mov_b32 s32, s52
    v_mfma_f32_16x16x32_bf16 v[248:251], a[0:3], a[48:51], 0
    s_and_b32 s33, s53, 0xffff
    ds_read_b64_tr_b16 a[96:97], v15 offset:16384
    s_mov_b32 s34, 256
    v_mfma_f32_16x16x32_bf16 v[252:255], a[52:55], a[0:3], 0
    s_mov_b32 s35, 0x20000
    buffer_load_dwordx4 v4, s[12:15], s60 offen lds
    s_lshl_b32 s79, s4, 12
    v_mfma_f32_16x16x32_bf16 v[108:111], a[52:55], a[4:7], 0
    s_lshl_b32 s3, s2, 2
    ds_read_b64_tr_b16 a[98:99], v15 offset:20224
    s_add_u32 s76, s3, s4
    v_mfma_f32_16x16x32_bf16 v[104:107], a[4:7], a[48:51], 0
    s_lshl_b32 s3, s4, 10
    s_add_u32 s3, s3, 23134208
    v_mfma_f32_16x16x32_bf16 v[100:103], a[44:47], a[4:7], 0
    buffer_load_dwordx4 v5, s[12:15], s60 offen offset:1024 lds
    ds_read_b64_tr_b16 a[100:101], v15 offset:16544
    v_add_u32_e64 v46, s3, v21
    v_mfma_f32_16x16x32_bf16 v[96:99], a[40:43], a[4:7], 0
    s_lshr_b32 s101, s31, 8
    s_cmp_lt_u32 s100, 5
    v_mfma_f32_16x16x32_bf16 v[112:115], a[40:43], a[8:11], 0
    s_cselect_b32 s101, s101, 0
    ds_read_b64_tr_b16 a[102:103], v15 offset:20384
    s_mov_b32 s3, 0x3f803f80
    v_mfma_f32_16x16x32_bf16 v[116:119], a[44:47], a[8:11], 0
    v_accvgpr_write_b32 a200, s3
    v_accvgpr_write_b32 a201, s3
    v_mfma_f32_16x16x32_bf16 v[120:123], a[8:11], a[48:51], 0
    buffer_load_dwordx4 v6, s[12:15], s60 offen offset:2048 lds
    ds_read_b64_tr_b16 a[104:105], v15 offset:16704
    v_accvgpr_write_b32 a202, s3
    v_mfma_f32_16x16x32_bf16 v[124:127], a[52:55], a[8:11], 0
    v_accvgpr_write_b32 a203, s3
    v_accvgpr_write_b32 a176, 0
    v_accvgpr_write_b32 a180, 0
    v_mfma_f32_16x16x32_bf16 v[140:143], a[52:55], a[12:15], 0
    ds_read_b64_tr_b16 a[106:107], v15 offset:20544
    v_accvgpr_write_b32 a184, 0
    v_accvgpr_write_b32 a188, 0
    v_mfma_f32_16x16x32_bf16 v[136:139], a[12:15], a[48:51], 0
    s_mul_i32 s3, s5, 146
    buffer_load_dwordx4 v7, s[12:15], s60 offen offset:3072 lds
    s_add_u32 s3, s3, 14
    v_mfma_f32_16x16x32_bf16 v[132:135], a[44:47], a[12:15], 0
    s_lshr_b32 s7, s3, 4
    ds_read_b64_tr_b16 a[108:109], v16 offset:16384
    s_mul_i32 s7, s7, 75776
    v_mfma_f32_16x16x32_bf16 v[128:131], a[40:43], a[12:15], 0
    s_and_b32 s3, s3, 8
    s_lshl_b32 s3, s3, 4
    v_mfma_f32_16x16x32_bf16 v[144:147], a[40:43], a[16:19], 0
    s_bfe_u32 s59, s30, 0x40008
    ds_read_b64_tr_b16 a[110:111], v17 offset:16384
    s_add_u32 s3, s3, s7
    v_mfma_f32_16x16x32_bf16 v[148:151], a[44:47], a[16:19], 0
    s_add_u32 s3, s3, 1048576
    s_add_u32 s7, s6, 32
    v_mfma_f32_16x16x32_bf16 v[152:155], a[16:19], a[48:51], 0
    s_sub_u32 s7, s7, s17
    ds_read_b128 a[60:63], v14 offset:43008
    v_bfe_u32 v1, v0, 1, 1
    v_mfma_f32_16x16x32_bf16 v[156:159], a[52:55], a[16:19], 0
    s_mul_i32 s59, s59, 245760
    v_mul_u32_u24 v1, s7, v1
    v_add_u32 v1, s17, v1
    v_mfma_f32_16x16x32_bf16 v[172:175], a[52:55], a[20:23], 0
    s_add_u32 s60, s56, s59
    ds_read_b128 a[64:67], v14 offset:45056
    v_and_b32 v2, 1, v0
    v_lshl_add_u32 v1, v1, 1, v2
    v_mfma_f32_16x16x32_bf16 v[168:171], a[20:23], a[48:51], 0
    s_add_u32 m0, s63, 106496
    v_lshlrev_b32_e64 v1, 8, v1
    buffer_load_dword v23, v1, s[20:23], s3 offen sc1
    v_mfma_f32_16x16x32_bf16 v[164:167], a[44:47], a[20:23], 0
    s_and_b32 s3, s2, 1
    ds_read_b128 a[68:71], v14 offset:47104
    v_mfma_f32_16x16x32_bf16 v[160:163], a[40:43], a[20:23], 0
    s_lshl_b32 s3, s3, 7
    s_bfe_u32 s7, s2, 0x20001
    v_mfma_f32_16x16x32_bf16 v[176:179], a[40:43], a[24:27], 0
    s_lshl_b32 s7, s7, 5
    ds_read_b128 a[72:75], v14 offset:49152
    v_mfma_f32_16x16x32_bf16 v[180:183], a[44:47], a[24:27], 0
    s_add_u32 s3, s3, s7
    s_lshr_b32 s7, s2, 3
    s_add_u32 s3, s3, s7
    v_mfma_f32_16x16x32_bf16 v[184:187], a[24:27], a[48:51], 0
    s_lshl_b32 s3, s3, 2
    ds_read_b128 a[76:79], v14 offset:51200
    v_mfma_f32_16x16x32_bf16 v[188:191], a[52:55], a[24:27], 0
    s_add_u32 s3, s3, s4
    s_lshl_b32 s7, s3, 1
    v_mfma_f32_16x16x32_bf16 v[204:207], a[52:55], a[28:31], 0
    s_mul_i32 s3, s3, 2560
    ds_read_b128 a[80:83], v14 offset:53248
    v_lshrrev_b32 v1, 5, v0
    v_mfma_f32_16x16x32_bf16 v[200:203], a[28:31], a[48:51], 0
    v_and_b32_e64 v2, 31, v0
    v_mul_u32_u24 v36, 1280, v1
    v_mfma_f32_16x16x32_bf16 v[196:199], a[44:47], a[28:31], 0
    buffer_load_dwordx4 v8, s[8:11], s61 offen lds
    v_lshl_add_u32 v36, v2, 4, v36
    v_mfma_f32_16x16x32_bf16 v[192:195], a[40:43], a[28:31], 0
    ds_read_b128 a[84:87], v14 offset:55296
    v_cmp_gt_u32 s[70:71], 16, v2
    v_add_u32 v37, 1024, v36
    v_mfma_f32_16x16x32_bf16 v[208:211], a[40:43], a[32:35], 0
    v_add_u32_e64 v1, s7, v1
    ds_read_b128 a[88:91], v14 offset:57344
    v_mfma_f32_16x16x32_bf16 v[212:215], a[44:47], a[32:35], 0
    v_cndmask_b32 v37, v38, v37, s[70:71]
    buffer_load_dwordx4 v[24:27], v36, s[8:11], s3 offen
    v_mfma_f32_16x16x32_bf16 v[216:219], a[32:35], a[48:51], 0
    ds_read_b128 a[92:95], v14 offset:59392
    buffer_load_dwordx4 v[28:31], v36, s[8:11], s3 offen offset:512
    v_mfma_f32_16x16x32_bf16 v[220:223], a[52:55], a[32:35], 0
    buffer_load_dwordx4 v[32:35], v37, s[8:11], s3 offen
    v_mfma_f32_16x16x32_bf16 v[236:239], a[52:55], a[36:39], 0
    v_lshlrev_b32_e64 v36, 2, v2
    v_lshl_add_u32 v36, v1, 3, v36
    v_add_u32 v36, 22020096, v36
    v_mfma_f32_16x16x32_bf16 v[232:235], a[36:39], a[48:51], 0
    v_lshlrev_b32_e64 v1, 2, v1
    v_add_u32 v1, 22085632, v1
    buffer_load_dwordx4 v9, s[8:11], s61 offen offset:1024 lds
    v_mfma_f32_16x16x32_bf16 v[228:231], a[44:47], a[36:39], 0
    v_cmp_gt_u32 s[70:71], 2, v2
    v_cmp_eq_u32 s[74:75], 2, v2
    s_nop 0
    v_cndmask_b32 v36, v38, v36, s[70:71]
    v_mfma_f32_16x16x32_bf16 v[224:227], a[40:43], a[36:39], 0
    v_cndmask_b32 v36, v36, v1, s[74:75]
    buffer_load_dword v23, v36, s[20:23], 0 offen sc1
    s_bitcmp0_b32 s101, 0
    s_cbranch_scc1 L_nocs_qkv_0
    v_mfma_f32_16x16x32_bf16 a[176:179], a[200:203], a[40:43], a[176:179]
    v_mfma_f32_16x16x32_bf16 a[180:183], a[200:203], a[44:47], a[180:183]
    v_mfma_f32_16x16x32_bf16 a[184:187], a[200:203], a[48:51], a[184:187]
    v_mfma_f32_16x16x32_bf16 a[188:191], a[200:203], a[52:55], a[188:191]
L_nocs_qkv_0:
    s_waitcnt vmcnt(11) lgkmcnt(0)
    s_barrier
    v_mfma_f32_16x16x32_bf16 v[240:243], a[96:99], a[56:59], v[240:243]
    s_add_u32 m0, s63, 106496
    v_or_b32 v1, s76, v0
    v_cmp_eq_u32 s[70:71], 0, v1
    v_mov_b32_e64 v2, 1
    v_mfma_f32_16x16x32_bf16 v[244:247], a[100:103], a[56:59], v[244:247]
    ds_read_b128 a[0:3], v13 offset:0
    v_cndmask_b32 v1, v38, 0, s[70:71]
    buffer_store_dword v2, v1, s[32:35], 0 offen sc1
    v_mfma_f32_16x16x32_bf16 v[248:251], a[56:59], a[104:107], v[248:251]
    s_min_u32 s3, s4, 1
    ds_read_b64_tr_b16 a[40:41], v15 offset:32768
    s_lshl_b32 s3, s3, 30
    v_lshl_add_u32 v1, v0, 2, s3
    v_mfma_f32_16x16x32_bf16 v[252:255], a[108:111], a[56:59], v[252:255]
    v_mov_b32_e64 v2, 0
    buffer_store_dword v2, v1, s[20:23], s77 offen sc1
    v_mfma_f32_16x16x32_bf16 v[108:111], a[108:111], a[60:63], v[108:111]
    s_mul_i32 s57, s4, 112
    ds_read_b64_tr_b16 a[42:43], v15 offset:36608
    s_add_u32 s57, s57, s2
    v_mfma_f32_16x16x32_bf16 v[104:107], a[60:63], a[104:107], v[104:107]
    s_add_u32 s57, s57, 432
    s_mul_i32 s64, s57, 6554
    v_mfma_f32_16x16x32_bf16 v[100:103], a[100:103], a[60:63], v[100:103]
    s_lshr_b32 s64, s64, 16
    buffer_load_dwordx4 v10, s[8:11], s61 offen offset:2048 lds
    ds_read_b64_tr_b16 a[44:45], v15 offset:32928
    s_mul_i32 s3, s64, 10
    v_mfma_f32_16x16x32_bf16 v[96:99], a[96:99], a[60:63], v[96:99]
    s_sub_u32 s65, s57, s3
    s_sub_u32 s66, s64, 20
    v_mfma_f32_16x16x32_bf16 v[112:115], a[96:99], a[64:67], v[112:115]
    s_mul_i32 s67, s66, 86
    ds_read_b64_tr_b16 a[46:47], v15 offset:36768
    s_lshr_b32 s67, s67, 8
    v_mfma_f32_16x16x32_bf16 v[116:119], a[100:103], a[64:67], v[116:119]
    s_mul_i32 s3, s67, 3
    buffer_load_dwordx4 v11, s[8:11], s61 offen offset:3072 lds
    s_add_u32 m0, s63, 110592
    s_sub_u32 s66, s66, s3
    v_mfma_f32_16x16x32_bf16 v[120:123], a[64:67], a[104:107], v[120:123]
    s_mul_i32 s67, s67, 192
    ds_read_b64_tr_b16 a[48:49], v15 offset:33088
    s_cmp_ge_u32 s64, 47
    s_cselect_b32 s3, 1632, 0
    v_mfma_f32_16x16x32_bf16 v[124:127], a[108:111], a[64:67], v[124:127]
    s_sub_u32 s67, s67, s3
    s_mul_i32 s3, s66, 48
    v_mfma_f32_16x16x32_bf16 v[140:143], a[108:111], a[68:71], v[140:143]
    s_cmp_eq_u32 s66, 2
    s_cselect_b32 s3, 32, s3
    s_cselect_b32 s68, 48, 8
    s_cselect_b32 s69, 8, 16
    v_mfma_f32_16x16x32_bf16 v[136:139], a[68:71], a[104:107], v[136:139]
    s_add_u32 s67, s67, s3
    buffer_load_dwordx4 v12, s[8:11], s61 offen lds
    ds_read_b64_tr_b16 a[50:51], v15 offset:36928
    s_mov_b32 s7, 2211840
    v_mfma_f32_16x16x32_bf16 v[132:135], a[100:103], a[68:71], v[132:135]
    s_bfe_u32 s59, s30, 0x4000c
    ds_read_b64_tr_b16 a[52:53], v16 offset:32768
    s_mul_i32 s3, s64, 160
    v_mfma_f32_16x16x32_bf16 v[128:131], a[96:99], a[68:71], v[128:131]
    s_lshl_b32 s59, s59, 7
    s_sub_u32 s3, s3, 2544
    v_mfma_f32_16x16x32_bf16 v[144:147], a[96:99], a[72:75], v[144:147]
    s_cmp_lt_u32 s64, 20
    s_cselect_b32 s67, s3, s67
    s_cselect_b32 s68, 0x50, s68
    s_cselect_b32 s66, 40, 4
    v_mfma_f32_16x16x32_bf16 v[148:151], a[100:103], a[72:75], v[148:151]
    s_cselect_b32 s69, 20, s69
    s_cselect_b32 s24, s40, s48
    s_cselect_b32 s25, s41, s49
    s_cselect_b32 s26, 819200, s7
    v_mfma_f32_16x16x32_bf16 v[152:155], a[72:75], a[104:107], v[152:155]
    s_add_u32 s61, s58, s59
    ds_read_b64_tr_b16 a[54:55], v17 offset:32768
    ds_read_b128 a[4:7], v13 offset:2048
    s_mul_i32 s3, s64, 40
    v_mfma_f32_16x16x32_bf16 v[156:159], a[108:111], a[72:75], v[156:159]
    s_add_u32 m0, s62, 0
    s_cmp_lt_u32 s64, 16
    v_mfma_f32_16x16x32_bf16 v[172:175], a[108:111], a[76:79], v[172:175]
    s_cselect_b32 s67, s3, s67
    s_cselect_b32 s68, 20, s68
    s_cselect_b32 s66, 4, s66
    s_cselect_b32 s69, 8, s69
    v_mfma_f32_16x16x32_bf16 v[168:171], a[76:79], a[104:107], v[168:171]
    ds_read_b128 a[8:11], v13 offset:4096
    s_and_b32 s25, s25, 0xffff
    v_mfma_f32_16x16x32_bf16 v[164:167], a[100:103], a[76:79], v[164:167]
    s_mov_b32 s27, 0x20000
    ds_read_b128 a[12:15], v13 offset:6144
    s_cmp_lt_u32 s57, 740
    v_mfma_f32_16x16x32_bf16 v[160:163], a[96:99], a[76:79], v[160:163]
    s_cselect_b32 s26, s26, 0
    s_cselect_b32 s67, s67, 0
    s_cselect_b32 s3, 0, 1073741824
    v_add_u32_e64 v43, s3, v21
    v_mfma_f32_16x16x32_bf16 v[176:179], a[96:99], a[80:83], v[176:179]
    buffer_load_dwordx4 v4, s[12:15], s60 offen lds
    ds_read_b128 a[16:19], v13 offset:8192
    s_mul_i32 s67, s67, 1280
    v_mfma_f32_16x16x32_bf16 v[180:183], a[100:103], a[80:83], v[180:183]
    s_lshl_b32 s3, s65, 7
    v_mfma_f32_16x16x32_bf16 v[184:187], a[80:83], a[104:107], v[184:187]
    s_add_u32 s67, s67, s3
    ds_read_b128 a[20:23], v13 offset:10240
    s_mul_i32 s68, s68, 1280
    v_mfma_f32_16x16x32_bf16 v[188:191], a[108:111], a[80:83], v[188:191]
    s_mul_i32 s66, s66, 1280
    buffer_load_dwordx4 v5, s[12:15], s60 offen offset:1024 lds
    v_lshrrev_b32_e64 v1, 5, v0
    v_mfma_f32_16x16x32_bf16 v[204:207], a[108:111], a[84:87], v[204:207]
    ds_read_b128 a[24:27], v13 offset:12288
    v_mul_u32_u24_e64 v1, s69, v1
    v_mfma_f32_16x16x32_bf16 v[200:203], a[84:87], a[104:107], v[200:203]
    v_bfe_u32 v2, v0, 3, 2
    v_mfma_f32_16x16x32_bf16 v[196:199], a[100:103], a[84:87], v[196:199]
    buffer_load_dwordx4 v6, s[12:15], s60 offen offset:2048 lds
    v_add_u32_e64 v1, v1, v2
    v_mul_u32_u24 v1, 1280, v1
    v_mfma_f32_16x16x32_bf16 v[192:195], a[96:99], a[84:87], v[192:195]
    ds_read_b128 a[28:31], v13 offset:14336
    v_bfe_u32 v2, v0, 4, 1
    v_lshlrev_b32_e64 v2, 1, v2
    v_mfma_f32_16x16x32_bf16 v[208:211], a[96:99], a[88:91], v[208:211]
    v_and_b32_e64 v39, 7, v0
    ds_read_b128 a[32:35], v13 offset:16384
    v_xor_b32_e64 v2, v2, v39
    v_mfma_f32_16x16x32_bf16 v[212:215], a[100:103], a[88:91], v[212:215]
    buffer_load_dwordx4 v7, s[12:15], s60 offen offset:3072 lds
    v_lshl_add_u32 v39, v2, 4, v1
    v_xor_b32_e64 v40, 64, v39
    v_mfma_f32_16x16x32_bf16 v[216:219], a[88:91], a[104:107], v[216:219]
    s_add_u32 m0, s79, 147456
    ds_read_b128 a[36:39], v13 offset:18432
    s_mov_b32 s3, s67
    v_mfma_f32_16x16x32_bf16 v[220:223], a[108:111], a[88:91], v[220:223]
    s_add_u32 s60, s60, s0
    buffer_load_dwordx4 v39, s[24:27], s3 offen nt lds
    v_mfma_f32_16x16x32_bf16 v[236:239], a[108:111], a[92:95], v[236:239]
    s_add_u32 m0, s79, 148480
    s_add_u32 s3, s67, s66
    v_mfma_f32_16x16x32_bf16 v[232:235], a[92:95], a[104:107], v[232:235]
    buffer_load_dwordx4 v40, s[24:27], s3 offen nt lds
    v_mfma_f32_16x16x32_bf16 v[228:231], a[100:103], a[92:95], v[228:231]
    s_add_u32 m0, s79, 149504
    s_add_u32 s3, s67, s68
    buffer_load_dwordx4 v39, s[24:27], s3 offen nt lds
    s_add_u32 m0, s79, 150528
    v_mfma_f32_16x16x32_bf16 v[224:227], a[96:99], a[92:95], v[224:227]
    s_add_u32 s3, s3, s66
    buffer_load_dwordx4 v40, s[24:27], s3 offen nt lds
    s_bitcmp0_b32 s101, 1
    s_cbranch_scc1 L_nocs_qkv_1
    v_mfma_f32_16x16x32_bf16 a[176:179], a[200:203], a[96:99], a[176:179]
    v_mfma_f32_16x16x32_bf16 a[180:183], a[200:203], a[100:103], a[180:183]
    v_mfma_f32_16x16x32_bf16 a[184:187], a[200:203], a[104:107], a[184:187]
    v_mfma_f32_16x16x32_bf16 a[188:191], a[200:203], a[108:111], a[188:191]
L_nocs_qkv_1:
    s_waitcnt vmcnt(20) lgkmcnt(0)
    s_barrier
    v_mfma_f32_16x16x32_bf16 v[240:243], a[40:43], a[0:3], v[240:243]
    s_lshr_b32 s3, s100, 1
    ds_read_b128 a[56:59], v14 offset:0
    s_add_u32 m0, s63, 126976
    v_mfma_f32_16x16x32_bf16 v[244:247], a[44:47], a[0:3], v[244:247]
    s_lshl_b32 s3, s3, 7
    s_and_b32 s7, s100, 1
    v_mfma_f32_16x16x32_bf16 v[248:251], a[0:3], a[48:51], v[248:251]
    s_lshl_b32 s7, s7, 2
    ds_read_b64_tr_b16 a[96:97], v15 offset:49152
    v_mfma_f32_16x16x32_bf16 v[252:255], a[52:55], a[0:3], v[252:255]
    s_add_u32 s3, s3, s7
    v_mfma_f32_16x16x32_bf16 v[108:111], a[52:55], a[4:7], v[108:111]
    s_add_u32 s3, s3, s42
    buffer_load_dwordx4 v8, s[8:11], s61 offen lds
    ds_read_b64_tr_b16 a[98:99], v15 offset:52992
    v_mfma_f32_16x16x32_bf16 v[104:107], a[4:7], a[48:51], v[104:107]
    s_cmp_lt_u32 s100, 8
    s_cselect_b32 s3, s3, 1073741824
    v_mfma_f32_16x16x32_bf16 v[100:103], a[44:47], a[4:7], v[100:103]
    ds_read_b64_tr_b16 a[100:101], v15 offset:49312
    v_mfma_f32_16x16x32_bf16 v[96:99], a[40:43], a[4:7], v[96:99]
    v_lshrrev_b32 v1, 4, v0
    v_mfma_f32_16x16x32_bf16 v[112:115], a[40:43], a[8:11], v[112:115]
    ds_read_b64_tr_b16 a[102:103], v15 offset:53152
    v_and_b32_e64 v2, 15, v0
    v_mfma_f32_16x16x32_bf16 v[116:119], a[44:47], a[8:11], v[116:119]
    buffer_load_dwordx4 v9, s[8:11], s61 offen offset:1024 lds
    v_lshlrev_b32_e64 v2, 3, v2
    v_mfma_f32_16x16x32_bf16 v[120:123], a[8:11], a[48:51], v[120:123]
    s_add_u32 m0, s62, 16384
    v_lshl_add_u32 v1, v1, 9, v2
    ds_read_b64_tr_b16 a[104:105], v15 offset:49472
    v_mfma_f32_16x16x32_bf16 v[124:127], a[52:55], a[8:11], v[124:127]
    v_add_u32_e64 v44, s3, v1
    v_mfma_f32_16x16x32_bf16 v[140:143], a[52:55], a[12:15], v[140:143]
    v_mov_b32_e64 v48, -1
    ds_read_b64_tr_b16 a[106:107], v15 offset:53312
    v_mfma_f32_16x16x32_bf16 v[136:139], a[12:15], a[48:51], v[136:139]
    v_mfma_f32_16x16x32_bf16 v[132:135], a[44:47], a[12:15], v[132:135]
    buffer_store_dword v48, v44, s[20:23], 0 offen offset:0 sc1
    v_lshrrev_b32_e64 v1, 4, v0
    v_mfma_f32_16x16x32_bf16 v[128:131], a[40:43], a[12:15], v[128:131]
    ds_read_b64_tr_b16 a[108:109], v16 offset:49152
    v_bfe_u32 v2, v0, 2, 2
    v_mfma_f32_16x16x32_bf16 v[144:147], a[40:43], a[16:19], v[144:147]
    v_lshlrev_b32_e64 v2, 7, v2
    ds_read_b64_tr_b16 a[110:111], v17 offset:49152
    v_mfma_f32_16x16x32_bf16 v[148:151], a[44:47], a[16:19], v[148:151]
    v_lshl_add_u32 v1, v1, 10, v2
    v_and_b32_e64 v2, 3, v0
    v_mfma_f32_16x16x32_bf16 v[152:155], a[16:19], a[48:51], v[152:155]
    ds_read_b128 a[60:63], v14 offset:2048
    v_lshl_add_u32 v1, v2, 3, v1
    v_mfma_f32_16x16x32_bf16 v[156:159], a[52:55], a[16:19], v[156:159]
    buffer_load_dwordx4 v4, s[12:15], s60 offen lds
    v_bfe_u32 v2, v0, 3, 2
    v_mfma_f32_16x16x32_bf16 v[172:175], a[52:55], a[20:23], v[172:175]
    ds_read_b128 a[64:67], v14 offset:4096
    v_lshl_add_u32 v1, v2, 5, v1
    v_mfma_f32_16x16x32_bf16 v[168:171], a[20:23], a[48:51], v[168:171]
    s_add_u32 s3, s79, 147456
    v_mfma_f32_16x16x32_bf16 v[164:167], a[44:47], a[20:23], v[164:167]
    ds_read_b128 a[68:71], v14 offset:6144
    v_add_u32_e64 v39, s3, v1
    v_mfma_f32_16x16x32_bf16 v[160:163], a[40:43], a[20:23], v[160:163]
    v_xor_b32_e64 v40, 32, v39
    v_mfma_f32_16x16x32_bf16 v[176:179], a[40:43], a[24:27], v[176:179]
    buffer_load_dwordx4 v5, s[12:15], s60 offen offset:1024 lds
    v_xor_b32_e64 v41, 64, v39
    v_mfma_f32_16x16x32_bf16 v[180:183], a[44:47], a[24:27], v[180:183]
    ds_read_b128 a[72:75], v14 offset:8192
    v_xor_b32 v42, 96, v39
    v_mfma_f32_16x16x32_bf16 v[184:187], a[24:27], a[48:51], v[184:187]
    s_lshl_b32 s64, s57, 12
    ds_read_b128 a[76:79], v14 offset:10240
    s_add_u32 s64, s64, 16777216
    v_mfma_f32_16x16x32_bf16 v[188:191], a[52:55], a[24:27], v[188:191]
    v_mov_b32 v54, 0
    v_mfma_f32_16x16x32_bf16 v[204:207], a[52:55], a[28:31], v[204:207]
    ds_read_b128 a[80:83], v14 offset:12288
    v_mov_b32_e64 v55, 0
    v_mfma_f32_16x16x32_bf16 v[200:203], a[28:31], a[48:51], v[200:203]
    s_mov_b32 s7, 0x3f803f80
    buffer_load_dwordx4 v6, s[12:15], s60 offen offset:2048 lds
    v_mfma_f32_16x16x32_bf16 v[196:199], a[44:47], a[28:31], v[196:199]
    s_waitcnt vmcnt(21)
    ds_read_b128 a[84:87], v14 offset:14336
    v_mfma_f32_16x16x32_bf16 v[192:195], a[40:43], a[28:31], v[192:195]
    v_dot2c_f32_bf16 v54, s7, v24
    v_dot2c_f32_bf16 v55, v24, v24
    v_dot2c_f32_bf16 v54, s7, v25
    v_dot2c_f32_bf16 v55, v25, v25
    v_dot2c_f32_bf16 v54, s7, v26
    v_dot2c_f32_bf16 v55, v26, v26
    v_dot2c_f32_bf16 v54, s7, v27
    v_dot2c_f32_bf16 v55, v27, v27
    v_dot2c_f32_bf16 v54, s7, v28
    v_dot2c_f32_bf16 v55, v28, v28
    v_dot2c_f32_bf16 v54, s7, v29
    v_dot2c_f32_bf16 v55, v29, v29
    v_dot2c_f32_bf16 v54, s7, v30
    v_dot2c_f32_bf16 v55, v30, v30
    v_dot2c_f32_bf16 v54, s7, v31
    v_dot2c_f32_bf16 v55, v31, v31
    v_dot2c_f32_bf16 v54, s7, v32
    v_dot2c_f32_bf16 v55, v32, v32
    v_dot2c_f32_bf16 v54, s7, v33
    v_dot2c_f32_bf16 v55, v33, v33
    v_dot2c_f32_bf16 v54, s7, v34
    v_dot2c_f32_bf16 v55, v34, v34
    v_dot2c_f32_bf16 v54, s7, v35
    v_dot2c_f32_bf16_e64 v55, v35, v35
    v_mfma_f32_16x16x32_bf16 v[208:211], a[40:43], a[32:35], v[208:211]
    ds_read_b128 a[88:91], v14 offset:16384
    v_add_f32_dpp v54, v54, v54 row_ror:8 row_mask:0xf bank_mask:0xf
    v_mfma_f32_16x16x32_bf16 v[212:215], a[44:47], a[32:35], v[212:215]
    v_add_f32_dpp v55, v55, v55 row_ror:8 row_mask:0xf bank_mask:0xf
    v_mfma_f32_16x16x32_bf16 v[216:219], a[32:35], a[48:51], v[216:219]
    buffer_load_dwordx4 v7, s[12:15], s60 offen offset:3072 lds
    s_bfe_u32 s59, s30, 0x4000c
    v_mfma_f32_16x16x32_bf16 v[220:223], a[52:55], a[32:35], v[220:223]
    s_mul_i32 s59, s59, 245760
    v_add_f32_dpp v54, v54, v54 row_ror:4 row_mask:0xf bank_mask:0xf
    ds_read_b128 a[92:95], v14 offset:18432
    v_mfma_f32_16x16x32_bf16 v[236:239], a[52:55], a[36:39], v[236:239]
    s_add_u32 s60, s56, s59
    v_add_f32_dpp v55, v55, v55 row_ror:4 row_mask:0xf bank_mask:0xf
    v_add_f32_dpp v54, v54, v54 row_ror:2 row_mask:0xf bank_mask:0xf
    v_mfma_f32_16x16x32_bf16 v[232:235], a[36:39], a[48:51], v[232:235]
    v_add_f32_dpp v55, v55, v55 row_ror:2 row_mask:0xf bank_mask:0xf
    v_mfma_f32_16x16x32_bf16 v[228:231], a[44:47], a[36:39], v[228:231]
    v_add_f32_dpp v54, v54, v54 row_ror:1 row_mask:0xf bank_mask:0xf
    v_mfma_f32_16x16x32_bf16 v[224:227], a[40:43], a[36:39], v[224:227]
    v_add_f32_dpp v55, v55, v55 row_ror:1 row_mask:0xf bank_mask:0xf
    s_waitcnt vmcnt(11) lgkmcnt(0)
    s_barrier
    v_mfma_f32_16x16x32_bf16 v[240:243], a[96:99], a[56:59], v[240:243]
    s_waitcnt vmcnt(7)
    ds_read_b128 a[0:3], v13 offset:20480
    s_add_u32 m0, s63, 126976
    v_mfma_f32_16x16x32_bf16 v[244:247], a[100:103], a[56:59], v[244:247]
    ds_read_b64_tr_b16 a[216:217], v39 offset:0
    v_mfma_f32_16x16x32_bf16 v[248:251], a[56:59], a[104:107], v[248:251]
    buffer_load_dwordx4 v10, s[8:11], s61 offen offset:2048 lds
    ds_read_b64_tr_b16 a[40:41], v15 offset:0
    v_mfma_f32_16x16x32_bf16 v[252:255], a[108:111], a[56:59], v[252:255]
    ds_read_b64_tr_b16 a[218:219], v39 offset:512
    v_mfma_f32_16x16x32_bf16 v[108:111], a[108:111], a[60:63], v[108:111]
    ds_read_b64_tr_b16 a[220:221], v40 offset:0
    v_mfma_f32_16x16x32_bf16 v[104:107], a[60:63], a[104:107], v[104:107]
    ds_read_b64_tr_b16 a[42:43], v15 offset:3840
    v_mfma_f32_16x16x32_bf16 v[100:103], a[100:103], a[60:63], v[100:103]
    buffer_load_dwordx4 v11, s[8:11], s61 offen offset:3072 lds
    ds_read_b64_tr_b16 a[222:223], v40 offset:512
    v_mfma_f32_16x16x32_bf16 v[96:99], a[96:99], a[60:63], v[96:99]
    s_add_u32 m0, s63, 131072
    ds_read_b64_tr_b16 a[224:225], v41 offset:0
    ds_read_b64_tr_b16 a[44:45], v15 offset:160
    v_mfma_f32_16x16x32_bf16 v[112:115], a[96:99], a[64:67], v[112:115]
    ds_read_b64_tr_b16 a[226:227], v41 offset:512
    v_mfma_f32_16x16x32_bf16 v[116:119], a[100:103], a[64:67], v[116:119]
    ds_read_b64_tr_b16 a[228:229], v42 offset:0
    v_mfma_f32_16x16x32_bf16 v[120:123], a[64:67], a[104:107], v[120:123]
    buffer_load_dwordx4 v12, s[8:11], s61 offen lds
    ds_read_b64_tr_b16 a[46:47], v15 offset:4000
    v_mfma_f32_16x16x32_bf16 v[124:127], a[108:111], a[64:67], v[124:127]
    s_bfe_u32 s59, s30, 0x40010
    ds_read_b64_tr_b16 a[230:231], v42 offset:512
    v_mov_b32_e64 v24, v54
    v_mfma_f32_16x16x32_bf16 v[140:143], a[108:111], a[68:71], v[140:143]
    s_lshl_b32 s59, s59, 7
    ds_read_b64_tr_b16 a[48:49], v15 offset:320
    v_mov_b32 v25, v55
    v_mfma_f32_16x16x32_bf16 v[136:139], a[68:71], a[104:107], v[136:139]
    s_add_u32 s61, s58, s59
    ds_read_b64_tr_b16 a[50:51], v15 offset:4160
    v_mfma_f32_16x16x32_bf16 v[132:135], a[100:103], a[68:71], v[132:135]
    s_add_u32 m0, s63, 86016
    v_permlane16_swap_b32 v54, v24
    v_mfma_f32_16x16x32_bf16 v[128:131], a[96:99], a[68:71], v[128:131]
    v_permlane16_swap_b32_e64 v55, v25
    v_mfma_f32_16x16x32_bf16 v[144:147], a[96:99], a[72:75], v[144:147]
    ds_read_b64_tr_b16 a[52:53], v16 offset:0
    v_add_f32_e64 v54, v54, v24
    v_mfma_f32_16x16x32_bf16 v[148:151], a[100:103], a[72:75], v[148:151]
    v_add_f32_e64 v55, v55, v25
    ds_read_b64_tr_b16 a[54:55], v17 offset:0
    v_mfma_f32_16x16x32_bf16 v[152:155], a[72:75], a[104:107], v[152:155]
    v_mul_f32 v54, 0x3acccccd, v54
    ds_read_b128 a[4:7], v13 offset:22528
    v_mfma_f32_16x16x32_bf16 v[156:159], a[108:111], a[72:75], v[156:159]
    buffer_load_dwordx4 v8, s[8:11], s61 offen lds
    v_mul_f32 v55, 0x3acccccd, v55
    v_mfma_f32_16x16x32_bf16 v[172:175], a[108:111], a[76:79], v[172:175]
    v_fma_f32 v55, -v54, v54, v55
    ds_read_b128 a[8:11], v13 offset:24576
    v_mfma_f32_16x16x32_bf16 v[168:171], a[76:79], a[104:107], v[168:171]
    v_max_f32_e64 v55, 0, v55
    v_mfma_f32_16x16x32_bf16 v[164:167], a[100:103], a[76:79], v[164:167]
    v_cvt_pk_bf16_f32 v55, v55, v55
    ds_read_b128 a[12:15], v13 offset:26624
    v_mfma_f32_16x16x32_bf16 v[160:163], a[96:99], a[76:79], v[160:163]
    buffer_load_dwordx4 v9, s[8:11], s61 offen offset:1024 lds
    v_lshlrev_b32_e64 v55, 16, v55
    v_mfma_f32_16x16x32_bf16 v[176:179], a[96:99], a[80:83], v[176:179]
    s_add_u32 m0, s62, 32768
    ds_read_b128 a[16:19], v13 offset:28672
    v_add_f32 v55, 0x3727c5ac, v55
    v_mfma_f32_16x16x32_bf16 v[180:183], a[100:103], a[80:83], v[180:183]
    v_cvt_pk_bf16_f32 v55, v55, v55
    v_mfma_f32_16x16x32_bf16 v[184:187], a[80:83], a[104:107], v[184:187]
    ds_read_b128 a[20:23], v13 offset:30720
    v_lshlrev_b32_e64 v55, 16, v55
    v_mfma_f32_16x16x32_bf16 v[188:191], a[108:111], a[80:83], v[188:191]
    buffer_load_dwordx4 v4, s[12:15], s60 offen lds
    v_mfma_f32_16x16x32_bf16 v[204:207], a[108:111], a[84:87], v[204:207]
    v_sqrt_f32_e64 v55, v55
    v_mfma_f32_16x16x32_bf16 v[200:203], a[84:87], a[104:107], v[200:203]
    ds_read_b128 a[24:27], v13 offset:32768
    v_cvt_pk_bf16_f32 v54, -v54, -v54
    v_mfma_f32_16x16x32_bf16 v[196:199], a[100:103], a[84:87], v[196:199]
    v_cvt_pk_bf16_f32 v55, v55, v55
    ds_read_b128 a[28:31], v13 offset:34816
    v_mfma_f32_16x16x32_bf16 v[192:195], a[96:99], a[84:87], v[192:195]
    buffer_load_dwordx4 v5, s[12:15], s60 offen offset:1024 lds
    v_lshlrev_b32_e64 v55, 16, v55
    v_mfma_f32_16x16x32_bf16 v[208:211], a[96:99], a[88:91], v[208:211]
    ds_read_b128 a[32:35], v13 offset:36864
    v_mfma_f32_16x16x32_bf16 v[212:215], a[100:103], a[88:91], v[212:215]
    v_rcp_f32_e64 v55, v55
    v_mfma_f32_16x16x32_bf16 v[216:219], a[88:91], a[104:107], v[216:219]
    v_cndmask_b32 v54, v54, v55, s[74:75]
    ds_read_b128 a[36:39], v13 offset:38912
    v_mfma_f32_16x16x32_bf16 v[220:223], a[108:111], a[88:91], v[220:223]
    buffer_load_dwordx4 v6, s[12:15], s60 offen offset:2048 lds
    buffer_store_dword v54, v36, s[20:23], 0 offen sc1
    v_mfma_f32_16x16x32_bf16 v[236:239], a[108:111], a[92:95], v[236:239]
L_isl_qkv_1:
    s_cbranch_execz L_isl_qkv_5
    buffer_load_dwordx4 v7, s[12:15], s60 offen offset:3072 lds
    v_mfma_f32_16x16x32_bf16 v[232:235], a[92:95], a[104:107], v[232:235]
    s_add_u32 s60, s60, s0
    v_mfma_f32_16x16x32_bf16 v[228:231], a[100:103], a[92:95], v[228:231]
    v_mfma_f32_16x16x32_bf16 v[224:227], a[96:99], a[92:95], v[224:227]
    s_waitcnt vmcnt(10) lgkmcnt(0)
    s_barrier
    v_mfma_f32_16x16x32_bf16 v[240:243], a[40:43], a[0:3], v[240:243]
    s_add_u32 m0, s63, 86016
    ds_read_b128 a[56:59], v14 offset:20480
    v_mfma_f32_16x16x32_bf16 v[244:247], a[44:47], a[0:3], v[244:247]
    v_mfma_f32_16x16x32_bf16 v[248:251], a[0:3], a[48:51], v[248:251]
    buffer_load_dwordx4 v10, s[8:11], s61 offen offset:2048 lds
    ds_read_b64_tr_b16 a[96:97], v15 offset:16384
    v_mfma_f32_16x16x32_bf16 v[252:255], a[52:55], a[0:3], v[252:255]
    v_mfma_f32_16x16x32_bf16 v[108:111], a[52:55], a[4:7], v[108:111]
    ds_read_b64_tr_b16 a[98:99], v15 offset:20224
    v_mfma_f32_16x16x32_bf16 v[104:107], a[4:7], a[48:51], v[104:107]
    v_mfma_f32_16x16x32_bf16 v[100:103], a[44:47], a[4:7], v[100:103]
    buffer_load_dwordx4 v11, s[8:11], s61 offen offset:3072 lds
    ds_read_b64_tr_b16 a[100:101], v15 offset:16544
    v_mfma_f32_16x16x32_bf16 v[96:99], a[40:43], a[4:7], v[96:99]
    s_add_u32 m0, s63, 90112
    v_mfma_f32_16x16x32_bf16 v[112:115], a[40:43], a[8:11], v[112:115]
    ds_read_b64_tr_b16 a[102:103], v15 offset:20384
    v_mfma_f32_16x16x32_bf16 v[116:119], a[44:47], a[8:11], v[116:119]
    v_mfma_f32_16x16x32_bf16 v[120:123], a[8:11], a[48:51], v[120:123]
    buffer_load_dwordx4 v12, s[8:11], s61 offen lds
    ds_read_b64_tr_b16 a[104:105], v15 offset:16704
    v_mfma_f32_16x16x32_bf16 v[124:127], a[52:55], a[8:11], v[124:127]
    s_bfe_u32 s59, s30, 0x40014
    v_mfma_f32_16x16x32_bf16 v[140:143], a[52:55], a[12:15], v[140:143]
    s_lshl_b32 s59, s59, 7
    ds_read_b64_tr_b16 a[106:107], v15 offset:20544
    v_mfma_f32_16x16x32_bf16 v[136:139], a[12:15], a[48:51], v[136:139]
    s_add_u32 s61, s58, s59
    v_mfma_f32_16x16x32_bf16 v[132:135], a[44:47], a[12:15], v[132:135]
    s_add_u32 m0, s62, 49152
    buffer_store_dwordx4 a[216:219], v43, s[20:23], s64 offen offset:0 sc1
    ds_read_b64_tr_b16 a[108:109], v16 offset:16384
    v_mfma_f32_16x16x32_bf16 v[128:131], a[40:43], a[12:15], v[128:131]
    v_mfma_f32_16x16x32_bf16 v[144:147], a[40:43], a[16:19], v[144:147]
    ds_read_b64_tr_b16 a[110:111], v17 offset:16384
    v_mfma_f32_16x16x32_bf16 v[148:151], a[44:47], a[16:19], v[148:151]
    v_mfma_f32_16x16x32_bf16 v[152:155], a[16:19], a[48:51], v[152:155]
    ds_read_b128 a[60:63], v14 offset:22528
    v_mfma_f32_16x16x32_bf16 v[156:159], a[52:55], a[16:19], v[156:159]
    v_mfma_f32_16x16x32_bf16 v[172:175], a[52:55], a[20:23], v[172:175]
    ds_read_b128 a[64:67], v14 offset:24576
    v_mfma_f32_16x16x32_bf16 v[168:171], a[20:23], a[48:51], v[168:171]
    buffer_load_dwordx4 v4, s[12:15], s60 offen lds
    v_mfma_f32_16x16x32_bf16 v[164:167], a[44:47], a[20:23], v[164:167]
    ds_read_b128 a[68:71], v14 offset:26624
    v_mfma_f32_16x16x32_bf16 v[160:163], a[40:43], a[20:23], v[160:163]
    v_mfma_f32_16x16x32_bf16 v[176:179], a[40:43], a[24:27], v[176:179]
    ds_read_b128 a[72:75], v14 offset:28672
    v_mfma_f32_16x16x32_bf16 v[180:183], a[44:47], a[24:27], v[180:183]
    buffer_load_dwordx4 v5, s[12:15], s60 offen offset:1024 lds
    v_mfma_f32_16x16x32_bf16 v[184:187], a[24:27], a[48:51], v[184:187]
    ds_read_b128 a[76:79], v14 offset:30720
    v_mfma_f32_16x16x32_bf16 v[188:191], a[52:55], a[24:27], v[188:191]
    v_mfma_f32_16x16x32_bf16 v[204:207], a[52:55], a[28:31], v[204:207]
    ds_read_b128 a[80:83], v14 offset:32768
    v_mfma_f32_16x16x32_bf16 v[200:203], a[28:31], a[48:51], v[200:203]
    buffer_load_dwordx4 v6, s[12:15], s60 offen offset:2048 lds
    v_mfma_f32_16x16x32_bf16 v[196:199], a[44:47], a[28:31], v[196:199]
    ds_read_b128 a[84:87], v14 offset:34816
    v_mfma_f32_16x16x32_bf16 v[192:195], a[40:43], a[28:31], v[192:195]
    v_mfma_f32_16x16x32_bf16 v[208:211], a[40:43], a[32:35], v[208:211]
    ds_read_b128 a[88:91], v14 offset:36864
    v_mfma_f32_16x16x32_bf16 v[212:215], a[44:47], a[32:35], v[212:215]
    buffer_load_dwordx4 v7, s[12:15], s60 offen offset:3072 lds
    s_bfe_u32 s59, s30, 0x40010
    v_mfma_f32_16x16x32_bf16 v[216:219], a[32:35], a[48:51], v[216:219]
    s_mul_i32 s59, s59, 245760
    ds_read_b128 a[92:95], v14 offset:38912
    v_mfma_f32_16x16x32_bf16 v[220:223], a[52:55], a[32:35], v[220:223]
    s_add_u32 s60, s56, s59
    v_mfma_f32_16x16x32_bf16 v[236:239], a[52:55], a[36:39], v[236:239]
    v_mfma_f32_16x16x32_bf16 v[232:235], a[36:39], a[48:51], v[232:235]
    buffer_store_dwordx4 a[220:223], v43, s[20:23], s64 offen offset:1024 sc1
    v_mfma_f32_16x16x32_bf16 v[228:231], a[44:47], a[36:39], v[228:231]
    v_mfma_f32_16x16x32_bf16 v[224:227], a[40:43], a[36:39], v[224:227]
    s_bitcmp0_b32 s101, 4
    s_cbranch_scc1 L_nocs_qkv_4
    v_mfma_f32_16x16x32_bf16 a[176:179], a[200:203], a[40:43], a[176:179]
    v_mfma_f32_16x16x32_bf16 a[180:183], a[200:203], a[44:47], a[180:183]
    v_mfma_f32_16x16x32_bf16 a[184:187], a[200:203], a[48:51], a[184:187]
    v_mfma_f32_16x16x32_bf16 a[188:191], a[200:203], a[52:55], a[188:191]
L_nocs_qkv_4:
    s_waitcnt vmcnt(9) lgkmcnt(0)
    s_barrier
    v_mfma_f32_16x16x32_bf16 v[240:243], a[96:99], a[56:59], v[240:243]
    s_add_u32 m0, s63, 106496
    ds_read_b128 a[0:3], v13 offset:40960
    v_mfma_f32_16x16x32_bf16 v[244:247], a[100:103], a[56:59], v[244:247]
    buffer_store_dwordx4 a[224:227], v43, s[20:23], s64 offen offset:2048 sc1
    v_mfma_f32_16x16x32_bf16 v[248:251], a[56:59], a[104:107], v[248:251]
    ds_read_b64_tr_b16 a[40:41], v15 offset:32768
    v_mfma_f32_16x16x32_bf16 v[252:255], a[108:111], a[56:59], v[252:255]
    v_mfma_f32_16x16x32_bf16 v[108:111], a[108:111], a[60:63], v[108:111]
    ds_read_b64_tr_b16 a[42:43], v15 offset:36608
    v_mfma_f32_16x16x32_bf16 v[104:107], a[60:63], a[104:107], v[104:107]
    buffer_load_dwordx4 v8, s[8:11], s61 offen lds
    v_mfma_f32_16x16x32_bf16 v[100:103], a[100:103], a[60:63], v[100:103]
    ds_read_b64_tr_b16 a[44:45], v15 offset:32928
    v_mfma_f32_16x16x32_bf16 v[96:99], a[96:99], a[60:63], v[96:99]
    v_mfma_f32_16x16x32_bf16 v[112:115], a[96:99], a[64:67], v[112:115]
    ds_read_b64_tr_b16 a[46:47], v15 offset:36768
    v_mfma_f32_16x16x32_bf16 v[116:119], a[100:103], a[64:67], v[116:119]
    buffer_load_dwordx4 v9, s[8:11], s61 offen offset:1024 lds
    v_mfma_f32_16x16x32_bf16 v[120:123], a[64:67], a[104:107], v[120:123]
    s_add_u32 m0, s62, 0
    ds_read_b64_tr_b16 a[48:49], v15 offset:33088
    v_mfma_f32_16x16x32_bf16 v[124:127], a[108:111], a[64:67], v[124:127]
    v_mfma_f32_16x16x32_bf16 v[140:143], a[108:111], a[68:71], v[140:143]
    ds_read_b64_tr_b16 a[50:51], v15 offset:36928
    v_mfma_f32_16x16x32_bf16 v[136:139], a[68:71], a[104:107], v[136:139]
    buffer_store_dwordx4 a[228:231], v43, s[20:23], s64 offen offset:3072 sc1
    v_mfma_f32_16x16x32_bf16 v[132:135], a[100:103], a[68:71], v[132:135]
    ds_read_b64_tr_b16 a[52:53], v16 offset:32768
    v_mfma_f32_16x16x32_bf16 v[128:131], a[96:99], a[68:71], v[128:131]
    v_mfma_f32_16x16x32_bf16 v[144:147], a[96:99], a[72:75], v[144:147]
    ds_read_b64_tr_b16 a[54:55], v17 offset:32768
    v_mfma_f32_16x16x32_bf16 v[148:151], a[100:103], a[72:75], v[148:151]
    buffer_load_dwordx4 v4, s[12:15], s60 offen lds
    v_mfma_f32_16x16x32_bf16 v[152:155], a[72:75], a[104:107], v[152:155]
    ds_read_b128 a[4:7], v13 offset:43008
    v_mfma_f32_16x16x32_bf16 v[156:159], a[108:111], a[72:75], v[156:159]
    v_mfma_f32_16x16x32_bf16 v[172:175], a[108:111], a[76:79], v[172:175]
    ds_read_b128 a[8:11], v13 offset:45056
    v_mfma_f32_16x16x32_bf16 v[168:171], a[76:79], a[104:107], v[168:171]
    buffer_load_dwordx4 v5, s[12:15], s60 offen offset:1024 lds
    v_mfma_f32_16x16x32_bf16 v[164:167], a[100:103], a[76:79], v[164:167]
    ds_read_b128 a[12:15], v13 offset:47104
    v_mfma_f32_16x16x32_bf16 v[160:163], a[96:99], a[76:79], v[160:163]
    v_mfma_f32_16x16x32_bf16 v[176:179], a[96:99], a[80:83], v[176:179]
    ds_read_b128 a[16:19], v13 offset:49152
    v_mfma_f32_16x16x32_bf16 v[180:183], a[100:103], a[80:83], v[180:183]
    buffer_load_dwordx4 v6, s[12:15], s60 offen offset:2048 lds
    v_mfma_f32_16x16x32_bf16 v[184:187], a[80:83], a[104:107], v[184:187]
    ds_read_b128 a[20:23], v13 offset:51200
    v_mfma_f32_16x16x32_bf16 v[188:191], a[108:111], a[80:83], v[188:191]
    v_mfma_f32_16x16x32_bf16 v[204:207], a[108:111], a[84:87], v[204:207]
    ds_read_b128 a[24:27], v13 offset:53248
    v_mfma_f32_16x16x32_bf16 v[200:203], a[84:87], a[104:107], v[200:203]
    buffer_load_dword v47, off, s[32:35], 0 sc1
    v_mfma_f32_16x16x32_bf16 v[196:199], a[100:103], a[84:87], v[196:199]
    ds_read_b128 a[28:31], v13 offset:55296
    v_mfma_f32_16x16x32_bf16 v[192:195], a[96:99], a[84:87], v[192:195]
    v_mfma_f32_16x16x32_bf16 v[208:211], a[96:99], a[88:91], v[208:211]
    ds_read_b128 a[32:35], v13 offset:57344
    v_mfma_f32_16x16x32_bf16 v[212:215], a[100:103], a[88:91], v[212:215]
    buffer_load_dwordx4 v7, s[12:15], s60 offen offset:3072 lds
    s_add_u32 s60, s60, s0
    v_mfma_f32_16x16x32_bf16 v[216:219], a[88:91], a[104:107], v[216:219]
    ds_read_b128 a[36:39], v13 offset:59392
    v_mfma_f32_16x16x32_bf16 v[220:223], a[108:111], a[88:91], v[220:223]
    v_mfma_f32_16x16x32_bf16 v[236:239], a[108:111], a[92:95], v[236:239]
    v_mfma_f32_16x16x32_bf16 v[232:235], a[92:95], a[104:107], v[232:235]
    v_mfma_f32_16x16x32_bf16 v[228:231], a[100:103], a[92:95], v[228:231]
    v_mfma_f32_16x16x32_bf16 v[224:227], a[96:99], a[92:95], v[224:227]
    s_bitcmp0_b32 s101, 5
    s_cbranch_scc1 L_nocs_qkv_5
    v_mfma_f32_16x16x32_bf16 a[176:179], a[200:203], a[96:99], a[176:179]
    v_mfma_f32_16x16x32_bf16 a[180:183], a[200:203], a[100:103], a[180:183]
    v_mfma_f32_16x16x32_bf16 a[184:187], a[200:203], a[104:107], a[184:187]
    v_mfma_f32_16x16x32_bf16 a[188:191], a[200:203], a[108:111], a[188:191]
L_nocs_qkv_5:
    s_waitcnt vmcnt(10) lgkmcnt(0)
    s_barrier
    v_mfma_f32_16x16x32_bf16 v[240:243], a[40:43], a[0:3], v[240:243]
    s_add_u32 m0, s63, 106496
    ds_read_b128 a[56:59], v14 offset:40960
    v_mfma_f32_16x16x32_bf16 v[244:247], a[44:47], a[0:3], v[244:247]
    v_mfma_f32_16x16x32_bf16 v[248:251], a[0:3], a[48:51], v[248:251]
    buffer_load_dwordx4 v10, s[8:11], s61 offen offset:2048 lds
    ds_read_b64_tr_b16 a[96:97], v15 offset:49152
    v_mfma_f32_16x16x32_bf16 v[252:255], a[52:55], a[0:3], v[252:255]
    v_mfma_f32_16x16x32_bf16 v[108:111], a[52:55], a[4:7], v[108:111]
    ds_read_b64_tr_b16 a[98:99], v15 offset:52992
    v_mfma_f32_16x16x32_bf16 v[104:107], a[4:7], a[48:51], v[104:107]
    v_mfma_f32_16x16x32_bf16 v[100:103], a[44:47], a[4:7], v[100:103]
    ds_read_b64_tr_b16 a[100:101], v15 offset:49312
    v_mfma_f32_16x16x32_bf16 v[96:99], a[40:43], a[4:7], v[96:99]
    buffer_load_dwordx4 v11, s[8:11], s61 offen offset:3072 lds
    s_add_u32 m0, s63, 110592
    v_mfma_f32_16x16x32_bf16 v[112:115], a[40:43], a[8:11], v[112:115]
    ds_read_b64_tr_b16 a[102:103], v15 offset:53152
    v_mfma_f32_16x16x32_bf16 v[116:119], a[44:47], a[8:11], v[116:119]
    v_mfma_f32_16x16x32_bf16 v[120:123], a[8:11], a[48:51], v[120:123]
    ds_read_b64_tr_b16 a[104:105], v15 offset:49472
    v_mfma_f32_16x16x32_bf16 v[124:127], a[52:55], a[8:11], v[124:127]
    v_mfma_f32_16x16x32_bf16 v[140:143], a[52:55], a[12:15], v[140:143]
    buffer_load_dwordx4 v12, s[8:11], s61 offen lds
    s_bfe_u32 s59, s30, 0x40018
    v_mfma_f32_16x16x32_bf16 v[136:139], a[12:15], a[48:51], v[136:139]
    s_lshl_b32 s59, s59, 7
    ds_read_b64_tr_b16 a[106:107], v15 offset:53312
    v_mfma_f32_16x16x32_bf16 v[132:135], a[44:47], a[12:15], v[132:135]
    s_add_u32 s61, s58, s59
    ds_read_b64_tr_b16 a[108:109], v16 offset:49152
    v_mfma_f32_16x16x32_bf16 v[128:131], a[40:43], a[12:15], v[128:131]
    s_add_u32 m0, s62, 16384
    v_mfma_f32_16x16x32_bf16 v[144:147], a[40:43], a[16:19], v[144:147]
    ds_read_b64_tr_b16 a[110:111], v17 offset:49152
    v_mfma_f32_16x16x32_bf16 v[148:151], a[44:47], a[16:19], v[148:151]
    v_mfma_f32_16x16x32_bf16 v[152:155], a[16:19], a[48:51], v[152:155]
    ds_read_b128 a[60:63], v14 offset:43008
    v_mfma_f32_16x16x32_bf16 v[156:159], a[52:55], a[16:19], v[156:159]
    v_mfma_f32_16x16x32_bf16 v[172:175], a[52:55], a[20:23], v[172:175]
    ds_read_b128 a[64:67], v14 offset:45056
    v_mfma_f32_16x16x32_bf16 v[168:171], a[20:23], a[48:51], v[168:171]
    buffer_load_dwordx4 v4, s[12:15], s60 offen lds
    v_mfma_f32_16x16x32_bf16 v[164:167], a[44:47], a[20:23], v[164:167]
    ds_read_b128 a[68:71], v14 offset:47104
    v_mfma_f32_16x16x32_bf16 v[160:163], a[40:43], a[20:23], v[160:163]
    v_mfma_f32_16x16x32_bf16 v[176:179], a[40:43], a[24:27], v[176:179]
    ds_read_b128 a[72:75], v14 offset:49152
    v_mfma_f32_16x16x32_bf16 v[180:183], a[44:47], a[24:27], v[180:183]
    v_mfma_f32_16x16x32_bf16 v[184:187], a[24:27], a[48:51], v[184:187]
    buffer_load_dwordx4 v5, s[12:15], s60 offen offset:1024 lds
    ds_read_b128 a[76:79], v14 offset:51200
    v_mfma_f32_16x16x32_bf16 v[188:191], a[52:55], a[24:27], v[188:191]
    v_mfma_f32_16x16x32_bf16 v[204:207], a[52:55], a[28:31], v[204:207]
    ds_read_b128 a[80:83], v14 offset:53248
    v_mfma_f32_16x16x32_bf16 v[200:203], a[28:31], a[48:51], v[200:203]
    v_mfma_f32_16x16x32_bf16 v[196:199], a[44:47], a[28:31], v[196:199]
    ds_read_b128 a[84:87], v14 offset:55296
    v_mfma_f32_16x16x32_bf16 v[192:195], a[40:43], a[28:31], v[192:195]
    buffer_load_dwordx4 v6, s[12:15], s60 offen offset:2048 lds
    v_mfma_f32_16x16x32_bf16 v[208:211], a[40:43], a[32:35], v[208:211]
    ds_read_b128 a[88:91], v14 offset:57344
    v_mfma_f32_16x16x32_bf16 v[212:215], a[44:47], a[32:35], v[212:215]
    v_mfma_f32_16x16x32_bf16 v[216:219], a[32:35], a[48:51], v[216:219]
    ds_read_b128 a[92:95], v14 offset:59392
    v_mfma_f32_16x16x32_bf16 v[220:223], a[52:55], a[32:35], v[220:223]
    v_mfma_f32_16x16x32_bf16 v[236:239], a[52:55], a[36:39], v[236:239]
    buffer_load_dwordx4 v7, s[12:15], s60 offen offset:3072 lds
    s_bfe_u32 s59, s30, 0x40014
    s_mul_i32 s59, s59, 245760
    v_mfma_f32_16x16x32_bf16 v[232:235], a[36:39], a[48:51], v[232:235]
    s_add_u32 s60, s56, s59
    v_mfma_f32_16x16x32_bf16 v[228:231], a[44:47], a[36:39], v[228:231]
    v_mfma_f32_16x16x32_bf16 v[224:227], a[40:43], a[36:39], v[224:227]
    s_waitcnt vmcnt(7) lgkmcnt(0)
    s_barrier
    v_cmp_eq_u32_e64 vcc, 0, v47
    v_mfma_f32_16x16x32_bf16 v[240:243], a[96:99], a[56:59], v[240:243]
    ds_read_b128 a[0:3], v13 offset:0
    v_mfma_f32_16x16x32_bf16 v[244:247], a[100:103], a[56:59], v[244:247]
    s_cbranch_vccnz L_slow_rqkv
L_ok_rqkv:
    v_mfma_f32_16x16x32_bf16 v[248:251], a[56:59], a[104:107], v[248:251]
    s_add_u32 m0, s63, 126976
    ds_read_b64_tr_b16 a[40:41], v15 offset:0
    v_mfma_f32_16x16x32_bf16 v[252:255], a[108:111], a[56:59], v[252:255]
    v_mfma_f32_16x16x32_bf16 v[108:111], a[108:111], a[60:63], v[108:111]
    ds_read_b64_tr_b16 a[42:43], v15 offset:3840
    v_mfma_f32_16x16x32_bf16 v[104:107], a[60:63], a[104:107], v[104:107]
    v_or_b32 v1, s4, v0
    v_mfma_f32_16x16x32_bf16 v[100:103], a[100:103], a[60:63], v[100:103]
    ds_read_b64_tr_b16 a[44:45], v15 offset:160
    v_mfma_f32_16x16x32_bf16 v[96:99], a[96:99], a[60:63], v[96:99]
    buffer_load_dwordx4 v8, s[8:11], s61 offen lds
    v_mfma_f32_16x16x32_bf16 v[112:115], a[96:99], a[64:67], v[112:115]
    ds_read_b64_tr_b16 a[46:47], v15 offset:4000
    v_mfma_f32_16x16x32_bf16 v[116:119], a[100:103], a[64:67], v[116:119]
    v_mfma_f32_16x16x32_bf16 v[120:123], a[64:67], a[104:107], v[120:123]
    ds_read_b64_tr_b16 a[48:49], v15 offset:320
    v_cmp_eq_u32 s[70:71], 0, v1
    v_mfma_f32_16x16x32_bf16 v[124:127], a[108:111], a[64:67], v[124:127]
    s_lshl_b32 s3, s2, 4
    v_mfma_f32_16x16x32_bf16 v[140:143], a[108:111], a[68:71], v[140:143]
    s_add_u32 s3, s3, 23134208
    buffer_load_dwordx4 v9, s[8:11], s61 offen offset:1024 lds
    ds_read_b64_tr_b16 a[50:51], v15 offset:4160
    v_mfma_f32_16x16x32_bf16 v[136:139], a[68:71], a[104:107], v[136:139]
    s_add_u32 m0, s62, 32768
    v_mfma_f32_16x16x32_bf16 v[132:135], a[100:103], a[68:71], v[132:135]
    ds_read_b64_tr_b16 a[52:53], v16 offset:0
    v_mfma_f32_16x16x32_bf16 v[128:131], a[96:99], a[68:71], v[128:131]
    v_mfma_f32_16x16x32_bf16 v[144:147], a[96:99], a[72:75], v[144:147]
    ds_read_b64_tr_b16 a[54:55], v17 offset:0
    v_mfma_f32_16x16x32_bf16 v[148:151], a[100:103], a[72:75], v[148:151]
    v_mfma_f32_16x16x32_bf16 v[152:155], a[72:75], a[104:107], v[152:155]
    buffer_load_dwordx4 v4, s[12:15], s60 offen lds
    ds_read_b128 a[4:7], v13 offset:2048
    v_mfma_f32_16x16x32_bf16 v[156:159], a[108:111], a[72:75], v[156:159]
    v_mfma_f32_16x16x32_bf16 v[172:175], a[108:111], a[76:79], v[172:175]
    ds_read_b128 a[8:11], v13 offset:4096
    v_mfma_f32_16x16x32_bf16 v[168:171], a[76:79], a[104:107], v[168:171]
    v_mfma_f32_16x16x32_bf16 v[164:167], a[100:103], a[76:79], v[164:167]
    ds_read_b128 a[12:15], v13 offset:6144
    v_mfma_f32_16x16x32_bf16 v[160:163], a[96:99], a[76:79], v[160:163]
    buffer_load_dwordx4 v5, s[12:15], s60 offen offset:1024 lds
    v_mfma_f32_16x16x32_bf16 v[176:179], a[96:99], a[80:83], v[176:179]
    ds_read_b128 a[16:19], v13 offset:8192
    v_mfma_f32_16x16x32_bf16 v[180:183], a[100:103], a[80:83], v[180:183]
    v_mov_b32 v2, 1
    v_mfma_f32_16x16x32_bf16 v[184:187], a[80:83], a[104:107], v[184:187]
    ds_read_b128 a[20:23], v13 offset:10240
    v_mfma_f32_16x16x32_bf16 v[188:191], a[108:111], a[80:83], v[188:191]
    v_mfma_f32_16x16x32_bf16 v[204:207], a[108:111], a[84:87], v[204:207]
    buffer_load_dwordx4 v6, s[12:15], s60 offen offset:2048 lds
    ds_read_b128 a[24:27], v13 offset:12288
    v_mfma_f32_16x16x32_bf16 v[200:203], a[84:87], a[104:107], v[200:203]
    v_mfma_f32_16x16x32_bf16 v[196:199], a[100:103], a[84:87], v[196:199]
    ds_read_b128 a[28:31], v13 offset:14336
    v_cndmask_b32 v1, v38, 0, s[70:71]
    v_mfma_f32_16x16x32_bf16 v[192:195], a[96:99], a[84:87], v[192:195]
    v_mfma_f32_16x16x32_bf16 v[208:211], a[96:99], a[88:91], v[208:211]
    ds_read_b128 a[32:35], v13 offset:16384
    v_mfma_f32_16x16x32_bf16 v[212:215], a[100:103], a[88:91], v[212:215]
    buffer_load_dwordx4 v7, s[12:15], s60 offen offset:3072 lds
    s_add_u32 s60, s60, s0
    v_mfma_f32_16x16x32_bf16 v[216:219], a[88:91], a[104:107], v[216:219]
    ds_read_b128 a[36:39], v13 offset:18432
    v_mfma_f32_16x16x32_bf16 v[220:223], a[108:111], a[88:91], v[220:223]
    v_mfma_f32_16x16x32_bf16 v[236:239], a[108:111], a[92:95], v[236:239]
    v_mfma_f32_16x16x32_bf16 v[232:235], a[92:95], a[104:107], v[232:235]
    v_mfma_f32_16x16x32_bf16 v[228:231], a[100:103], a[92:95], v[228:231]
    buffer_store_dword v2, v1, s[20:23], s3 offen sc1
    v_mfma_f32_16x16x32_bf16 v[224:227], a[96:99], a[92:95], v[224:227]
    s_waitcnt vmcnt(7) lgkmcnt(0)
    s_barrier
    v_mfma_f32_16x16x32_bf16 v[240:243], a[40:43], a[0:3], v[240:243]
    s_and_b32 s3, s2, 1
    ds_read_b128 a[56:59], v14 offset:0
    s_add_u32 m0, s63, 126976
    v_mfma_f32_16x16x32_bf16 v[244:247], a[44:47], a[0:3], v[244:247]
    s_lshl_b32 s3, s3, 4
    v_mfma_f32_16x16x32_bf16 v[248:251], a[0:3], a[48:51], v[248:251]
    s_lshr_b32 s7, s2, 5
    ds_read_b64_tr_b16 a[96:97], v15 offset:16384
    v_mfma_f32_16x16x32_bf16 v[252:255], a[52:55], a[0:3], v[252:255]
    s_add_u32 s36, s3, s7
    buffer_load_dwordx4 v10, s[8:11], s61 offen offset:2048 lds
    v_mfma_f32_16x16x32_bf16 v[108:111], a[52:55], a[4:7], v[108:111]
    s_and_b32 s3, s2, 2
    ds_read_b64_tr_b16 a[98:99], v15 offset:20224
    v_mfma_f32_16x16x32_bf16 v[104:107], a[4:7], a[48:51], v[104:107]
    s_lshl_b32 s3, s3, 2
    v_mfma_f32_16x16x32_bf16 v[100:103], a[44:47], a[4:7], v[100:103]
    s_add_u32 s36, s36, s3
    ds_read_b64_tr_b16 a[100:101], v15 offset:16544
    v_mfma_f32_16x16x32_bf16 v[96:99], a[40:43], a[4:7], v[96:99]
    v_mfma_f32_16x16x32_bf16 v[112:115], a[40:43], a[8:11], v[112:115]
    s_and_b32 s3, s2, 4
    buffer_load_dwordx4 v11, s[8:11], s61 offen offset:3072 lds
    s_add_u32 m0, s63, 131072
    v_mfma_f32_16x16x32_bf16 v[116:119], a[44:47], a[8:11], v[116:119]
    s_bfe_u32 s7, s2, 0x20003
    ds_read_b64_tr_b16 a[102:103], v15 offset:20384
    v_mfma_f32_16x16x32_bf16 v[120:123], a[8:11], a[48:51], v[120:123]
    ds_read_b64_tr_b16 a[104:105], v15 offset:16704
    v_mfma_f32_16x16x32_bf16 v[124:127], a[52:55], a[8:11], v[124:127]
    s_add_u32 s37, s3, s7
    v_mfma_f32_16x16x32_bf16 v[140:143], a[52:55], a[12:15], v[140:143]
    s_and_b32 s3, s36, 1
    ds_read_b64_tr_b16 a[106:107], v15 offset:20544
    v_mfma_f32_16x16x32_bf16 v[136:139], a[12:15], a[48:51], v[136:139]
    buffer_load_dwordx4 v12, s[8:11], s61 offen lds
    s_bfe_u32 s59, s30, 0x4001c
    v_mfma_f32_16x16x32_bf16 v[132:135], a[44:47], a[12:15], v[132:135]
    s_lshl_b32 s59, s59, 7
    ds_read_b64_tr_b16 a[108:109], v16 offset:16384
    v_mfma_f32_16x16x32_bf16 v[128:131], a[40:43], a[12:15], v[128:131]
    s_add_u32 s61, s58, s59
    v_mfma_f32_16x16x32_bf16 v[144:147], a[40:43], a[16:19], v[144:147]
    s_mul_i32 s69, s3, 27
    ds_read_b64_tr_b16 a[110:111], v17 offset:16384
    v_mfma_f32_16x16x32_bf16 v[148:151], a[44:47], a[16:19], v[148:151]
    s_add_u32 m0, s62, 49152
    v_mfma_f32_16x16x32_bf16 v[152:155], a[16:19], a[48:51], v[152:155]
    s_mul_i32 s7, s4, 7
    ds_read_b128 a[60:63], v14 offset:2048
    v_mfma_f32_16x16x32_bf16 v[156:159], a[52:55], a[16:19], v[156:159]
    s_add_u32 s7, s7, 20
    v_mfma_f32_16x16x32_bf16 v[172:175], a[52:55], a[20:23], v[172:175]
    s_add_u32 s48, s7, s69
    ds_read_b128 a[64:67], v14 offset:4096
    v_mfma_f32_16x16x32_bf16 v[168:171], a[20:23], a[48:51], v[168:171]
    s_sub_u32 s49, s7, s69
    buffer_load_dwordx4 v4, s[12:15], s60 offen lds
    v_mfma_f32_16x16x32_bf16 v[164:167], a[44:47], a[20:23], v[164:167]
    s_add_u32 s49, s49, 27
    ds_read_b128 a[68:71], v14 offset:6144
    v_mfma_f32_16x16x32_bf16 v[160:163], a[40:43], a[20:23], v[160:163]
    v_mfma_f32_16x16x32_bf16 v[176:179], a[40:43], a[24:27], v[176:179]
    s_mul_i32 s57, s4, 5
    ds_read_b128 a[72:75], v14 offset:8192
    v_mfma_f32_16x16x32_bf16 v[180:183], a[44:47], a[24:27], v[180:183]
    s_mul_i32 s7, s37, 5120
    v_mfma_f32_16x16x32_bf16 v[184:187], a[24:27], a[48:51], v[184:187]
    buffer_load_dwordx4 v5, s[12:15], s60 offen offset:1024 lds
    ds_read_b128 a[76:79], v14 offset:10240
    v_mfma_f32_16x16x32_bf16 v[188:191], a[52:55], a[24:27], v[188:191]
    s_add_u32 s7, s7, 16773120
    v_mfma_f32_16x16x32_bf16 v[204:207], a[52:55], a[28:31], v[204:207]
    s_mul_i32 s69, s48, 40960
    ds_read_b128 a[80:83], v14 offset:12288
    v_mfma_f32_16x16x32_bf16 v[200:203], a[28:31], a[48:51], v[200:203]
    v_mfma_f32_16x16x32_bf16 v[196:199], a[44:47], a[28:31], v[196:199]
    s_add_u32 s38, s69, s7
    ds_read_b128 a[84:87], v14 offset:14336
    v_mfma_f32_16x16x32_bf16 v[192:195], a[40:43], a[28:31], v[192:195]
    buffer_load_dwordx4 v6, s[12:15], s60 offen offset:2048 lds
    v_mfma_f32_16x16x32_bf16 v[208:211], a[40:43], a[32:35], v[208:211]
    s_mul_i32 s69, s49, 40960
    ds_read_b128 a[88:91], v14 offset:16384
    v_mfma_f32_16x16x32_bf16 v[212:215], a[44:47], a[32:35], v[212:215]
    s_add_u32 s39, s69, s7
    v_mfma_f32_16x16x32_bf16 v[216:219], a[32:35], a[48:51], v[216:219]
    ds_read_b128 a[92:95], v14 offset:18432
    v_mfma_f32_16x16x32_bf16 v[220:223], a[52:55], a[32:35], v[220:223]
    s_mul_i32 s69, s57, 40960
    v_mfma_f32_16x16x32_bf16 v[236:239], a[52:55], a[36:39], v[236:239]
    buffer_load_dwordx4 v7, s[12:15], s60 offen offset:3072 lds
    s_bfe_u32 s59, s30, 0x40018
    s_mul_i32 s59, s59, 245760
    v_mfma_f32_16x16x32_bf16 v[232:235], a[36:39], a[48:51], v[232:235]
    s_add_u32 s60, s56, s59
    v_mfma_f32_16x16x32_bf16 v[228:231], a[44:47], a[36:39], v[228:231]
    v_mfma_f32_16x16x32_bf16 v[224:227], a[40:43], a[36:39], v[224:227]
    s_waitcnt vmcnt(8) lgkmcnt(0)
    s_barrier
    v_mfma_f32_16x16x32_bf16 v[240:243], a[96:99], a[56:59], v[240:243]
    s_add_u32 s40, s69, s7
    ds_read_b128 a[0:3], v13 offset:20480
    s_add_u32 m0, s63, 86016
    v_mfma_f32_16x16x32_bf16 v[244:247], a[100:103], a[56:59], v[244:247]
    s_mul_i32 s7, s36, 296
    v_mfma_f32_16x16x32_bf16 v[248:251], a[56:59], a[104:107], v[248:251]
    s_add_u32 s7, s7, s48
    ds_read_b64_tr_b16 a[40:41], v15 offset:32768
    v_mfma_f32_16x16x32_bf16 v[252:255], a[108:111], a[56:59], v[252:255]
    s_lshl_b32 s7, s7, 10
    v_mfma_f32_16x16x32_bf16 v[108:111], a[108:111], a[60:63], v[108:111]
    s_add_u32 s7, s7, 1048576
    buffer_load_dwordx4 v8, s[8:11], s61 offen lds
    ds_read_b64_tr_b16 a[42:43], v15 offset:36608
    v_mfma_f32_16x16x32_bf16 v[104:107], a[60:63], a[104:107], v[104:107]
    s_add_u32 s69, s4, 0
    v_mfma_f32_16x16x32_bf16 v[100:103], a[100:103], a[60:63], v[100:103]
    s_and_b32 s69, s69, 3
    ds_read_b64_tr_b16 a[44:45], v15 offset:32928
    v_mfma_f32_16x16x32_bf16 v[96:99], a[96:99], a[60:63], v[96:99]
    s_mul_i32 s69, s69, 75776
    v_mfma_f32_16x16x32_bf16 v[112:115], a[96:99], a[64:67], v[112:115]
    ds_read_b64_tr_b16 a[46:47], v15 offset:36768
    v_mfma_f32_16x16x32_bf16 v[116:119], a[100:103], a[64:67], v[116:119]
    s_add_u32 s44, s69, s7
    buffer_load_dwordx4 v9, s[8:11], s61 offen offset:1024 lds
    v_mfma_f32_16x16x32_bf16 v[120:123], a[64:67], a[104:107], v[120:123]
    s_add_u32 m0, s62, 0
    ds_read_b64_tr_b16 a[48:49], v15 offset:33088
    v_mfma_f32_16x16x32_bf16 v[124:127], a[108:111], a[64:67], v[124:127]
    s_add_u32 s69, s4, 1
    v_mfma_f32_16x16x32_bf16 v[140:143], a[108:111], a[68:71], v[140:143]
    s_and_b32 s69, s69, 3
    ds_read_b64_tr_b16 a[50:51], v15 offset:36928
    v_mfma_f32_16x16x32_bf16 v[136:139], a[68:71], a[104:107], v[136:139]
    s_mul_i32 s69, s69, 75776
    v_mfma_f32_16x16x32_bf16 v[132:135], a[100:103], a[68:71], v[132:135]
    ds_read_b64_tr_b16 a[52:53], v16 offset:32768
    v_mfma_f32_16x16x32_bf16 v[128:131], a[96:99], a[68:71], v[128:131]
    s_add_u32 s45, s69, s7
    v_mfma_f32_16x16x32_bf16 v[144:147], a[96:99], a[72:75], v[144:147]
    s_add_u32 s69, s4, 2
    buffer_load_dwordx4 v4, s[12:15], s60 offen lds
    ds_read_b64_tr_b16 a[54:55], v17 offset:32768
    v_mfma_f32_16x16x32_bf16 v[148:151], a[100:103], a[72:75], v[148:151]
    v_mfma_f32_16x16x32_bf16 v[152:155], a[72:75], a[104:107], v[152:155]
    s_and_b32 s69, s69, 3
    ds_read_b128 a[4:7], v13 offset:22528
    v_mfma_f32_16x16x32_bf16 v[156:159], a[108:111], a[72:75], v[156:159]
    v_mfma_f32_16x16x32_bf16 v[172:175], a[108:111], a[76:79], v[172:175]
    s_mul_i32 s69, s69, 75776
    ds_read_b128 a[8:11], v13 offset:24576
    v_mfma_f32_16x16x32_bf16 v[168:171], a[76:79], a[104:107], v[168:171]
    s_add_u32 s46, s69, s7
    buffer_load_dwordx4 v5, s[12:15], s60 offen offset:1024 lds
    v_mfma_f32_16x16x32_bf16 v[164:167], a[100:103], a[76:79], v[164:167]
    ds_read_b128 a[12:15], v13 offset:26624
    v_mfma_f32_16x16x32_bf16 v[160:163], a[96:99], a[76:79], v[160:163]
    s_add_u32 s69, s4, 3
    v_mfma_f32_16x16x32_bf16 v[176:179], a[96:99], a[80:83], v[176:179]
    s_and_b32 s69, s69, 3
    ds_read_b128 a[16:19], v13 offset:28672
    v_mfma_f32_16x16x32_bf16 v[180:183], a[100:103], a[80:83], v[180:183]
    v_mfma_f32_16x16x32_bf16 v[184:187], a[80:83], a[104:107], v[184:187]
    s_mul_i32 s69, s69, 75776
    buffer_load_dwordx4 v6, s[12:15], s60 offen offset:2048 lds
    ds_read_b128 a[20:23], v13 offset:30720
    v_mfma_f32_16x16x32_bf16 v[188:191], a[108:111], a[80:83], v[188:191]
    s_add_u32 s47, s69, s7
    v_mfma_f32_16x16x32_bf16 v[204:207], a[108:111], a[84:87], v[204:207]
    ds_read_b128 a[24:27], v13 offset:32768
    v_mfma_f32_16x16x32_bf16 v[200:203], a[84:87], a[104:107], v[200:203]
    s_sub_u32 s57, s57, s49
    v_mfma_f32_16x16x32_bf16 v[196:199], a[100:103], a[84:87], v[196:199]
    s_sub_u32 s48, s49, s48
    ds_read_b128 a[28:31], v13 offset:34816
    v_mfma_f32_16x16x32_bf16 v[192:195], a[96:99], a[84:87], v[192:195]
    buffer_load_dwordx4 v7, s[12:15], s60 offen offset:3072 lds
    v_mfma_f32_16x16x32_bf16 v[208:211], a[96:99], a[88:91], v[208:211]
    s_add_u32 s60, s60, s0
    ds_read_b128 a[32:35], v13 offset:36864
    v_mfma_f32_16x16x32_bf16 v[212:215], a[100:103], a[88:91], v[212:215]
    s_cmp_eq_u32 s4, 3
    s_cselect_b32 s41, 1, 0
    v_mfma_f32_16x16x32_bf16 v[216:219], a[88:91], a[104:107], v[216:219]
    ds_read_b128 a[36:39], v13 offset:38912
    v_mfma_f32_16x16x32_bf16 v[220:223], a[108:111], a[88:91], v[220:223]
    s_add_u32 s48, s48, s41
    v_mfma_f32_16x16x32_bf16 v[236:239], a[108:111], a[92:95], v[236:239]
    v_mfma_f32_16x16x32_bf16 v[232:235], a[92:95], a[104:107], v[232:235]
    v_mfma_f32_16x16x32_bf16 v[228:231], a[100:103], a[92:95], v[228:231]
    v_mfma_f32_16x16x32_bf16 v[224:227], a[96:99], a[92:95], v[224:227]
    s_waitcnt vmcnt(6) lgkmcnt(0)
    s_barrier
    v_mfma_f32_16x16x32_bf16 v[240:243], a[40:43], a[0:3], v[240:243]
    s_mul_i32 s48, s48, 1024
    s_add_u32 m0, s63, 86016
    ds_read_b128 a[56:59], v14 offset:20480
    v_mfma_f32_16x16x32_bf16 v[244:247], a[44:47], a[0:3], v[244:247]
    s_sub_u32 s48, s48, 4096
    buffer_load_dwordx4 v10, s[8:11], s61 offen offset:2048 lds
    v_mfma_f32_16x16x32_bf16 v[248:251], a[0:3], a[48:51], v[248:251]
    s_add_u32 s49, s57, s41
    ds_read_b64_tr_b16 a[96:97], v15 offset:49152
    v_mfma_f32_16x16x32_bf16 v[252:255], a[52:55], a[0:3], v[252:255]
    s_mul_i32 s49, s49, 1024
    v_mfma_f32_16x16x32_bf16 v[108:111], a[52:55], a[4:7], v[108:111]
    s_sub_u32 s49, s49, 4096
    buffer_load_dwordx4 v11, s[8:11], s61 offen offset:3072 lds
    ds_read_b64_tr_b16 a[98:99], v15 offset:52992
    v_mfma_f32_16x16x32_bf16 v[104:107], a[4:7], a[48:51], v[104:107]
    s_add_u32 m0, s63, 90112
    v_mfma_f32_16x16x32_bf16 v[100:103], a[44:47], a[4:7], v[100:103]
    s_lshl_b32 s41, s41, 10
    ds_read_b64_tr_b16 a[100:101], v15 offset:49312
    v_mfma_f32_16x16x32_bf16 v[96:99], a[40:43], a[4:7], v[96:99]
    s_lshr_b32 s7, s36, 1
    buffer_load_dwordx4 v12, s[8:11], s61 offen lds
    v_mfma_f32_16x16x32_bf16 v[112:115], a[40:43], a[8:11], v[112:115]
    s_bfe_u32 s59, s31, 0x40000
    ds_read_b64_tr_b16 a[102:103], v15 offset:53152
    v_mfma_f32_16x16x32_bf16 v[116:119], a[44:47], a[8:11], v[116:119]
    s_mul_i32 s7, s7, 9
    v_mfma_f32_16x16x32_bf16 v[120:123], a[8:11], a[48:51], v[120:123]
    s_lshl_b32 s59, s59, 7
    ds_read_b64_tr_b16 a[104:105], v15 offset:49472
    v_mfma_f32_16x16x32_bf16 v[124:127], a[52:55], a[8:11], v[124:127]
L_isl_qkv_2:
    s_cbranch_execz L_isl_qkv_6
    s_mul_i32 s69, s4, 602
    s_add_u32 s61, s58, s59
    v_mfma_f32_16x16x32_bf16 v[140:143], a[52:55], a[12:15], v[140:143]
    s_lshr_b32 s69, s69, 8
    ds_read_b64_tr_b16 a[106:107], v15 offset:53312
    v_mfma_f32_16x16x32_bf16 v[136:139], a[12:15], a[48:51], v[136:139]
    s_add_u32 m0, s62, 16384
    v_mfma_f32_16x16x32_bf16 v[132:135], a[44:47], a[12:15], v[132:135]
    s_add_u32 s7, s7, s69
    ds_read_b64_tr_b16 a[108:109], v16 offset:49152
    v_mfma_f32_16x16x32_bf16 v[128:131], a[40:43], a[12:15], v[128:131]
    s_lshl_b32 s7, s7, 8
    buffer_load_dwordx4 v4, s[12:15], s60 offen lds
    v_mfma_f32_16x16x32_bf16 v[144:147], a[40:43], a[16:19], v[144:147]
    s_add_u32 s52, s7, 23068672
    ds_read_b64_tr_b16 a[110:111], v17 offset:49152
    v_mfma_f32_16x16x32_bf16 v[148:151], a[44:47], a[16:19], v[148:151]
    s_add_u32 s53, s52, 128
    v_mfma_f32_16x16x32_bf16 v[152:155], a[16:19], a[48:51], v[152:155]
    s_lshl_b32 s54, s36, 6
    buffer_load_dwordx4 v5, s[12:15], s60 offen offset:1024 lds
    ds_read_b128 a[60:63], v14 offset:22528
    v_mfma_f32_16x16x32_bf16 v[156:159], a[52:55], a[16:19], v[156:159]
    s_add_u32 s55, s54, 63
    v_mfma_f32_16x16x32_bf16 v[172:175], a[52:55], a[20:23], v[172:175]
    s_max_u32 s54, s54, 14
    ds_read_b128 a[64:67], v14 offset:24576
    v_mfma_f32_16x16x32_bf16 v[168:171], a[20:23], a[48:51], v[168:171]
    s_sub_u32 s54, s54, 14
    buffer_load_dwordx4 v6, s[12:15], s60 offen offset:2048 lds
    v_mfma_f32_16x16x32_bf16 v[164:167], a[44:47], a[20:23], v[164:167]
    s_mul_i32 s54, s54, 449
    ds_read_b128 a[68:71], v14 offset:26624
    v_mfma_f32_16x16x32_bf16 v[160:163], a[40:43], a[20:23], v[160:163]
    v_mfma_f32_16x16x32_bf16 v[176:179], a[40:43], a[24:27], v[176:179]
    s_lshr_b32 s54, s54, 16
    buffer_load_dwordx4 v7, s[12:15], s60 offen offset:3072 lds
    s_bfe_u32 s59, s30, 0x4001c
    v_mfma_f32_16x16x32_bf16 v[180:183], a[44:47], a[24:27], v[180:183]
    s_mul_i32 s59, s59, 245760
    ds_read_b128 a[72:75], v14 offset:28672
    s_add_u32 s60, s56, s59
    v_mfma_f32_16x16x32_bf16 v[184:187], a[24:27], a[48:51], v[184:187]
    s_add_u32 m0, s62, 32768
    ds_read_b128 a[76:79], v14 offset:30720
    v_mfma_f32_16x16x32_bf16 v[188:191], a[52:55], a[24:27], v[188:191]
    s_max_u32 s55, s55, 14
    v_mfma_f32_16x16x32_bf16 v[204:207], a[52:55], a[28:31], v[204:207]
    s_sub_u32 s55, s55, 14
    ds_read_b128 a[80:83], v14 offset:32768
    v_mfma_f32_16x16x32_bf16 v[200:203], a[28:31], a[48:51], v[200:203]
    s_mul_i32 s55, s55, 449
    buffer_load_dwordx4 v4, s[12:15], s60 offen lds
    v_mfma_f32_16x16x32_bf16 v[196:199], a[44:47], a[28:31], v[196:199]
    s_lshr_b32 s55, s55, 16
    ds_read_b128 a[84:87], v14 offset:34816
    v_mfma_f32_16x16x32_bf16 v[192:195], a[40:43], a[28:31], v[192:195]
    s_cmp_eq_u32 s54, s55
    s_cselect_b32 s55, 7, 15
    v_mfma_f32_16x16x32_bf16 v[208:211], a[40:43], a[32:35], v[208:211]
    buffer_load_dwordx4 v5, s[12:15], s60 offen offset:1024 lds
    ds_read_b128 a[88:91], v14 offset:36864
    v_mfma_f32_16x16x32_bf16 v[212:215], a[44:47], a[32:35], v[212:215]
    v_mfma_f32_16x16x32_bf16 v[216:219], a[32:35], a[48:51], v[216:219]
    s_lshl_b32 s54, s54, 11
    ds_read_b128 a[92:95], v14 offset:38912
    v_mfma_f32_16x16x32_bf16 v[220:223], a[52:55], a[32:35], v[220:223]
    s_add_u32 s54, s54, 23105664
    buffer_load_dwordx4 v6, s[12:15], s60 offen offset:2048 lds
    v_mfma_f32_16x16x32_bf16 v[236:239], a[52:55], a[36:39], v[236:239]
    buffer_load_dwordx4 v7, s[12:15], s60 offen offset:3072 lds
    v_mfma_f32_16x16x32_bf16 v[232:235], a[36:39], a[48:51], v[232:235]
    s_add_u32 s60, s60, s0
    v_mfma_f32_16x16x32_bf16 v[228:231], a[44:47], a[36:39], v[228:231]
    v_mfma_f32_16x16x32_bf16 v[224:227], a[40:43], a[36:39], v[224:227]
    s_bitcmp0_b32 s101, 10
    s_cbranch_scc1 L_nocs_qkv_10
    v_mfma_f32_16x16x32_bf16 a[176:179], a[200:203], a[40:43], a[176:179]
    v_mfma_f32_16x16x32_bf16 a[180:183], a[200:203], a[44:47], a[180:183]
    v_mfma_f32_16x16x32_bf16 a[184:187], a[200:203], a[48:51], a[184:187]
    v_mfma_f32_16x16x32_bf16 a[188:191], a[200:203], a[52:55], a[188:191]
L_nocs_qkv_10:
    s_waitcnt vmcnt(11) lgkmcnt(0)
    s_barrier
    v_mfma_f32_16x16x32_bf16 v[240:243], a[96:99], a[56:59], v[240:243]
    s_add_u32 m0, s62, 49152
    ds_read_b128 a[0:3], v13 offset:40960
    v_mfma_f32_16x16x32_bf16 v[244:247], a[100:103], a[56:59], v[244:247]
    v_mfma_f32_16x16x32_bf16 v[248:251], a[56:59], a[104:107], v[248:251]
    ds_read_b64_tr_b16 a[40:41], v15 offset:0
    v_mfma_f32_16x16x32_bf16 v[252:255], a[108:111], a[56:59], v[252:255]
    buffer_load_dwordx4 v4, s[12:15], s60 offen lds
    v_mfma_f32_16x16x32_bf16 v[108:111], a[108:111], a[60:63], v[108:111]
    ds_read_b64_tr_b16 a[42:43], v15 offset:3840
    v_mfma_f32_16x16x32_bf16 v[104:107], a[60:63], a[104:107], v[104:107]
    v_mfma_f32_16x16x32_bf16 v[100:103], a[100:103], a[60:63], v[100:103]
    ds_read_b64_tr_b16 a[44:45], v15 offset:160
    v_mfma_f32_16x16x32_bf16 v[96:99], a[96:99], a[60:63], v[96:99]
    v_mfma_f32_16x16x32_bf16 v[112:115], a[96:99], a[64:67], v[112:115]
    buffer_load_dwordx4 v5, s[12:15], s60 offen offset:1024 lds
    ds_read_b64_tr_b16 a[46:47], v15 offset:4000
    v_mfma_f32_16x16x32_bf16 v[116:119], a[100:103], a[64:67], v[116:119]
    v_mfma_f32_16x16x32_bf16 v[120:123], a[64:67], a[104:107], v[120:123]
    ds_read_b64_tr_b16 a[48:49], v15 offset:320
    v_mfma_f32_16x16x32_bf16 v[124:127], a[108:111], a[64:67], v[124:127]
    v_mfma_f32_16x16x32_bf16 v[140:143], a[108:111], a[68:71], v[140:143]
    ds_read_b64_tr_b16 a[50:51], v15 offset:4160
    v_mfma_f32_16x16x32_bf16 v[136:139], a[68:71], a[104:107], v[136:139]
    buffer_load_dwordx4 v6, s[12:15], s60 offen offset:2048 lds
    v_mfma_f32_16x16x32_bf16 v[132:135], a[100:103], a[68:71], v[132:135]
    ds_read_b64_tr_b16 a[52:53], v16 offset:0
    v_mfma_f32_16x16x32_bf16 v[128:131], a[96:99], a[68:71], v[128:131]
    v_mfma_f32_16x16x32_bf16 v[144:147], a[96:99], a[72:75], v[144:147]
    ds_read_b64_tr_b16 a[54:55], v17 offset:0
    v_mfma_f32_16x16x32_bf16 v[148:151], a[100:103], a[72:75], v[148:151]
    v_mfma_f32_16x16x32_bf16 v[152:155], a[72:75], a[104:107], v[152:155]
    buffer_load_dwordx4 v7, s[12:15], s60 offen offset:3072 lds
    s_bfe_u32 s59, s31, 0x40000
    v_mfma_f32_16x16x32_bf16 v[156:159], a[108:111], a[72:75], v[156:159]
    s_mul_i32 s59, s59, 245760
    ds_read_b128 a[4:7], v13 offset:43008
    v_mfma_f32_16x16x32_bf16 v[172:175], a[108:111], a[76:79], v[172:175]
    s_add_u32 s60, s56, s59
    ds_read_b128 a[8:11], v13 offset:45056
    v_mfma_f32_16x16x32_bf16 v[168:171], a[76:79], a[104:107], v[168:171]
    s_add_u32 m0, s63, 106496
    v_mfma_f32_16x16x32_bf16 v[164:167], a[100:103], a[76:79], v[164:167]
    ds_read_b128 a[12:15], v13 offset:47104
    v_mfma_f32_16x16x32_bf16 v[160:163], a[96:99], a[76:79], v[160:163]
    v_mfma_f32_16x16x32_bf16 v[176:179], a[96:99], a[80:83], v[176:179]
    buffer_load_dword v47, v46, s[20:23], 0 offen sc1
    ds_read_b128 a[16:19], v13 offset:49152
    v_mfma_f32_16x16x32_bf16 v[180:183], a[100:103], a[80:83], v[180:183]
    v_mfma_f32_16x16x32_bf16 v[184:187], a[80:83], a[104:107], v[184:187]
    ds_read_b128 a[20:23], v13 offset:51200
    v_mfma_f32_16x16x32_bf16 v[188:191], a[108:111], a[80:83], v[188:191]
    v_mfma_f32_16x16x32_bf16 v[204:207], a[108:111], a[84:87], v[204:207]
    ds_read_b128 a[24:27], v13 offset:53248
    v_mfma_f32_16x16x32_bf16 v[200:203], a[84:87], a[104:107], v[200:203]
    v_mfma_f32_16x16x32_bf16 v[196:199], a[100:103], a[84:87], v[196:199]
    buffer_load_dwordx4 v8, s[8:11], s61 offen lds
    ds_read_b128 a[28:31], v13 offset:55296
    v_mfma_f32_16x16x32_bf16 v[192:195], a[96:99], a[84:87], v[192:195]
    v_mfma_f32_16x16x32_bf16 v[208:211], a[96:99], a[88:91], v[208:211]
    ds_read_b128 a[32:35], v13 offset:57344
    v_mfma_f32_16x16x32_bf16 v[212:215], a[100:103], a[88:91], v[212:215]
    v_mfma_f32_16x16x32_bf16 v[216:219], a[88:91], a[104:107], v[216:219]
    ds_read_b128 a[36:39], v13 offset:59392
    v_mfma_f32_16x16x32_bf16 v[220:223], a[108:111], a[88:91], v[220:223]
    buffer_load_dwordx4 v9, s[8:11], s61 offen offset:1024 lds
    v_mfma_f32_16x16x32_bf16 v[236:239], a[108:111], a[92:95], v[236:239]
    v_mfma_f32_16x16x32_bf16 v[232:235], a[92:95], a[104:107], v[232:235]
    v_mfma_f32_16x16x32_bf16 v[228:231], a[100:103], a[92:95], v[228:231]
    v_mfma_f32_16x16x32_bf16 v[224:227], a[96:99], a[92:95], v[224:227]
    s_bitcmp0_b32 s101, 11
    s_cbranch_scc1 L_nocs_qkv_11
    v_mfma_f32_16x16x32_bf16 a[176:179], a[200:203], a[96:99], a[176:179]
    v_mfma_f32_16x16x32_bf16 a[180:183], a[200:203], a[100:103], a[180:183]
    v_mfma_f32_16x16x32_bf16 a[184:187], a[200:203], a[104:107], a[184:187]
    v_mfma_f32_16x16x32_bf16 a[188:191], a[200:203], a[108:111], a[188:191]
L_nocs_qkv_11:
    s_waitcnt vmcnt(11) lgkmcnt(0)
    s_barrier
    v_mfma_f32_16x16x32_bf16 v[240:243], a[40:43], a[0:3], v[240:243]
    s_mov_b32 s70, 0xffff0000
    ds_read_b128 a[56:59], v14 offset:40960
    s_add_u32 m0, s63, 106496
    v_mfma_f32_16x16x32_bf16 v[244:247], a[44:47], a[0:3], v[244:247]
    s_mov_b32 s71, 0xffff0000
    v_mfma_f32_16x16x32_bf16 v[248:251], a[0:3], a[48:51], v[248:251]
    s_mov_b32 s72, 0
    buffer_load_dwordx4 v10, s[8:11], s61 offen offset:2048 lds
    ds_read_b64_tr_b16 a[96:97], v15 offset:16384
    v_mfma_f32_16x16x32_bf16 v[252:255], a[52:55], a[0:3], v[252:255]
    s_mov_b32 s73, -1
    v_mfma_f32_16x16x32_bf16 v[108:111], a[52:55], a[4:7], v[108:111]
    ds_read_b64_tr_b16 a[98:99], v15 offset:20224
    v_mfma_f32_16x16x32_bf16 v[104:107], a[4:7], a[48:51], v[104:107]
    v_mfma_f32_16x16x32_bf16 v[100:103], a[44:47], a[4:7], v[100:103]
    buffer_load_dwordx4 v11, s[8:11], s61 offen offset:3072 lds
    ds_read_b64_tr_b16 a[100:101], v15 offset:16544
    v_mfma_f32_16x16x32_bf16 v[96:99], a[40:43], a[4:7], v[96:99]
    s_add_u32 m0, s63, 110592
    v_mfma_f32_16x16x32_bf16 v[112:115], a[40:43], a[8:11], v[112:115]
    ds_read_b64_tr_b16 a[102:103], v15 offset:20384
    v_accvgpr_read_b32 v48, a176
    v_mfma_f32_16x16x32_bf16 v[116:119], a[44:47], a[8:11], v[116:119]
    v_mfma_f32_16x16x32_bf16 v[120:123], a[8:11], a[48:51], v[120:123]
    buffer_load_dwordx4 v12, s[8:11], s61 offen lds
    ds_read_b64_tr_b16 a[104:105], v15 offset:16704
    v_mfma_f32_16x16x32_bf16 v[124:127], a[52:55], a[8:11], v[124:127]
    s_bfe_u32 s59, s31, 0x40004
    v_accvgpr_read_b32 v49, a180
    v_mfma_f32_16x16x32_bf16 v[140:143], a[52:55], a[12:15], v[140:143]
    s_lshl_b32 s59, s59, 7
    ds_read_b64_tr_b16 a[106:107], v15 offset:20544
    v_mfma_f32_16x16x32_bf16 v[136:139], a[12:15], a[48:51], v[136:139]
    s_add_u32 s61, s58, s59
    v_accvgpr_read_b32 v50, a184
    v_mfma_f32_16x16x32_bf16 v[132:135], a[44:47], a[12:15], v[132:135]
    ds_read_b64_tr_b16 a[108:109], v16 offset:16384
    v_mfma_f32_16x16x32_bf16 v[128:131], a[40:43], a[12:15], v[128:131]
    v_accvgpr_read_b32 v51, a188
    v_mfma_f32_16x16x32_bf16 v[144:147], a[40:43], a[16:19], v[144:147]
    s_add_u32 m0, s62, 0
    ds_read_b64_tr_b16 a[110:111], v17 offset:16384
    v_mfma_f32_16x16x32_bf16 v[148:151], a[44:47], a[16:19], v[148:151]
    v_cndmask_b32 v48, v48, v49, s[70:71]
    v_mfma_f32_16x16x32_bf16 v[152:155], a[16:19], a[48:51], v[152:155]
    ds_read_b128 a[60:63], v14 offset:43008
    v_mfma_f32_16x16x32_bf16 v[156:159], a[52:55], a[16:19], v[156:159]
    v_mfma_f32_16x16x32_bf16 v[172:175], a[52:55], a[20:23], v[172:175]
    ds_read_b128 a[64:67], v14 offset:45056
    v_cndmask_b32 v50, v50, v51, s[70:71]
    v_mfma_f32_16x16x32_bf16 v[168:171], a[20:23], a[48:51], v[168:171]
    v_mfma_f32_16x16x32_bf16 v[164:167], a[44:47], a[20:23], v[164:167]
    ds_read_b128 a[68:71], v14 offset:47104
    v_cndmask_b32 v48, v48, v50, s[72:73]
    v_mfma_f32_16x16x32_bf16 v[160:163], a[40:43], a[20:23], v[160:163]
    v_mfma_f32_16x16x32_bf16 v[176:179], a[40:43], a[24:27], v[176:179]
    buffer_load_dwordx4 v4, s[12:15], s60 offen lds
    ds_read_b128 a[72:75], v14 offset:49152
    v_mfma_f32_16x16x32_bf16 v[180:183], a[44:47], a[24:27], v[180:183]
    v_cvt_pk_bf16_f32 v49, v48, v48
    v_mfma_f32_16x16x32_bf16 v[184:187], a[24:27], a[48:51], v[184:187]
    ds_read_b128 a[76:79], v14 offset:51200
    v_lshlrev_b32_e64 v49, 16, v49
    v_mfma_f32_16x16x32_bf16 v[188:191], a[52:55], a[24:27], v[188:191]
    v_mfma_f32_16x16x32_bf16 v[204:207], a[52:55], a[28:31], v[204:207]
    buffer_load_dwordx4 v5, s[12:15], s60 offen offset:1024 lds
    ds_read_b128 a[80:83], v14 offset:53248
    v_mfma_f32_16x16x32_bf16 v[200:203], a[28:31], a[48:51], v[200:203]
    v_sub_f32_e64 v49, v48, v49
    v_mfma_f32_16x16x32_bf16 v[196:199], a[44:47], a[28:31], v[196:199]
    ds_read_b128 a[84:87], v14 offset:55296
    v_mfma_f32_16x16x32_bf16 v[192:195], a[40:43], a[28:31], v[192:195]
    v_cvt_pk_bf16_f32 v48, v48, v49
    v_mfma_f32_16x16x32_bf16 v[208:211], a[40:43], a[32:35], v[208:211]
    buffer_load_dwordx4 v6, s[12:15], s60 offen offset:2048 lds
    ds_read_b128 a[88:91], v14 offset:57344
    v_mfma_f32_16x16x32_bf16 v[212:215], a[44:47], a[32:35], v[212:215]
    v_min_u32_e64 v48, -2, v48
    v_mfma_f32_16x16x32_bf16 v[216:219], a[32:35], a[48:51], v[216:219]
    ds_read_b128 a[92:95], v14 offset:59392
    v_mfma_f32_16x16x32_bf16 v[220:223], a[52:55], a[32:35], v[220:223]
    v_mfma_f32_16x16x32_bf16 v[236:239], a[52:55], a[36:39], v[236:239]
    buffer_load_dwordx4 v7, s[12:15], s60 offen offset:3072 lds
    s_add_u32 s60, s60, s0
    v_mfma_f32_16x16x32_bf16 v[232:235], a[36:39], a[48:51], v[232:235]
    v_mfma_f32_16x16x32_bf16 v[228:231], a[44:47], a[36:39], v[228:231]
    v_mfma_f32_16x16x32_bf16 v[224:227], a[40:43], a[36:39], v[224:227]
    buffer_store_dword v48, v44, s[20:23], 0 offen offset:0 sc1
    global_load_dword v23, v22, s[28:29]
    s_waitcnt vmcnt(11) lgkmcnt(0)
    s_barrier
    v_cmp_eq_u32 vcc, 0, v47
    v_mfma_f32_16x16x32_bf16 v[240:243], a[96:99], a[56:59], v[240:243]
    ds_read_b128 a[0:3], v13 offset:0
    v_mfma_f32_16x16x32_bf16 v[244:247], a[100:103], a[56:59], v[244:247]
    s_cbranch_vccnz L_slow_s1qkv
L_ok_s1qkv:
    v_mfma_f32_16x16x32_bf16 v[248:251], a[56:59], a[104:107], v[248:251]
    s_add_u32 m0, s62, 16384
    ds_read_b64_tr_b16 a[40:41], v15 offset:32768
    v_mfma_f32_16x16x32_bf16 v[252:255], a[108:111], a[56:59], v[252:255]
    v_mfma_f32_16x16x32_bf16 v[108:111], a[108:111], a[60:63], v[108:111]
    ds_read_b64_tr_b16 a[42:43], v15 offset:36608
    v_mfma_f32_16x16x32_bf16 v[104:107], a[60:63], a[104:107], v[104:107]
    v_mfma_f32_16x16x32_bf16 v[100:103], a[100:103], a[60:63], v[100:103]
    buffer_load_dwordx4 v4, s[12:15], s60 offen lds
    ds_read_b64_tr_b16 a[44:45], v15 offset:32928
    v_mfma_f32_16x16x32_bf16 v[96:99], a[96:99], a[60:63], v[96:99]
    v_mfma_f32_16x16x32_bf16 v[112:115], a[96:99], a[64:67], v[112:115]
    ds_read_b64_tr_b16 a[46:47], v15 offset:36768
    v_mfma_f32_16x16x32_bf16 v[116:119], a[100:103], a[64:67], v[116:119]
    v_mfma_f32_16x16x32_bf16 v[120:123], a[64:67], a[104:107], v[120:123]
    ds_read_b64_tr_b16 a[48:49], v15 offset:33088
    v_mfma_f32_16x16x32_bf16 v[124:127], a[108:111], a[64:67], v[124:127]
    buffer_load_dwordx4 v5, s[12:15], s60 offen offset:1024 lds
    v_mfma_f32_16x16x32_bf16 v[140:143], a[108:111], a[68:71], v[140:143]
    ds_read_b64_tr_b16 a[50:51], v15 offset:36928
    v_mfma_f32_16x16x32_bf16 v[136:139], a[68:71], a[104:107], v[136:139]
    v_mfma_f32_16x16x32_bf16 v[132:135], a[100:103], a[68:71], v[132:135]
    ds_read_b64_tr_b16 a[52:53], v16 offset:32768
    v_mfma_f32_16x16x32_bf16 v[128:131], a[96:99], a[68:71], v[128:131]
    v_mfma_f32_16x16x32_bf16 v[144:147], a[96:99], a[72:75], v[144:147]
    buffer_load_dwordx4 v6, s[12:15], s60 offen offset:2048 lds
    ds_read_b64_tr_b16 a[54:55], v17 offset:32768
    v_mfma_f32_16x16x32_bf16 v[148:151], a[100:103], a[72:75], v[148:151]
    v_mfma_f32_16x16x32_bf16 v[152:155], a[72:75], a[104:107], v[152:155]
    ds_read_b128 a[4:7], v13 offset:2048
    v_mfma_f32_16x16x32_bf16 v[156:159], a[108:111], a[72:75], v[156:159]
    v_mfma_f32_16x16x32_bf16 v[172:175], a[108:111], a[76:79], v[172:175]
    ds_read_b128 a[8:11], v13 offset:4096
    v_mfma_f32_16x16x32_bf16 v[168:171], a[76:79], a[104:107], v[168:171]
    buffer_load_dwordx4 v7, s[12:15], s60 offen offset:3072 lds
    s_bfe_u32 s59, s31, 0x40004
    v_mfma_f32_16x16x32_bf16 v[164:167], a[100:103], a[76:79], v[164:167]
    s_mul_i32 s59, s59, 245760
    ds_read_b128 a[12:15], v13 offset:6144
    v_mfma_f32_16x16x32_bf16 v[160:163], a[96:99], a[76:79], v[160:163]
    s_add_u32 s60, s56, s59
    v_mfma_f32_16x16x32_bf16 v[176:179], a[96:99], a[80:83], v[176:179]
    s_add_u32 m0, s63, 126976
    ds_read_b128 a[16:19], v13 offset:8192
    v_mfma_f32_16x16x32_bf16 v[180:183], a[100:103], a[80:83], v[180:183]
    v_mfma_f32_16x16x32_bf16 v[184:187], a[80:83], a[104:107], v[184:187]
    ds_read_b128 a[20:23], v13 offset:10240
    v_mfma_f32_16x16x32_bf16 v[188:191], a[108:111], a[80:83], v[188:191]
    v_mfma_f32_16x16x32_bf16 v[204:207], a[108:111], a[84:87], v[204:207]
    ds_read_b128 a[24:27], v13 offset:12288
    v_mfma_f32_16x16x32_bf16 v[200:203], a[84:87], a[104:107], v[200:203]
    v_mfma_f32_16x16x32_bf16 v[196:199], a[100:103], a[84:87], v[196:199]
    ds_read_b128 a[28:31], v13 offset:14336
    v_mfma_f32_16x16x32_bf16 v[192:195], a[96:99], a[84:87], v[192:195]
    buffer_load_dwordx4 v8, s[8:11], s61 offen lds
    v_mfma_f32_16x16x32_bf16 v[208:211], a[96:99], a[88:91], v[208:211]
    ds_read_b128 a[32:35], v13 offset:16384
    v_mfma_f32_16x16x32_bf16 v[212:215], a[100:103], a[88:91], v[212:215]
    v_mfma_f32_16x16x32_bf16 v[216:219], a[88:91], a[104:107], v[216:219]
    ds_read_b128 a[36:39], v13 offset:18432
    v_mfma_f32_16x16x32_bf16 v[220:223], a[108:111], a[88:91], v[220:223]
    v_mfma_f32_16x16x32_bf16 v[236:239], a[108:111], a[92:95], v[236:239]
    buffer_load_dwordx4 v9, s[8:11], s61 offen offset:1024 lds
    v_mfma_f32_16x16x32_bf16 v[232:235], a[92:95], a[104:107], v[232:235]
    v_mfma_f32_16x16x32_bf16 v[228:231], a[100:103], a[92:95], v[228:231]
    v_mfma_f32_16x16x32_bf16 v[224:227], a[96:99], a[92:95], v[224:227]
    s_waitcnt lgkmcnt(0)
    s_barrier
    v_mfma_f32_16x16x32_bf16 v[240:243], a[40:43], a[0:3], v[240:243]
    s_waitcnt vmcnt(6)
    ds_read_b128 a[56:59], v14 offset:0
    s_add_u32 m0, s63, 126976
    v_mfma_f32_16x16x32_bf16 v[244:247], a[44:47], a[0:3], v[244:247]
    s_cmp_eq_u32 s4, 3
    s_cselect_b32 s3, 1073741824, 0
    s_cselect_b32 s7, 1, 2
    v_mfma_f32_16x16x32_bf16 v[248:251], a[0:3], a[48:51], v[248:251]
    ds_read_b64_tr_b16 a[96:97], v15 offset:49152
    v_mfma_f32_16x16x32_bf16 v[252:255], a[52:55], a[0:3], v[252:255]
    buffer_load_dwordx4 v10, s[8:11], s61 offen offset:2048 lds
    v_mfma_f32_16x16x32_bf16 v[108:111], a[52:55], a[4:7], v[108:111]
    v_add_u32_e64 v22, s3, v21
    ds_read_b64_tr_b16 a[98:99], v15 offset:52992
    v_mfma_f32_16x16x32_bf16 v[104:107], a[4:7], a[48:51], v[104:107]
    v_min_u32_e64 v23, s7, v0
    v_mfma_f32_16x16x32_bf16 v[100:103], a[44:47], a[4:7], v[100:103]
    v_lshlrev_b32_e64 v23, 8, v23
    ds_read_b64_tr_b16 a[100:101], v15 offset:49312
    v_mfma_f32_16x16x32_bf16 v[96:99], a[40:43], a[4:7], v[96:99]
    s_lshl_b32 s67, s16, 3
    buffer_load_dwordx4 v11, s[8:11], s61 offen offset:3072 lds
    v_mfma_f32_16x16x32_bf16 v[112:115], a[40:43], a[8:11], v[112:115]
    s_add_u32 s67, s67, 22018048
    ds_read_b64_tr_b16 a[102:103], v15 offset:53152
    v_mfma_f32_16x16x32_bf16 v[116:119], a[44:47], a[8:11], v[116:119]
    s_lshl_b32 s68, s16, 2
    v_mfma_f32_16x16x32_bf16 v[120:123], a[8:11], a[48:51], v[120:123]
    s_add_u32 s68, s68, 22082304
    ds_read_b64_tr_b16 a[104:105], v15 offset:49472
    s_add_u32 m0, s63, 131072
    v_mfma_f32_16x16x32_bf16 v[124:127], a[52:55], a[8:11], v[124:127]
    v_add_u32_e64 v1, s67, v21
    v_mfma_f32_16x16x32_bf16 v[140:143], a[52:55], a[12:15], v[140:143]
    v_add_u32_e64 v2, s68, v21
    ds_read_b64_tr_b16 a[106:107], v15 offset:53312
    v_mfma_f32_16x16x32_bf16 v[136:139], a[12:15], a[48:51], v[136:139]
    buffer_load_dwordx4 v12, s[8:11], s61 offen lds
    v_cmp_gt_u32 s[70:71], 16, v0
    v_mfma_f32_16x16x32_bf16 v[132:135], a[44:47], a[12:15], v[132:135]
    s_add_u32 m0, s62, 32768
    v_cmp_gt_u32 s[72:73], 60, v0
    ds_read_b64_tr_b16 a[108:109], v16 offset:49152
    v_mfma_f32_16x16x32_bf16 v[128:131], a[40:43], a[12:15], v[128:131]
    s_lshr_b32 s68, s18, 1
    v_mfma_f32_16x16x32_bf16 v[144:147], a[40:43], a[16:19], v[144:147]
    v_cndmask_b32 v2, v2, v1, s[70:71]
    ds_read_b64_tr_b16 a[110:111], v17 offset:49152
    v_mfma_f32_16x16x32_bf16 v[148:151], a[44:47], a[16:19], v[148:151]
    v_cmp_gt_u32 s[70:71], s68, v0
    v_mfma_f32_16x16x32_bf16 v[152:155], a[16:19], a[48:51], v[152:155]
    v_add_u32 v3, 1280, v1
    ds_read_b128 a[60:63], v14 offset:2048
    v_mfma_f32_16x16x32_bf16 v[156:159], a[52:55], a[16:19], v[156:159]
    v_cndmask_b32 v2, v38, v2, s[72:73]
    v_mfma_f32_16x16x32_bf16 v[172:175], a[52:55], a[20:23], v[172:175]
    buffer_load_dwordx4 v4, s[12:15], s60 offen lds
    v_cndmask_b32 v1, v1, v3, s[70:71]
    v_mfma_f32_16x16x32_bf16 v[168:171], a[20:23], a[48:51], v[168:171]
    ds_read_b128 a[64:67], v14 offset:4096
    v_mfma_f32_16x16x32_bf16 v[164:167], a[44:47], a[20:23], v[164:167]
    ds_read_b128 a[68:71], v14 offset:6144
    v_mfma_f32_16x16x32_bf16 v[160:163], a[40:43], a[20:23], v[160:163]
    v_mfma_f32_16x16x32_bf16 v[176:179], a[40:43], a[24:27], v[176:179]
    buffer_load_dwordx4 v5, s[12:15], s60 offen offset:1024 lds
    ds_read_b128 a[72:75], v14 offset:8192
    v_mfma_f32_16x16x32_bf16 v[180:183], a[44:47], a[24:27], v[180:183]
    v_mfma_f32_16x16x32_bf16 v[184:187], a[24:27], a[48:51], v[184:187]
    ds_read_b128 a[76:79], v14 offset:10240
    v_mfma_f32_16x16x32_bf16 v[188:191], a[52:55], a[24:27], v[188:191]
    v_mfma_f32_16x16x32_bf16 v[204:207], a[52:55], a[28:31], v[204:207]
    buffer_load_dwordx4 v6, s[12:15], s60 offen offset:2048 lds
    ds_read_b128 a[80:83], v14 offset:12288
    v_mfma_f32_16x16x32_bf16 v[200:203], a[28:31], a[48:51], v[200:203]
    v_mfma_f32_16x16x32_bf16 v[196:199], a[44:47], a[28:31], v[196:199]
    ds_read_b128 a[84:87], v14 offset:14336
    v_mfma_f32_16x16x32_bf16 v[192:195], a[40:43], a[28:31], v[192:195]
    v_mfma_f32_16x16x32_bf16 v[208:211], a[40:43], a[32:35], v[208:211]
    buffer_load_dwordx4 v7, s[12:15], s60 offen offset:3072 lds
    s_add_u32 m0, s79, 147456
    s_add_u32 s3, s79, 147456
    v_mfma_f32_16x16x32_bf16 v[212:215], a[44:47], a[32:35], v[212:215]
    s_add_u32 s60, s60, s0
    ds_read_b128 a[88:91], v14 offset:16384
    buffer_load_dwordx4 v1, s[20:23], 0 offen offset:2048 sc1 lds
    v_mfma_f32_16x16x32_bf16 v[216:219], a[32:35], a[48:51], v[216:219]
    ds_read_b128 a[92:95], v14 offset:18432
    buffer_load_dwordx4 v2, s[20:23], 0 offen offset:3072 sc1 lds
    v_mfma_f32_16x16x32_bf16 v[220:223], a[52:55], a[32:35], v[220:223]
    v_and_b32_e64 v2, 15, v0
    v_lshl_add_u32 v75, v2, 3, s3
    v_lshl_add_u32 v76, v2, 2, s3
    v_mfma_f32_16x16x32_bf16 v[236:239], a[52:55], a[36:39], v[236:239]
    v_and_b32 v1, 0x30, v0
    v_add_u32 v77, s3, v1
    v_cmp_gt_u32 s[70:71], s18, v2
    v_mfma_f32_16x16x32_bf16 v[232:235], a[36:39], a[48:51], v[232:235]
    v_lshrrev_b32_e64 v1, 2, v1
    v_add_u32 v78, 640, v76
    v_cmp_gt_u32 s[72:73], s18, v1
    v_mfma_f32_16x16x32_bf16 v[228:231], a[44:47], a[36:39], v[228:231]
    v_add_u32_e64 v1, 2, v1
    v_cndmask_b32 v78, v76, v78, s[70:71]
    v_cmp_gt_u32 s[70:71], s18, v1
    v_add_u32 v80, 640, v77
    v_mfma_f32_16x16x32_bf16 v[224:227], a[40:43], a[36:39], v[224:227]
    v_cndmask_b32 v79, v77, v80, s[72:73]
    v_cndmask_b32 v80, v77, v80, s[70:71]
    s_waitcnt lgkmcnt(0)
    s_barrier
    v_mfma_f32_16x16x32_bf16 v[240:243], a[96:99], a[56:59], v[240:243]
    s_add_u32 m0, s62, 49152
    v_lshlrev_b32_e64 v60, 3, v0
    buffer_load_dwordx2 v[48:49], v60, s[20:23], s42 offen offset:0 sc1
    v_mfma_f32_16x16x32_bf16 v[244:247], a[100:103], a[56:59], v[244:247]
    ds_read_b128 a[0:3], v13 offset:20480
    v_mfma_f32_16x16x32_bf16 v[248:251], a[56:59], a[104:107], v[248:251]
    ds_read_b64_tr_b16 a[40:41], v15 offset:0
    v_mfma_f32_16x16x32_bf16 v[252:255], a[108:111], a[56:59], v[252:255]
    v_mfma_f32_16x16x32_bf16 v[108:111], a[108:111], a[60:63], v[108:111]
    ds_read_b64_tr_b16 a[42:43], v15 offset:3840
    v_mfma_f32_16x16x32_bf16 v[104:107], a[60:63], a[104:107], v[104:107]
    buffer_load_dwordx2 v[50:51], v60, s[20:23], s42 offen offset:512 sc1
    v_mfma_f32_16x16x32_bf16 v[100:103], a[100:103], a[60:63], v[100:103]
    ds_read_b64_tr_b16 a[44:45], v15 offset:160
    v_mfma_f32_16x16x32_bf16 v[96:99], a[96:99], a[60:63], v[96:99]
    v_mfma_f32_16x16x32_bf16 v[112:115], a[96:99], a[64:67], v[112:115]
    ds_read_b64_tr_b16 a[46:47], v15 offset:4000
    buffer_load_dwordx2 v[52:53], v60, s[20:23], s42 offen offset:1024 sc1
    v_mfma_f32_16x16x32_bf16 v[116:119], a[100:103], a[64:67], v[116:119]
    buffer_load_dwordx2 v[54:55], v60, s[20:23], s42 offen offset:1536 sc1
    v_mfma_f32_16x16x32_bf16 v[120:123], a[64:67], a[104:107], v[120:123]
    v_and_b32 v1, 15, v0
    v_lshrrev_b32 v2, 4, v0
    v_and_b32_e64 v3, 1, v0
    v_mfma_f32_16x16x32_bf16 v[124:127], a[108:111], a[64:67], v[124:127]
    v_cmp_eq_u32 s[70:71], 1, v3
    v_lshl_add_u32 v3, v2, 2, v3
    v_cmp_gt_u32 s[72:73], v3, v1
    v_mfma_f32_16x16x32_bf16 v[140:143], a[108:111], a[68:71], v[140:143]
    v_add_u32_e64 v3, 2, v3
    v_cmp_gt_u32 s[74:75], v3, v1
    v_mov_b32 v3, 0xffff
    v_mfma_f32_16x16x32_bf16 v[136:139], a[68:71], a[104:107], v[136:139]
    v_mov_b32 v19, 0xffff0000
    v_cndmask_b32 v18, v3, v19, s[70:71]
    v_mfma_f32_16x16x32_bf16 v[132:135], a[100:103], a[68:71], v[132:135]
    buffer_load_dwordx4 v4, s[12:15], s60 offen lds
    v_xor_b32 v8, 32, v0
    v_lshlrev_b32 v8, 2, v8
    v_mfma_f32_16x16x32_bf16 v[128:131], a[96:99], a[68:71], v[128:131]
    v_and_b32 v3, 0x3f803f80, v18
    ds_read_b64_tr_b16 a[48:49], v15 offset:320
    v_mfma_f32_16x16x32_bf16 v[144:147], a[96:99], a[72:75], v[144:147]
    v_and_b32_e64 v19, 0x32, v0
    v_cmp_eq_u32 s[64:65], 48, v19
    v_mfma_f32_16x16x32_bf16 v[148:151], a[100:103], a[72:75], v[148:151]
    v_cmp_eq_u32 s[66:67], 50, v19
    ds_read_b64_tr_b16 a[50:51], v15 offset:4160
    v_mfma_f32_16x16x32_bf16 v[152:155], a[72:75], a[104:107], v[152:155]
    v_cndmask_b32 v19, 0, v3, s[64:65]
    v_cndmask_b32 v20, 0, v3, s[66:67]
    v_lshrrev_b32_e64 v3, 5, v0
    v_mfma_f32_16x16x32_bf16 v[156:159], a[108:111], a[72:75], v[156:159]
    buffer_load_dwordx4 v5, s[12:15], s60 offen offset:1024 lds
    ds_read_b64_tr_b16 a[52:53], v16 offset:0
    v_mfma_f32_16x16x32_bf16 v[172:175], a[108:111], a[76:79], v[172:175]
    v_mul_u32_u24 v2, 75264, v3
    v_add_u32_e64 v9, v2, v21
    v_mfma_f32_16x16x32_bf16 v[168:171], a[76:79], a[104:107], v[168:171]
    s_mul_i32 s67, s5, 146
    ds_read_b64_tr_b16 a[54:55], v17 offset:0
    s_add_u32 s67, s67, 14
    v_mfma_f32_16x16x32_bf16 v[164:167], a[100:103], a[76:79], v[164:167]
    s_cmp_eq_u32 s5, 0
    s_cselect_b32 s67, 0, s67
    s_cselect_b32 s19, 0xf149f2ca, 0
    v_mfma_f32_16x16x32_bf16 v[160:163], a[96:99], a[76:79], v[160:163]
    s_sub_u32 s67, s67, s16
    ds_read_b128 a[4:7], v13 offset:22528
    ds_read_b128 a[8:11], v13 offset:24576
    v_mfma_f32_16x16x32_bf16 v[176:179], a[96:99], a[80:83], v[176:179]
    buffer_load_dwordx4 v6, s[12:15], s60 offen offset:2048 lds
    v_lshl_add_u32 v3, v3, 4, v1
    v_mfma_f32_16x16x32_bf16 v[180:183], a[100:103], a[80:83], v[180:183]
    v_add_u32_e64 v2, 16, v3
    ds_read_b128 a[12:15], v13 offset:26624
    v_mfma_f32_16x16x32_bf16 v[184:187], a[80:83], a[104:107], v[184:187]
    v_cmp_le_u32 s[64:65], s67, v2
    v_cmp_le_u32 s[68:69], s67, v1
    v_mfma_f32_16x16x32_bf16 v[188:191], a[108:111], a[80:83], v[188:191]
    s_add_u32 s67, s18, 16
    ds_read_b128 a[16:19], v13 offset:28672
    v_cndmask_b32 v12, v38, v9, s[64:65]
    v_mfma_f32_16x16x32_bf16 v[204:207], a[108:111], a[84:87], v[204:207]
    v_cndmask_b32 v72, v38, v9, s[68:69]
    v_cmp_gt_u32 s[64:65], s67, v3
    v_mfma_f32_16x16x32_bf16 v[200:203], a[84:87], a[104:107], v[200:203]
    ds_read_b128 a[20:23], v13 offset:30720
    v_add_u32 v2, 757760, v9
    v_mfma_f32_16x16x32_bf16 v[196:199], a[100:103], a[84:87], v[196:199]
    buffer_load_dwordx4 v7, s[12:15], s60 offen offset:3072 lds
    v_cndmask_b32 v72, v72, v2, s[64:65]
    v_mfma_f32_16x16x32_bf16 v[192:195], a[96:99], a[84:87], v[192:195]
    s_lshr_b32 s64, s4, 1
    ds_read_b128 a[24:27], v13 offset:32768
    s_lshl_b32 s64, s64, 8
    v_mfma_f32_16x16x32_bf16 v[208:211], a[96:99], a[88:91], v[208:211]
    s_and_b32 s65, s4, 1
    ds_read_b128 a[28:31], v13 offset:34816
    s_lshl_b32 s65, s65, 3
    v_mfma_f32_16x16x32_bf16 v[212:215], a[100:103], a[88:91], v[212:215]
    s_add_u32 s64, s64, s65
    s_add_u32 s64, s64, 147456
    ds_read_b128 a[32:35], v13 offset:36864
    v_mfma_f32_16x16x32_bf16 v[216:219], a[88:91], a[104:107], v[216:219]
L_isl_qkv_3:
    s_cbranch_execz L_warm_qkv_0
    v_lshl_add_u32 v10, v1, 4, s64
    v_mov_b32 v11, v77
    v_mfma_f32_16x16x32_bf16 v[220:223], a[108:111], a[88:91], v[220:223]
    s_lshr_b32 s65, s16, 4
    ds_read_b128 a[36:39], v13 offset:38912
    s_mul_i32 s65, s65, 75776
    v_mfma_f32_16x16x32_bf16 v[236:239], a[108:111], a[92:95], v[236:239]
    s_add_u32 s65, s65, 1124352
    s_lshl_b32 s64, s17, 9
    v_mfma_f32_16x16x32_bf16 v[232:235], a[92:95], a[104:107], v[232:235]
    s_add_u32 s64, s64, s65
    s_lshl_b32 s66, s6, 9
    v_mfma_f32_16x16x32_bf16 v[228:231], a[100:103], a[92:95], v[228:231]
    s_add_u32 s65, s65, s66
    v_mfma_f32_16x16x32_bf16 v[224:227], a[96:99], a[92:95], v[224:227]
    s_add_u32 s65, s65, 16384
    s_waitcnt vmcnt(10) lgkmcnt(0)
    s_barrier
    v_mfma_f32_16x16x32_bf16 v[240:243], a[40:43], a[0:3], v[240:243]
    s_add_u32 s78, s38, 4096
    v_cndmask_b32 v4, 0, v18, s[72:73]
    ds_read_b64_tr_b16 a[56:57], v15 offset:16384
    v_mfma_f32_16x16x32_bf16 v[244:247], a[44:47], a[0:3], v[244:247]
    v_cndmask_b32 v5, 0, v18, s[74:75]
    v_mfma_f32_16x16x32_bf16 v[248:251], a[0:3], a[48:51], v[248:251]
    buffer_load_dwordx4 a[144:147], v21, s[20:23], s78 offen sc1
    ds_read_b64_tr_b16 a[58:59], v15 offset:20224
    v_mfma_f32_16x16x32_bf16 v[252:255], a[52:55], a[0:3], v[252:255]
    v_cndmask_b32 v6, v18, 0, s[72:73]
    v_cndmask_b32 v7, v18, 0, s[74:75]
    v_mfma_f32_16x16x32_bf16 v[108:111], a[52:55], a[4:7], v[108:111]
    s_waitcnt vmcnt(9)
    ds_read_b64_tr_b16 a[60:61], v15 offset:16544
    v_mfma_f32_16x16x32_bf16 v[104:107], a[4:7], a[48:51], v[104:107]
    buffer_load_dwordx4 a[148:151], v21, s[20:23], s78 offen offset:1024 sc1
    v_mfma_f32_16x16x32_bf16 v[100:103], a[44:47], a[4:7], v[100:103]
    ds_read_b64 a[120:121], v75 offset:2048
    v_mfma_f32_16x16x32_bf16 v[96:99], a[40:43], a[4:7], v[96:99]
    ds_read_b64_tr_b16 a[62:63], v15 offset:20384
    v_mfma_f32_16x16x32_bf16 v[112:115], a[40:43], a[8:11], v[112:115]
    buffer_load_dwordx4 a[152:155], v21, s[20:23], s78 offen offset:2048 sc1
    ds_read_b64 a[122:123], v75 offset:2176
    v_mfma_f32_16x16x32_bf16 v[116:119], a[44:47], a[8:11], v[116:119]
    ds_read_b64_tr_b16 a[64:65], v15 offset:16704
    v_mfma_f32_16x16x32_bf16 v[120:123], a[8:11], a[48:51], v[120:123]
    ds_read_b64 a[124:125], v75 offset:2304
    v_mfma_f32_16x16x32_bf16 v[124:127], a[52:55], a[8:11], v[124:127]
    buffer_load_dwordx4 a[156:159], v21, s[20:23], s78 offen offset:3072 sc1
    ds_read_b64 a[126:127], v75 offset:2432
    v_mfma_f32_16x16x32_bf16 v[140:143], a[52:55], a[12:15], v[140:143]
    s_add_u32 s78, s38, 8192
    ds_read_b64_tr_b16 a[66:67], v15 offset:20544
    ds_read_b64 a[128:129], v75 offset:2560
    v_mfma_f32_16x16x32_bf16 v[136:139], a[12:15], a[48:51], v[136:139]
    ds_read_b64 a[130:131], v75 offset:2688
    v_mfma_f32_16x16x32_bf16 v[132:135], a[44:47], a[12:15], v[132:135]
    buffer_load_dwordx4 a[160:163], v21, s[20:23], s78 offen sc1
    ds_read_b64_tr_b16 a[68:69], v16 offset:16384
    v_mfma_f32_16x16x32_bf16 v[128:131], a[40:43], a[12:15], v[128:131]
    s_add_u32 s78, s38, 44032
    ds_read_b64 a[132:133], v75 offset:2816
    ds_read_b64_tr_b16 a[70:71], v17 offset:16384
    v_mfma_f32_16x16x32_bf16 v[144:147], a[40:43], a[16:19], v[144:147]
    ds_read_b64 a[134:135], v75 offset:2944
    v_mfma_f32_16x16x32_bf16 v[148:151], a[44:47], a[16:19], v[148:151]
    buffer_load_dwordx4 a[164:167], v21, s[20:23], s78 offen offset:1024 sc1
    ds_read_b64 a[136:137], v75 offset:3072
    v_mfma_f32_16x16x32_bf16 v[152:155], a[16:19], a[48:51], v[152:155]
    ds_read_b64_tr_b16 a[72:73], v15 offset:32768
    v_mfma_f32_16x16x32_bf16 v[156:159], a[52:55], a[16:19], v[156:159]
    ds_read_b64 a[138:139], v75 offset:3200
    s_waitcnt vmcnt(10)
    v_mfma_f32_16x16x32_bf16 v[172:175], a[52:55], a[20:23], v[172:175]
    buffer_load_dwordx4 a[168:171], v21, s[20:23], s78 offen offset:2048 sc1
    ds_read_b64_tr_b16 a[74:75], v15 offset:36608
    v_mfma_f32_16x16x32_bf16 v[168:171], a[20:23], a[48:51], v[168:171]
    v_max3_u32 v61, v48, v49, v50
    ds_read_b64_tr_b16 a[76:77], v15 offset:32928
    v_mfma_f32_16x16x32_bf16 v[164:167], a[44:47], a[20:23], v[164:167]
    v_max3_u32 v61, v61, v51, v52
    ds_read_b64_tr_b16 a[78:79], v15 offset:36768
    v_mfma_f32_16x16x32_bf16 v[160:163], a[40:43], a[20:23], v[160:163]
    buffer_load_dwordx4 a[172:175], v21, s[20:23], s78 offen offset:3072 sc1
    v_max3_u32 v61, v61, v53, v54
    v_mfma_f32_16x16x32_bf16 v[176:179], a[40:43], a[24:27], v[176:179]
    s_add_u32 s78, s38, 48128
    v_max_u32 v61, v61, v55
    ds_read_b64_tr_b16 a[80:81], v15 offset:33088
    v_mfma_f32_16x16x32_bf16 v[180:183], a[44:47], a[24:27], v[180:183]
    v_cmp_eq_u32_e64 vcc, -1, v61
    v_mfma_f32_16x16x32_bf16 v[184:187], a[24:27], a[48:51], v[184:187]
    buffer_load_dwordx4 a[176:179], v21, s[20:23], s78 offen sc1
    v_accvgpr_write_b32 a112, v48
    v_mfma_f32_16x16x32_bf16 v[188:191], a[52:55], a[24:27], v[188:191]
    ds_read_b64_tr_b16 a[82:83], v15 offset:36928
    v_accvgpr_write_b32 a113, v49
    v_mfma_f32_16x16x32_bf16 v[204:207], a[52:55], a[28:31], v[204:207]
    ds_read_b64_tr_b16 a[84:85], v16 offset:32768
    v_accvgpr_write_b32 a114, v50
    v_mfma_f32_16x16x32_bf16 v[200:203], a[28:31], a[48:51], v[200:203]
    buffer_load_dwordx4 a[180:183], v21, s[20:23], s78 offen offset:1024 sc1
    v_accvgpr_write_b32 a115, v51
    v_mfma_f32_16x16x32_bf16 v[196:199], a[44:47], a[28:31], v[196:199]
    s_add_u32 s78, s38, 83968
    ds_read_b64_tr_b16 a[86:87], v17 offset:32768
    v_mfma_f32_16x16x32_bf16 v[192:195], a[40:43], a[28:31], v[192:195]
    v_accvgpr_write_b32 a116, v52
    v_mfma_f32_16x16x32_bf16 v[208:211], a[40:43], a[32:35], v[208:211]
    ds_read_b128 a[88:91], v14 offset:20480
    v_accvgpr_write_b32 a117, v53
    v_mfma_f32_16x16x32_bf16 v[212:215], a[44:47], a[32:35], v[212:215]
    buffer_load_dwordx4 a[184:187], v21, s[20:23], s78 offen offset:2048 sc1
    v_accvgpr_write_b32 a118, v54
    v_mfma_f32_16x16x32_bf16 v[216:219], a[32:35], a[48:51], v[216:219]
    ds_read_b128 a[92:95], v13 offset:40960
    v_accvgpr_write_b32 a119, v55
    v_mfma_f32_16x16x32_bf16 v[220:223], a[52:55], a[32:35], v[220:223]
    v_mfma_f32_16x16x32_bf16 v[236:239], a[52:55], a[36:39], v[236:239]
    buffer_load_dwordx4 a[188:191], v21, s[20:23], s78 offen offset:3072 sc1
    v_mfma_f32_16x16x32_bf16 v[232:235], a[36:39], a[48:51], v[232:235]
    v_mfma_f32_16x16x32_bf16 v[228:231], a[44:47], a[36:39], v[228:231]
    v_mfma_f32_16x16x32_bf16 v[224:227], a[40:43], a[36:39], v[224:227]
    s_waitcnt vmcnt(12) lgkmcnt(0)
    s_barrier
    s_cbranch_vccnz L_slow_csqkv
L_ok_csqkv:
    v_mfma_f32_16x16x16_bf16 v[240:243], a[112:113], a[120:121], v[240:243]
    ds_read_b64_tr_b16 a[0:1], v15 offset:49152
    s_mov_b32 s66, 0x3f803f80
    ds_read_b64_tr_b16 a[2:3], v15 offset:52992
    v_mfma_f32_16x16x16_bf16 v[244:247], a[114:115], a[120:121], v[244:247]
    v_accvgpr_write_b32 a140, s66
    ds_read_b64_tr_b16 a[4:5], v15 offset:49312
    s_add_u32 s78, s38, 88064
    v_mfma_f32_16x16x16_bf16 v[248:251], a[120:121], a[116:117], v[248:251]
    v_accvgpr_write_b32 a141, s66
    ds_read_b64_tr_b16 a[6:7], v15 offset:53152
    v_accvgpr_write_b32 a142, s66
    v_mfma_f32_16x16x16_bf16 v[252:255], a[118:119], a[120:121], v[252:255]
    ds_read_b64_tr_b16 a[8:9], v15 offset:49472
    ds_read_b64_tr_b16 a[10:11], v15 offset:53312
    v_accvgpr_write_b32 a143, s66
    v_mfma_f32_16x16x32_bf16 v[240:243], a[56:59], a[88:91], v[240:243]
    ds_read_b64_tr_b16 a[12:13], v16 offset:49152
    v_mov_b32 v2, v19
    v_mfma_f32_16x16x32_bf16 v[244:247], a[60:63], a[88:91], v[244:247]
    ds_read_b64_tr_b16 a[14:15], v17 offset:49152
    v_mov_b32_e64 v3, v20
    v_mfma_f32_16x16x32_bf16 v[248:251], a[88:91], a[64:67], v[248:251]
    s_mov_b32 s66, 0x3ea52b5c
    ds_read_b128 a[96:99], v14 offset:40960
    v_mfma_f32_16x16x32_bf16 v[252:255], a[68:71], a[88:91], v[252:255]
    v_mfma_f32_16x16x32_bf16 v[240:243], a[72:75], a[92:95], v[240:243]
    buffer_load_dwordx4 a[192:195], v21, s[20:23], s78 offen sc1
    ds_read_b32 v24, v78 offset:3328
    v_mfma_f32_16x16x32_bf16 v[244:247], a[76:79], a[92:95], v[244:247]
    ds_read_b128 a[100:103], v14 offset:22528
    v_mfma_f32_16x16x32_bf16 v[248:251], a[92:95], a[80:83], v[248:251]
    buffer_load_dwordx4 a[196:199], v21, s[20:23], s78 offen offset:1024 sc1
    ds_read_b32 v25, v76 offset:3392
    v_mfma_f32_16x16x32_bf16 v[252:255], a[84:87], a[92:95], v[252:255]
    ds_read_b32 v26, v76 offset:3456
    s_waitcnt lgkmcnt(4)
    v_mfma_f32_16x16x32_bf16 v[240:243], a[0:3], a[96:99], v[240:243]
    buffer_load_dwordx4 a[200:203], v21, s[20:23], s78 offen offset:2048 sc1
    ds_read_b32 v27, v76 offset:3520
    v_mfma_f32_16x16x32_bf16 v[244:247], a[4:7], a[96:99], v[244:247]
    s_add_u32 s78, s38, 123904
    ds_read_b128 a[104:107], v13 offset:43008
    ds_read_b32 v28, v76 offset:3584
    v_mfma_f32_16x16x32_bf16 v[248:251], a[96:99], a[8:11], v[248:251]
    buffer_load_dwordx4 a[204:207], v21, s[20:23], s78 offen offset:3072 sc1
    ds_read_b32 v29, v76 offset:3648
    v_mfma_f32_16x16x32_bf16 v[252:255], a[12:15], a[96:99], v[252:255]
    ds_read_b32 v30, v76 offset:3712
    ds_read_b64 v[56:57], v79 offset:3328
    ds_read_b64 v[58:59], v80 offset:3336
    s_nop 0
    ds_read_b32 v31, v76 offset:3776
    ds_read_b32 v32, v76 offset:3840
    ds_read_b32 v33, v76 offset:3904
    s_waitcnt lgkmcnt(0)
    s_nop 0
    v_pk_mul_f32 v[240:241], v[240:241], v[24:25] op_sel_hi:[1,0]
    v_pk_mul_f32 v[242:243], v[242:243], v[24:25] op_sel_hi:[1,0]
    v_pk_mul_f32 v[244:245], v[244:245], v[24:25] op_sel_hi:[1,0]
    v_pk_mul_f32 v[246:247], v[246:247], v[24:25] op_sel_hi:[1,0]
    v_pk_mul_f32 v[248:249], v[248:249], v[56:57]
    v_pk_mul_f32 v[250:251], v[250:251], v[58:59]
    v_pk_mul_f32 v[252:253], v[252:253], v[24:25] op_sel_hi:[1,0]
    v_pk_mul_f32 v[254:255], v[254:255], v[24:25] op_sel_hi:[1,0]
    v_cvt_pk_bf16_f32 v240, v240, v241
    v_cvt_pk_bf16_f32 v241, v242, v243
    v_cvt_pk_bf16_f32 v244, v244, v245
    v_cvt_pk_bf16_f32 v245, v246, v247
    v_mov_b32 v242, 0
    v_mov_b32 v243, 0
    v_cvt_pk_bf16_f32 v246, v252, v253
    v_cvt_pk_bf16_f32 v247, v254, v255
    v_cvt_pk_bf16_f32 v74, v248, v249
    v_cvt_pk_bf16_f32 v75, v250, v251
    v_permlane16_swap_b32 v242, v246
    v_permlane16_swap_b32 v243, v247
    v_cvt_pk_bf16_f32 v94, v248, v249
    v_cvt_pk_bf16_f32 v95, v250, v251
    v_mov_b32 v252, s19
    v_mov_b32 v253, s19
    v_mov_b32 v254, s19
    v_mov_b32 v255, s19
    s_barrier
    v_mfma_f32_16x16x16_bf16 v[64:67], v[242:243], v[2:3], 0
    s_add_u32 s78, s38, 128000
    ds_read_b128 a[108:111], v14 offset:43008
    v_mfma_f32_16x16x16_bf16 v[96:99], a[112:113], a[122:123], v[96:99]
    v_mfma_f32_16x16x16_bf16 v[100:103], a[114:115], a[122:123], v[100:103]
    v_mfma_f32_16x16x16_bf16 v[104:107], a[122:123], a[116:117], v[104:107]
    v_mfma_f32_16x16x16_bf16 v[108:111], a[118:119], a[122:123], v[108:111]
    buffer_load_dwordx4 a[208:211], v21, s[20:23], s78 offen sc1
    v_mfma_f32_16x16x32_bf16 v[96:99], a[56:59], a[100:103], v[96:99]
    v_mfma_f32_16x16x32_bf16 v[100:103], a[60:63], a[100:103], v[100:103]
    v_mfma_f32_16x16x32_bf16 v[104:107], a[100:103], a[64:67], v[104:107]
    v_mfma_f32_16x16x32_bf16 v[108:111], a[68:71], a[100:103], v[108:111]
    v_mfma_f32_16x16x32_bf16 v[96:99], a[72:75], a[104:107], v[96:99]
    buffer_load_dwordx4 a[212:215], v21, s[20:23], s78 offen offset:1024 sc1
    v_cvt_pk_bf16_f32 v34, v64, v65
    v_mfma_f32_16x16x32_bf16 v[100:103], a[76:79], a[104:107], v[100:103]
    ds_read_b128 a[16:19], v14 offset:24576
    v_cvt_pk_bf16_f32 v35, v66, v67
    v_mfma_f32_16x16x32_bf16 v[104:107], a[104:107], a[80:83], v[104:107]
    buffer_load_dwordx4 a[216:219], v21, s[20:23], s78 offen offset:2048 sc1
    ds_read_b128 a[20:23], v13 offset:45056
    v_mfma_f32_16x16x32_bf16 v[108:111], a[84:87], a[104:107], v[108:111]
    v_cvt_pk_bf16_f32 v54, v64, v65
    s_waitcnt lgkmcnt(2)
    v_mfma_f32_16x16x32_bf16 v[96:99], a[0:3], a[108:111], v[96:99]
    buffer_load_dwordx4 a[220:223], v21, s[20:23], s78 offen offset:3072 sc1
    s_add_u32 s78, s38, 167936
    v_mfma_f32_16x16x32_bf16 v[100:103], a[4:7], a[108:111], v[100:103]
    ds_read_b128 v[60:63], v11 offset:3392
    v_cvt_pk_bf16_f32 v55, v66, v67
    v_mfma_f32_16x16x32_bf16 v[104:107], a[108:111], a[8:11], v[104:107]
    buffer_load_dwordx4 a[224:227], v21, s[20:23], s78 offen sc1
    v_mfma_f32_16x16x32_bf16 v[108:111], a[12:15], a[108:111], v[108:111]
    buffer_load_dwordx4 a[228:231], v21, s[20:23], s78 offen offset:1024 sc1
    buffer_load_dwordx4 a[232:235], v21, s[20:23], s78 offen offset:2048 sc1
    buffer_load_dwordx4 a[236:239], v21, s[20:23], s78 offen offset:3072 sc1
    s_waitcnt lgkmcnt(0)
    s_nop 0
    v_pk_mul_f32 v[96:97], v[96:97], v[24:25] op_sel:[0,1]
    v_pk_mul_f32 v[98:99], v[98:99], v[24:25] op_sel:[0,1]
    v_pk_mul_f32 v[100:101], v[100:101], v[24:25] op_sel:[0,1]
    v_pk_mul_f32 v[102:103], v[102:103], v[24:25] op_sel:[0,1]
    v_pk_mul_f32 v[104:105], v[104:105], v[60:61]
    v_pk_mul_f32 v[106:107], v[106:107], v[62:63]
    v_pk_mul_f32 v[108:109], v[108:109], v[24:25] op_sel:[0,1]
    v_pk_mul_f32 v[110:111], v[110:111], v[24:25] op_sel:[0,1]
    v_cvt_pk_bf16_f32 v96, v96, v97
    v_cvt_pk_bf16_f32 v97, v98, v99
    v_cvt_pk_bf16_f32 v100, v100, v101
    v_cvt_pk_bf16_f32 v101, v102, v103
    v_mov_b32 v98, 0
    v_mov_b32 v99, 0
    v_cvt_pk_bf16_f32 v102, v108, v109
    v_cvt_pk_bf16_f32 v103, v110, v111
    v_cvt_pk_bf16_f32 v76, v104, v105
    v_cvt_pk_bf16_f32 v77, v106, v107
    v_permlane16_swap_b32 v98, v102
    v_permlane16_swap_b32 v99, v103
    s_nop 1
    v_mfma_f32_16x16x32_bf16 v[104:107], v[100:103], v[96:99], 0
    s_add_u32 s78, s38, 172032
    ds_read_b128 a[24:27], v14 offset:45056
    v_mfma_f32_16x16x32_bf16 v[108:111], v[244:247], v[96:99], 0
    v_mfma_f32_16x16x16_bf16 v[68:71], v[98:99], v[2:3], 0
    v_mfma_f32_16x16x16_bf16 v[112:115], a[112:113], a[124:125], v[112:115]
    v_mfma_f32_16x16x16_bf16 v[116:119], a[114:115], a[124:125], v[116:119]
    v_mfma_f32_16x16x16_bf16 v[120:123], a[124:125], a[116:117], v[120:123]
    v_mfma_f32_16x16x16_bf16 v[124:127], a[118:119], a[124:125], v[124:127]
    v_cndmask_b32 v104, v104, v105, s[70:71]
    v_cndmask_b32 v106, v106, v107, s[70:71]
    v_mfma_f32_16x16x32_bf16 v[112:115], a[56:59], a[16:19], v[112:115]
    v_cndmask_b32 v108, v108, v109, s[70:71]
    v_cndmask_b32 v110, v110, v111, s[70:71]
    v_mfma_f32_16x16x32_bf16 v[116:119], a[60:63], a[16:19], v[116:119]
    v_cndmask_b32 v104, v104, v108, s[72:73]
    v_cndmask_b32 v105, v106, v110, s[74:75]
    v_mfma_f32_16x16x32_bf16 v[120:123], a[16:19], a[64:67], v[120:123]
    v_max_f32 v25, v104, v105
    ds_swizzle_b32 v106, v25 offset:0x401F
    v_mfma_f32_16x16x32_bf16 v[124:127], a[68:71], a[16:19], v[124:127]
    v_mfma_f32_16x16x32_bf16 v[112:115], a[72:75], a[20:23], v[112:115]
    buffer_load_dwordx4 a[240:243], v21, s[20:23], s78 offen sc1
    v_cvt_pk_bf16_f32 v36, v68, v69
    v_mfma_f32_16x16x32_bf16 v[116:119], a[76:79], a[20:23], v[116:119]
    s_add_u32 s78, s38, 207872
    ds_read_b128 a[28:31], v14 offset:26624
    v_cvt_pk_bf16_f32 v37, v70, v71
    v_mfma_f32_16x16x32_bf16 v[120:123], a[20:23], a[80:83], v[120:123]
    s_waitcnt lgkmcnt(1)
    ds_read_b128 a[88:91], v13 offset:47104
    v_mfma_f32_16x16x32_bf16 v[124:127], a[84:87], a[20:23], v[124:127]
    buffer_load_dwordx4 a[244:247], v21, s[20:23], s78 offen offset:1024 sc1
    v_mfma_f32_16x16x32_bf16 v[112:115], a[0:3], a[24:27], v[112:115]
    v_max_f32 v25, v25, v106
    ds_read_b128 v[56:59], v11 offset:3456
    v_mfma_f32_16x16x32_bf16 v[116:119], a[4:7], a[24:27], v[116:119]
    buffer_load_dwordx4 a[248:251], v21, s[20:23], s78 offen offset:2048 sc1
    ds_bpermute_b32 v106, v8, v25
    v_mfma_f32_16x16x32_bf16 v[120:123], a[24:27], a[8:11], v[120:123]
    v_mfma_f32_16x16x32_bf16 v[124:127], a[12:15], a[24:27], v[124:127]
    buffer_load_dwordx4 a[252:255], v21, s[20:23], s78 offen offset:3072 sc1
    s_waitcnt lgkmcnt(1)
    v_pk_mul_f32 v[112:113], v[112:113], v[26:27] op_sel_hi:[1,0]
    s_nop 0
    v_pk_mul_f32 v[114:115], v[114:115], v[26:27] op_sel_hi:[1,0]
    v_pk_mul_f32 v[116:117], v[116:117], v[26:27] op_sel_hi:[1,0]
    v_pk_mul_f32 v[118:119], v[118:119], v[26:27] op_sel_hi:[1,0]
    s_nop 0
    s_nop 0
    v_pk_mul_f32 v[120:121], v[120:121], v[56:57]
    v_pk_mul_f32 v[122:123], v[122:123], v[58:59]
    v_pk_mul_f32 v[124:125], v[124:125], v[26:27] op_sel_hi:[1,0]
    v_pk_mul_f32 v[126:127], v[126:127], v[26:27] op_sel_hi:[1,0]
    v_cvt_pk_bf16_f32 v112, v112, v113
    v_cvt_pk_bf16_f32 v113, v114, v115
    v_cvt_pk_bf16_f32 v116, v116, v117
    v_cvt_pk_bf16_f32 v117, v118, v119
    v_mov_b32 v114, 0
    v_mov_b32 v115, 0
    v_cvt_pk_bf16_f32 v118, v124, v125
    v_cvt_pk_bf16_f32 v119, v126, v127
    v_cvt_pk_bf16_f32 v78, v120, v121
    v_cvt_pk_bf16_f32 v79, v122, v123
    v_permlane16_swap_b32 v114, v118
    v_permlane16_swap_b32 v115, v119
    s_nop 1
    v_mfma_f32_16x16x32_bf16 v[120:123], v[116:119], v[112:115], 0
    s_waitcnt lgkmcnt(0)
    v_max_f32_e64 v25, v25, v106
    s_add_u32 m0, s79, 65536
    v_mfma_f32_16x16x32_bf16 v[124:127], v[100:103], v[112:115], 0
    s_add_u32 s78, s38, 211968
    v_mul_f32_e64 v25, s66, v25
    v_fma_f32 v104, v104, s66, -v25
    v_mfma_f32_16x16x16_bf16 v[64:67], v[114:115], v[2:3], 0
    v_fma_f32 v105, v105, s66, -v25
    v_exp_f32_e64 v104, v104
    v_mfma_f32_16x16x16_bf16 v[128:131], a[112:113], a[126:127], v[128:131]
    v_exp_f32_e64 v105, v105
    ds_read_b128 a[92:95], v14 offset:47104
    v_mfma_f32_16x16x16_bf16 v[132:135], a[114:115], a[126:127], v[132:135]
    v_cvt_pk_bf16_f32 v104, v104, v104
    v_cvt_pk_bf16_f32 v105, v105, v105
    v_and_b32_e64 v96, v4, v104
    v_mfma_f32_16x16x16_bf16 v[136:139], a[126:127], a[116:117], v[136:139]
    v_and_b32 v97, v5, v105
    v_and_b32 v98, v6, v104
    v_and_b32_e64 v99, v7, v105
    v_mfma_f32_16x16x16_bf16 v[140:143], a[118:119], a[126:127], v[140:143]
    v_cndmask_b32 v120, v120, v121, s[70:71]
    v_cndmask_b32 v122, v122, v123, s[70:71]
    v_mfma_f32_16x16x32_bf16 v[128:131], a[56:59], a[28:31], v[128:131]
    buffer_load_dwordx4 v21, s[20:23], s78 offen sc1 lds
    v_cndmask_b32 v124, v124, v125, s[70:71]
    v_mfma_f32_16x16x32_bf16 v[132:135], a[60:63], a[28:31], v[132:135]
    v_cndmask_b32 v126, v126, v127, s[70:71]
    v_cndmask_b32 v120, v120, v124, s[72:73]
    v_mfma_f32_16x16x32_bf16 v[136:139], a[28:31], a[64:67], v[136:139]
    v_cndmask_b32 v121, v122, v126, s[74:75]
    v_max_f32_e64 v26, v120, v121
    v_mfma_f32_16x16x32_bf16 v[140:143], a[68:71], a[28:31], v[140:143]
    ds_swizzle_b32 v122, v26 offset:0x401F
    v_mfma_f32_16x16x32_bf16 v[16:19], a[140:143], v[96:99], 0
    buffer_load_dwordx4 v21, s[20:23], s78 offen offset:1024 sc1 lds
    v_cvt_pk_bf16_f32 v38, v64, v65
    v_mfma_f32_16x16x32_bf16 v[104:107], v[74:77], v[96:99], 0
    s_add_u32 s78, s38, 247808
    ds_read_b128 a[96:99], v14 offset:28672
    v_cvt_pk_bf16_f32 v39, v66, v67
    v_mfma_f32_16x16x32_bf16 v[108:111], v[34:37], v[96:99], 0
    s_waitcnt lgkmcnt(1)
    buffer_load_dwordx4 v22, s[20:23], s78 offen offset:2048 sc1 lds
    v_mfma_f32_16x16x32_bf16 v[128:131], a[72:75], a[88:91], v[128:131]
    ds_read_b128 a[100:103], v13 offset:49152
    v_mfma_f32_16x16x32_bf16 v[132:135], a[76:79], a[88:91], v[132:135]
    buffer_load_dwordx4 v22, s[20:23], s78 offen offset:3072 sc1 lds
    s_add_u32 m0, s79, 81920
    v_mfma_f32_16x16x32_bf16 v[136:139], a[88:91], a[80:83], v[136:139]
    s_add_u32 s78, s38, 251904
    v_max_f32 v26, v26, v122
    ds_bpermute_b32 v122, v8, v26
    v_mfma_f32_16x16x32_bf16 v[140:143], a[84:87], a[88:91], v[140:143]
    buffer_load_dwordx4 v22, s[20:23], s78 offen sc1 lds
    v_mfma_f32_16x16x32_bf16 v[128:131], a[0:3], a[92:95], v[128:131]
    ds_read_b128 v[60:63], v11 offset:3520
    v_mfma_f32_16x16x32_bf16 v[132:135], a[4:7], a[92:95], v[132:135]
    buffer_load_dwordx4 v22, s[20:23], s78 offen offset:1024 sc1 lds
    v_mfma_f32_16x16x32_bf16 v[136:139], a[92:95], a[8:11], v[136:139]
    v_rcp_f32_e64 v16, v16
    v_mfma_f32_16x16x32_bf16 v[140:143], a[12:15], a[92:95], v[140:143]
    buffer_load_dwordx4 v22, s[20:23], s78 offen offset:2048 sc1 lds
    s_add_u32 s78, s39, 1024
    buffer_load_dwordx4 v21, s[20:23], s78 offen offset:3072 sc1 lds
    v_pk_mul_f32 v[104:105], v[104:105], v[16:17] op_sel_hi:[1,0]
    v_pk_mul_f32 v[106:107], v[106:107], v[16:17] op_sel_hi:[1,0]
    v_pk_mul_f32 v[108:109], v[108:109], v[16:17] op_sel_hi:[1,0]
    v_pk_mul_f32 v[110:111], v[110:111], v[16:17] op_sel_hi:[1,0]
    v_cvt_pk_bf16_f32 v96, v104, v105
    v_cvt_pk_bf16_f32 v97, v106, v107
    v_cvt_pk_bf16_f32 v108, v108, v109
    v_cvt_pk_bf16_f32 v109, v110, v111
    ds_write_b64 v10, v[108:109] offset:0
    s_waitcnt lgkmcnt(1)
    s_nop 0
    v_pk_mul_f32 v[128:129], v[128:129], v[26:27] op_sel:[0,1]
    v_pk_mul_f32 v[130:131], v[130:131], v[26:27] op_sel:[0,1]
    v_pk_mul_f32 v[132:133], v[132:133], v[26:27] op_sel:[0,1]
    v_pk_mul_f32 v[134:135], v[134:135], v[26:27] op_sel:[0,1]
    v_pk_mul_f32 v[136:137], v[136:137], v[60:61]
    v_pk_mul_f32 v[138:139], v[138:139], v[62:63]
    v_pk_mul_f32 v[140:141], v[140:141], v[26:27] op_sel:[0,1]
    v_pk_mul_f32 v[142:143], v[142:143], v[26:27] op_sel:[0,1]
    v_cvt_pk_bf16_f32 v128, v128, v129
    v_cvt_pk_bf16_f32 v129, v130, v131
    v_cvt_pk_bf16_f32 v132, v132, v133
    v_cvt_pk_bf16_f32 v133, v134, v135
    v_mov_b32 v130, 0
    v_mov_b32 v131, 0
    v_cvt_pk_bf16_f32 v134, v140, v141
    v_cvt_pk_bf16_f32 v135, v142, v143
    v_cvt_pk_bf16_f32 v80, v136, v137
    v_cvt_pk_bf16_f32 v81, v138, v139
    v_permlane16_swap_b32 v130, v134
    v_permlane16_swap_b32 v131, v135
    s_nop 1
    v_mfma_f32_16x16x32_bf16 v[136:139], v[132:135], v[128:131], 0
    s_add_u32 m0, s79, 0
    v_max_f32_e64 v26, v26, v122
    ds_read_b128 a[104:107], v14 offset:49152
    v_mfma_f32_16x16x32_bf16 v[140:143], v[116:119], v[128:131], 0
    s_add_u32 s78, s39, 5120
    v_mul_f32_e64 v26, s66, v26
    v_fma_f32 v120, v120, s66, -v26
    v_mfma_f32_16x16x16_bf16 v[68:71], v[130:131], v[2:3], 0
    v_fma_f32 v121, v121, s66, -v26
    v_exp_f32_e64 v120, v120
    v_mfma_f32_16x16x16_bf16 v[144:147], a[112:113], a[128:129], v[144:147]
    v_exp_f32_e64 v121, v121
    v_cvt_pk_bf16_f32 v120, v120, v120
    v_mfma_f32_16x16x16_bf16 v[148:151], a[114:115], a[128:129], v[148:151]
    v_cvt_pk_bf16_f32 v121, v121, v121
    v_and_b32 v112, v4, v120
    v_and_b32 v113, v5, v121
    v_mfma_f32_16x16x16_bf16 v[152:155], a[128:129], a[116:117], v[152:155]
    v_and_b32 v114, v6, v120
    v_and_b32 v115, v7, v121
    v_mfma_f32_16x16x16_bf16 v[156:159], a[118:119], a[128:129], v[156:159]
    v_cndmask_b32 v136, v136, v137, s[70:71]
    v_cndmask_b32 v138, v138, v139, s[70:71]
    v_mfma_f32_16x16x32_bf16 v[144:147], a[56:59], a[96:99], v[144:147]
    buffer_load_dwordx4 v21, s[20:23], s78 offen sc1 lds
    v_cndmask_b32 v140, v140, v141, s[70:71]
    v_mfma_f32_16x16x32_bf16 v[148:151], a[60:63], a[96:99], v[148:151]
    v_cndmask_b32 v142, v142, v143, s[70:71]
    v_cndmask_b32 v136, v136, v140, s[72:73]
    v_mfma_f32_16x16x32_bf16 v[152:155], a[96:99], a[64:67], v[152:155]
    v_cndmask_b32 v137, v138, v142, s[74:75]
    v_max_f32_e64 v27, v136, v137
    v_mfma_f32_16x16x32_bf16 v[156:159], a[68:71], a[96:99], v[156:159]
    ds_swizzle_b32 v138, v27 offset:0x401F
    v_mfma_f32_16x16x32_bf16 v[100:103], a[140:143], v[112:115], 0
    buffer_load_dwordx4 v21, s[20:23], s78 offen offset:1024 sc1 lds
    v_cvt_pk_bf16_f32 v40, v68, v69
    v_mfma_f32_16x16x32_bf16 v[120:123], v[76:79], v[112:115], 0
    ds_read_b128 a[108:111], v14 offset:30720
    v_cvt_pk_bf16_f32 v41, v70, v71
    v_mfma_f32_16x16x32_bf16 v[124:127], v[36:39], v[112:115], 0
    s_waitcnt lgkmcnt(1)
    buffer_load_dwordx4 v21, s[20:23], s78 offen offset:2048 sc1 lds
    v_mfma_f32_16x16x32_bf16 v[144:147], a[72:75], a[100:103], v[144:147]
    ds_read_b128 a[16:19], v13 offset:51200
    v_mfma_f32_16x16x32_bf16 v[148:151], a[76:79], a[100:103], v[148:151]
    buffer_load_dwordx4 v21, s[20:23], s78 offen offset:3072 sc1 lds
    s_add_u32 m0, s79, 16384
    v_mfma_f32_16x16x32_bf16 v[152:155], a[100:103], a[80:83], v[152:155]
    s_add_u32 s78, s39, 45056
    v_max_f32 v27, v27, v138
    ds_bpermute_b32 v138, v8, v27
    v_mfma_f32_16x16x32_bf16 v[156:159], a[84:87], a[100:103], v[156:159]
    buffer_load_dwordx4 v21, s[20:23], s78 offen sc1 lds
    v_mfma_f32_16x16x32_bf16 v[144:147], a[0:3], a[104:107], v[144:147]
    ds_read_b128 v[56:59], v11 offset:3584
    v_mfma_f32_16x16x32_bf16 v[148:151], a[4:7], a[104:107], v[148:151]
    buffer_load_dwordx4 v21, s[20:23], s78 offen offset:1024 sc1 lds
    v_mfma_f32_16x16x32_bf16 v[152:155], a[104:107], a[8:11], v[152:155]
    v_rcp_f32_e64 v100, v100
    v_mfma_f32_16x16x32_bf16 v[156:159], a[12:15], a[104:107], v[156:159]
    buffer_load_dwordx4 v21, s[20:23], s78 offen offset:2048 sc1 lds
    buffer_load_dwordx4 v21, s[20:23], s78 offen offset:3072 sc1 lds
    v_pk_mul_f32 v[120:121], v[120:121], v[100:101] op_sel_hi:[1,0]
    v_pk_mul_f32 v[122:123], v[122:123], v[100:101] op_sel_hi:[1,0]
    v_pk_mul_f32 v[124:125], v[124:125], v[100:101] op_sel_hi:[1,0]
    v_pk_mul_f32 v[126:127], v[126:127], v[100:101] op_sel_hi:[1,0]
    v_cvt_pk_bf16_f32 v98, v120, v121
    v_cvt_pk_bf16_f32 v99, v122, v123
    v_cvt_pk_bf16_f32 v124, v124, v125
    v_cvt_pk_bf16_f32 v125, v126, v127
    ds_write_b64 v10, v[124:125] offset:512
    v_permlane32_swap_b32 v96, v98
    v_permlane32_swap_b32 v97, v99
    buffer_store_dwordx4 v[96:99], v12, s[20:23], s64 offen sc1
    s_add_u32 s64, s64, 151552
    s_waitcnt lgkmcnt(1)
    s_nop 0
    v_pk_mul_f32 v[144:145], v[144:145], v[28:29] op_sel_hi:[1,0]
    v_pk_mul_f32 v[146:147], v[146:147], v[28:29] op_sel_hi:[1,0]
    v_pk_mul_f32 v[148:149], v[148:149], v[28:29] op_sel_hi:[1,0]
    v_pk_mul_f32 v[150:151], v[150:151], v[28:29] op_sel_hi:[1,0]
    v_pk_mul_f32 v[152:153], v[152:153], v[56:57]
    v_pk_mul_f32 v[154:155], v[154:155], v[58:59]
    v_pk_mul_f32 v[156:157], v[156:157], v[28:29] op_sel_hi:[1,0]
    v_pk_mul_f32 v[158:159], v[158:159], v[28:29] op_sel_hi:[1,0]
    v_cvt_pk_bf16_f32 v144, v144, v145
    v_cvt_pk_bf16_f32 v145, v146, v147
    v_cvt_pk_bf16_f32 v148, v148, v149
    v_cvt_pk_bf16_f32 v149, v150, v151
    v_mov_b32 v146, 0
    v_mov_b32 v147, 0
    v_cvt_pk_bf16_f32 v150, v156, v157
    v_cvt_pk_bf16_f32 v151, v158, v159
    v_cvt_pk_bf16_f32 v82, v152, v153
    v_cvt_pk_bf16_f32 v83, v154, v155
    v_permlane16_swap_b32 v146, v150
    v_permlane16_swap_b32 v147, v151
    s_nop 1
    v_mfma_f32_16x16x32_bf16 v[152:155], v[148:151], v[144:147], 0
    s_add_u32 m0, s79, 32768
    v_max_f32 v27, v27, v138
    ds_read_b128 a[20:23], v14 offset:51200
    v_mfma_f32_16x16x32_bf16 v[156:159], v[132:135], v[144:147], 0
    v_mul_f32_e64 v27, s66, v27
    v_fma_f32 v136, v136, s66, -v27
    v_mfma_f32_16x16x16_bf16 v[64:67], v[146:147], v[2:3], 0
    v_fma_f32 v137, v137, s66, -v27
    v_exp_f32_e64 v136, v136
    v_mfma_f32_16x16x16_bf16 v[160:163], a[112:113], a[130:131], v[160:163]
    v_exp_f32_e64 v137, v137
    v_cvt_pk_bf16_f32 v136, v136, v136
    v_mfma_f32_16x16x16_bf16 v[164:167], a[114:115], a[130:131], v[164:167]
    v_cvt_pk_bf16_f32 v137, v137, v137
    v_and_b32 v128, v4, v136
    v_and_b32 v129, v5, v137
    v_mfma_f32_16x16x16_bf16 v[168:171], a[130:131], a[116:117], v[168:171]
L_isl_qkv_4:
    s_cbranch_execz L_warm_qkv_0
    v_and_b32 v130, v6, v136
    v_and_b32_e64 v131, v7, v137
    v_mfma_f32_16x16x16_bf16 v[172:175], a[118:119], a[130:131], v[172:175]
    v_cndmask_b32 v152, v152, v153, s[70:71]
    v_cndmask_b32 v154, v154, v155, s[70:71]
    v_mfma_f32_16x16x32_bf16 v[160:163], a[56:59], a[108:111], v[160:163]
    v_cndmask_b32 v156, v156, v157, s[70:71]
    v_cndmask_b32 v158, v158, v159, s[70:71]
    v_mfma_f32_16x16x32_bf16 v[164:167], a[60:63], a[108:111], v[164:167]
    v_cndmask_b32 v152, v152, v156, s[72:73]
    v_cndmask_b32 v153, v154, v158, s[74:75]
    v_mfma_f32_16x16x32_bf16 v[168:171], a[108:111], a[64:67], v[168:171]
    v_max_f32_e64 v28, v152, v153
    ds_swizzle_b32 v154, v28 offset:0x401F
    v_mfma_f32_16x16x32_bf16 v[172:175], a[68:71], a[108:111], v[172:175]
    v_mfma_f32_16x16x32_bf16 v[116:119], a[140:143], v[128:131], 0
    s_add_u32 s78, s39, 49152
    v_cvt_pk_bf16_f32 v42, v64, v65
    ds_read_b128 a[24:27], v14 offset:32768
    v_mfma_f32_16x16x32_bf16 v[136:139], v[78:81], v[128:131], 0
    buffer_load_dwordx4 v21, s[20:23], s78 offen sc1 lds
    v_cvt_pk_bf16_f32 v43, v66, v67
    v_mfma_f32_16x16x32_bf16 v[140:143], v[38:41], v[128:131], 0
    s_waitcnt lgkmcnt(1)
    ds_read_b128 a[28:31], v13 offset:53248
    v_mfma_f32_16x16x32_bf16 v[160:163], a[72:75], a[16:19], v[160:163]
    s_add_u32 s78, s39, 84992
    v_mfma_f32_16x16x32_bf16 v[164:167], a[76:79], a[16:19], v[164:167]
    v_max_f32 v28, v28, v154
    v_mfma_f32_16x16x32_bf16 v[168:171], a[16:19], a[80:83], v[168:171]
    buffer_load_dwordx4 v21, s[20:23], s78 offen offset:1024 sc1 lds
    ds_bpermute_b32 v154, v8, v28
    v_mfma_f32_16x16x32_bf16 v[172:175], a[84:87], a[16:19], v[172:175]
    ds_read_b128 v[60:63], v11 offset:3648
    v_mfma_f32_16x16x32_bf16 v[160:163], a[0:3], a[20:23], v[160:163]
    buffer_load_dwordx4 v21, s[20:23], s78 offen offset:2048 sc1 lds
    v_mfma_f32_16x16x32_bf16 v[164:167], a[4:7], a[20:23], v[164:167]
    v_rcp_f32_e64 v116, v116
    v_mfma_f32_16x16x32_bf16 v[168:171], a[20:23], a[8:11], v[168:171]
    buffer_load_dwordx4 v21, s[20:23], s78 offen offset:3072 sc1 lds
    v_mfma_f32_16x16x32_bf16 v[172:175], a[12:15], a[20:23], v[172:175]
    v_pk_mul_f32 v[136:137], v[136:137], v[116:117] op_sel_hi:[1,0]
    v_pk_mul_f32 v[138:139], v[138:139], v[116:117] op_sel_hi:[1,0]
    v_pk_mul_f32 v[140:141], v[140:141], v[116:117] op_sel_hi:[1,0]
    v_pk_mul_f32 v[142:143], v[142:143], v[116:117] op_sel_hi:[1,0]
    v_cvt_pk_bf16_f32 v128, v136, v137
    v_cvt_pk_bf16_f32 v129, v138, v139
    v_cvt_pk_bf16_f32 v140, v140, v141
    v_cvt_pk_bf16_f32 v141, v142, v143
    ds_write_b64 v10, v[140:141] offset:4096
    s_waitcnt lgkmcnt(1)
    s_nop 0
    v_pk_mul_f32 v[160:161], v[160:161], v[28:29] op_sel:[0,1]
    v_pk_mul_f32 v[162:163], v[162:163], v[28:29] op_sel:[0,1]
    v_pk_mul_f32 v[164:165], v[164:165], v[28:29] op_sel:[0,1]
    v_pk_mul_f32 v[166:167], v[166:167], v[28:29] op_sel:[0,1]
    v_pk_mul_f32 v[168:169], v[168:169], v[60:61]
    v_pk_mul_f32 v[170:171], v[170:171], v[62:63]
    v_pk_mul_f32 v[172:173], v[172:173], v[28:29] op_sel:[0,1]
    v_pk_mul_f32 v[174:175], v[174:175], v[28:29] op_sel:[0,1]
    v_cvt_pk_bf16_f32 v160, v160, v161
    v_cvt_pk_bf16_f32 v161, v162, v163
    v_cvt_pk_bf16_f32 v164, v164, v165
    v_cvt_pk_bf16_f32 v165, v166, v167
    v_mov_b32 v162, 0
    v_mov_b32 v163, 0
    v_cvt_pk_bf16_f32 v166, v172, v173
    v_cvt_pk_bf16_f32 v167, v174, v175
    v_cvt_pk_bf16_f32 v84, v168, v169
    v_cvt_pk_bf16_f32 v85, v170, v171
    v_permlane16_swap_b32 v162, v166
    v_permlane16_swap_b32 v163, v167
    s_nop 1
    v_mfma_f32_16x16x32_bf16 v[168:171], v[164:167], v[160:163], 0
    s_add_u32 m0, s79, 49152
    v_max_f32 v28, v28, v154
    ds_read_b128 a[88:91], v14 offset:53248
    v_mfma_f32_16x16x32_bf16 v[172:175], v[148:151], v[160:163], 0
    s_add_u32 s78, s39, 89088
    v_mul_f32_e64 v28, s66, v28
    v_fma_f32 v152, v152, s66, -v28
    v_mfma_f32_16x16x16_bf16 v[68:71], v[162:163], v[2:3], 0
    v_fma_f32 v153, v153, s66, -v28
    v_exp_f32_e64 v152, v152
    v_mfma_f32_16x16x16_bf16 v[176:179], a[112:113], a[132:133], v[176:179]
    v_exp_f32_e64 v153, v153
    v_cvt_pk_bf16_f32 v152, v152, v152
    v_mfma_f32_16x16x16_bf16 v[180:183], a[114:115], a[132:133], v[180:183]
    v_cvt_pk_bf16_f32 v153, v153, v153
    v_and_b32 v144, v4, v152
    v_and_b32 v145, v5, v153
    v_mfma_f32_16x16x16_bf16 v[184:187], a[132:133], a[116:117], v[184:187]
    v_and_b32 v146, v6, v152
    v_and_b32 v147, v7, v153
    v_mfma_f32_16x16x16_bf16 v[188:191], a[118:119], a[132:133], v[188:191]
    v_cndmask_b32 v168, v168, v169, s[70:71]
    v_cndmask_b32 v170, v170, v171, s[70:71]
    v_mfma_f32_16x16x32_bf16 v[176:179], a[56:59], a[24:27], v[176:179]
    buffer_load_dwordx4 v21, s[20:23], s78 offen sc1 lds
    v_cndmask_b32 v172, v172, v173, s[70:71]
    v_mfma_f32_16x16x32_bf16 v[180:183], a[60:63], a[24:27], v[180:183]
    v_cndmask_b32 v174, v174, v175, s[70:71]
    v_cndmask_b32 v168, v168, v172, s[72:73]
    v_mfma_f32_16x16x32_bf16 v[184:187], a[24:27], a[64:67], v[184:187]
    v_cndmask_b32 v169, v170, v174, s[74:75]
    v_max_f32_e64 v29, v168, v169
    v_mfma_f32_16x16x32_bf16 v[188:191], a[68:71], a[24:27], v[188:191]
    ds_swizzle_b32 v170, v29 offset:0x401F
    v_mfma_f32_16x16x32_bf16 v[132:135], a[140:143], v[144:147], 0
    buffer_load_dwordx4 v21, s[20:23], s78 offen offset:1024 sc1 lds
    v_cvt_pk_bf16_f32 v44, v68, v69
    v_mfma_f32_16x16x32_bf16 v[152:155], v[80:83], v[144:147], 0
    s_add_u32 s78, s39, 124928
    ds_read_b128 a[92:95], v14 offset:34816
    v_cvt_pk_bf16_f32 v45, v70, v71
    v_mfma_f32_16x16x32_bf16 v[156:159], v[40:43], v[144:147], 0
    s_waitcnt lgkmcnt(1)
    buffer_load_dwordx4 v21, s[20:23], s78 offen offset:2048 sc1 lds
    v_mfma_f32_16x16x32_bf16 v[176:179], a[72:75], a[28:31], v[176:179]
    ds_read_b128 a[96:99], v13 offset:55296
    v_mfma_f32_16x16x32_bf16 v[180:183], a[76:79], a[28:31], v[180:183]
    buffer_load_dwordx4 v21, s[20:23], s78 offen offset:3072 sc1 lds
    v_max_f32 v29, v29, v170
    v_mfma_f32_16x16x32_bf16 v[184:187], a[28:31], a[80:83], v[184:187]
    s_add_u32 s78, s39, 212992
    ds_bpermute_b32 v170, v8, v29
    ds_read_b128 v[56:59], v11 offset:3712
    v_mfma_f32_16x16x32_bf16 v[188:191], a[84:87], a[28:31], v[188:191]
    buffer_load_dwordx4 v[96:99], v21, s[20:23], s78 offen sc1
    v_mfma_f32_16x16x32_bf16 v[176:179], a[0:3], a[88:91], v[176:179]
    s_add_u32 s78, s39, 248832
    v_mfma_f32_16x16x32_bf16 v[180:183], a[4:7], a[88:91], v[180:183]
    buffer_load_dwordx4 v[100:103], v22, s[20:23], s78 offen offset:1024 sc1
    v_mfma_f32_16x16x32_bf16 v[184:187], a[88:91], a[8:11], v[184:187]
    v_rcp_f32_e64 v132, v132
    v_mfma_f32_16x16x32_bf16 v[188:191], a[12:15], a[88:91], v[188:191]
    buffer_load_dwordx4 v[104:107], v22, s[20:23], s78 offen offset:2048 sc1
    buffer_load_dwordx4 v[108:111], v22, s[20:23], s78 offen offset:3072 sc1
    v_pk_mul_f32 v[152:153], v[152:153], v[132:133] op_sel_hi:[1,0]
    v_pk_mul_f32 v[154:155], v[154:155], v[132:133] op_sel_hi:[1,0]
    v_pk_mul_f32 v[156:157], v[156:157], v[132:133] op_sel_hi:[1,0]
    v_pk_mul_f32 v[158:159], v[158:159], v[132:133] op_sel_hi:[1,0]
    v_cvt_pk_bf16_f32 v130, v152, v153
    v_cvt_pk_bf16_f32 v131, v154, v155
    v_cvt_pk_bf16_f32 v156, v156, v157
    v_cvt_pk_bf16_f32 v157, v158, v159
    ds_write_b64 v10, v[156:157] offset:4608
    v_permlane32_swap_b32 v128, v130
    v_permlane32_swap_b32 v129, v131
    buffer_store_dwordx4 v[128:131], v9, s[20:23], s64 offen sc1
    s_add_u32 s64, s64, 151552
    s_waitcnt lgkmcnt(1)
    s_nop 0
    v_pk_mul_f32 v[176:177], v[176:177], v[30:31] op_sel_hi:[1,0]
    v_pk_mul_f32 v[178:179], v[178:179], v[30:31] op_sel_hi:[1,0]
    v_pk_mul_f32 v[180:181], v[180:181], v[30:31] op_sel_hi:[1,0]
    v_pk_mul_f32 v[182:183], v[182:183], v[30:31] op_sel_hi:[1,0]
    v_pk_mul_f32 v[184:185], v[184:185], v[56:57]
    v_pk_mul_f32 v[186:187], v[186:187], v[58:59]
    v_pk_mul_f32 v[188:189], v[188:189], v[30:31] op_sel_hi:[1,0]
    v_pk_mul_f32 v[190:191], v[190:191], v[30:31] op_sel_hi:[1,0]
    v_cvt_pk_bf16_f32 v176, v176, v177
    v_cvt_pk_bf16_f32 v177, v178, v179
    v_cvt_pk_bf16_f32 v180, v180, v181
    v_cvt_pk_bf16_f32 v181, v182, v183
    v_mov_b32 v178, 0
    v_mov_b32 v179, 0
    v_cvt_pk_bf16_f32 v182, v188, v189
    v_cvt_pk_bf16_f32 v183, v190, v191
    v_cvt_pk_bf16_f32 v86, v184, v185
    v_cvt_pk_bf16_f32 v87, v186, v187
    v_permlane16_swap_b32 v178, v182
    v_permlane16_swap_b32 v179, v183
    s_nop 1
    v_mfma_f32_16x16x32_bf16 v[184:187], v[180:183], v[176:179], 0
    s_add_u32 s78, s39, 252928
    v_max_f32 v29, v29, v170
    ds_read_b128 a[100:103], v14 offset:55296
    v_mfma_f32_16x16x32_bf16 v[188:191], v[164:167], v[176:179], 0
    v_mul_f32_e64 v29, s66, v29
    v_fma_f32 v168, v168, s66, -v29
    v_mfma_f32_16x16x16_bf16 v[64:67], v[178:179], v[2:3], 0
    v_fma_f32 v169, v169, s66, -v29
    v_exp_f32_e64 v168, v168
    v_mfma_f32_16x16x16_bf16 v[192:195], a[112:113], a[134:135], v[192:195]
    buffer_load_dwordx4 v[112:115], v22, s[20:23], s78 offen sc1
    v_exp_f32_e64 v169, v169
    v_mfma_f32_16x16x16_bf16 v[196:199], a[114:115], a[134:135], v[196:199]
    v_cvt_pk_bf16_f32 v168, v168, v168
    v_cvt_pk_bf16_f32 v169, v169, v169
    v_and_b32_e64 v160, v4, v168
    v_mfma_f32_16x16x16_bf16 v[200:203], a[134:135], a[116:117], v[200:203]
    v_and_b32 v161, v5, v169
    v_and_b32 v162, v6, v168
    v_and_b32_e64 v163, v7, v169
    v_mfma_f32_16x16x16_bf16 v[204:207], a[118:119], a[134:135], v[204:207]
    v_cndmask_b32 v184, v184, v185, s[70:71]
    v_cndmask_b32 v186, v186, v187, s[70:71]
    v_mfma_f32_16x16x32_bf16 v[192:195], a[56:59], a[92:95], v[192:195]
    buffer_load_dwordx4 v[116:119], v22, s[20:23], s78 offen offset:1024 sc1
    v_cndmask_b32 v188, v188, v189, s[70:71]
    v_mfma_f32_16x16x32_bf16 v[196:199], a[60:63], a[92:95], v[196:199]
    v_cndmask_b32 v190, v190, v191, s[70:71]
    v_cndmask_b32 v184, v184, v188, s[72:73]
    v_mfma_f32_16x16x32_bf16 v[200:203], a[92:95], a[64:67], v[200:203]
    v_cndmask_b32 v185, v186, v190, s[74:75]
    v_max_f32_e64 v30, v184, v185
    v_mfma_f32_16x16x32_bf16 v[204:207], a[68:71], a[92:95], v[204:207]
    ds_swizzle_b32 v186, v30 offset:0x401F
    v_mfma_f32_16x16x32_bf16 v[148:151], a[140:143], v[160:163], 0
    s_add_u32 s78, s40, 2048
    v_cvt_pk_bf16_f32 v46, v64, v65
    ds_read_b128 a[104:107], v14 offset:36864
    v_mfma_f32_16x16x32_bf16 v[168:171], v[82:85], v[160:163], 0
    buffer_load_dwordx4 v[120:123], v21, s[20:23], s78 offen offset:2048 sc1
    v_cvt_pk_bf16_f32 v47, v66, v67
    v_mfma_f32_16x16x32_bf16 v[172:175], v[42:45], v[160:163], 0
    s_waitcnt lgkmcnt(1)
    ds_read_b128 a[108:111], v13 offset:57344
    v_mfma_f32_16x16x32_bf16 v[192:195], a[72:75], a[96:99], v[192:195]
    buffer_load_dwordx4 v[124:127], v21, s[20:23], s78 offen offset:3072 sc1
    s_add_u32 s78, s40, 6144
    v_mfma_f32_16x16x32_bf16 v[196:199], a[76:79], a[96:99], v[196:199]
    v_max_f32 v30, v30, v186
    v_mfma_f32_16x16x32_bf16 v[200:203], a[96:99], a[80:83], v[200:203]
    buffer_load_dwordx4 v[128:131], v21, s[20:23], s78 offen sc1
    ds_bpermute_b32 v186, v8, v30
    v_mfma_f32_16x16x32_bf16 v[204:207], a[84:87], a[96:99], v[204:207]
    ds_read_b128 v[60:63], v11 offset:3776
    v_mfma_f32_16x16x32_bf16 v[192:195], a[0:3], a[100:103], v[192:195]
    buffer_load_dwordx4 v[132:135], v21, s[20:23], s78 offen offset:1024 sc1
    v_mfma_f32_16x16x32_bf16 v[196:199], a[4:7], a[100:103], v[196:199]
    v_rcp_f32_e64 v148, v148
    v_mfma_f32_16x16x32_bf16 v[200:203], a[100:103], a[8:11], v[200:203]
    buffer_load_dwordx4 v[136:139], v21, s[20:23], s78 offen offset:2048 sc1
    s_add_u32 s78, s40, 41984
    v_mfma_f32_16x16x32_bf16 v[204:207], a[12:15], a[100:103], v[204:207]
    buffer_load_dwordx4 v[140:143], v21, s[20:23], s78 offen offset:3072 sc1
    v_pk_mul_f32 v[168:169], v[168:169], v[148:149] op_sel_hi:[1,0]
    v_pk_mul_f32 v[170:171], v[170:171], v[148:149] op_sel_hi:[1,0]
    v_pk_mul_f32 v[172:173], v[172:173], v[148:149] op_sel_hi:[1,0]
    v_pk_mul_f32 v[174:175], v[174:175], v[148:149] op_sel_hi:[1,0]
    v_cvt_pk_bf16_f32 v160, v168, v169
    v_cvt_pk_bf16_f32 v161, v170, v171
    v_cvt_pk_bf16_f32 v172, v172, v173
    v_cvt_pk_bf16_f32 v173, v174, v175
    ds_write_b64 v10, v[172:173] offset:8192
    s_waitcnt lgkmcnt(1)
    s_nop 0
    v_pk_mul_f32 v[192:193], v[192:193], v[30:31] op_sel:[0,1]
    v_pk_mul_f32 v[194:195], v[194:195], v[30:31] op_sel:[0,1]
    v_pk_mul_f32 v[196:197], v[196:197], v[30:31] op_sel:[0,1]
    v_pk_mul_f32 v[198:199], v[198:199], v[30:31] op_sel:[0,1]
    v_pk_mul_f32 v[200:201], v[200:201], v[60:61]
    v_pk_mul_f32 v[202:203], v[202:203], v[62:63]
    v_pk_mul_f32 v[204:205], v[204:205], v[30:31] op_sel:[0,1]
    v_pk_mul_f32 v[206:207], v[206:207], v[30:31] op_sel:[0,1]
    v_cvt_pk_bf16_f32 v192, v192, v193
    v_cvt_pk_bf16_f32 v193, v194, v195
    v_cvt_pk_bf16_f32 v196, v196, v197
    v_cvt_pk_bf16_f32 v197, v198, v199
    v_mov_b32 v194, 0
    v_mov_b32 v195, 0
    v_cvt_pk_bf16_f32 v198, v204, v205
    v_cvt_pk_bf16_f32 v199, v206, v207
    v_cvt_pk_bf16_f32 v88, v200, v201
    v_cvt_pk_bf16_f32 v89, v202, v203
    v_permlane16_swap_b32 v194, v198
    v_permlane16_swap_b32 v195, v199
    s_nop 1
    v_mfma_f32_16x16x32_bf16 v[200:203], v[196:199], v[192:195], 0
    s_add_u32 s78, s40, 46080
    v_max_f32 v30, v30, v186
    ds_read_b128 a[16:19], v14 offset:57344
    v_mfma_f32_16x16x32_bf16 v[204:207], v[180:183], v[192:195], 0
    v_mul_f32_e64 v30, s66, v30
    v_fma_f32 v184, v184, s66, -v30
    v_mfma_f32_16x16x16_bf16 v[68:71], v[194:195], v[2:3], 0
    v_fma_f32 v185, v185, s66, -v30
    v_exp_f32_e64 v184, v184
    v_mfma_f32_16x16x16_bf16 v[208:211], a[112:113], a[136:137], v[208:211]
    v_exp_f32_e64 v185, v185
    v_cvt_pk_bf16_f32 v184, v184, v184
    v_mfma_f32_16x16x16_bf16 v[212:215], a[114:115], a[136:137], v[212:215]
    v_cvt_pk_bf16_f32 v185, v185, v185
    v_and_b32 v176, v4, v184
    v_and_b32 v177, v5, v185
    v_mfma_f32_16x16x16_bf16 v[216:219], a[136:137], a[116:117], v[216:219]
    v_and_b32 v178, v6, v184
    v_and_b32 v179, v7, v185
    v_mfma_f32_16x16x16_bf16 v[220:223], a[118:119], a[136:137], v[220:223]
    v_cndmask_b32 v200, v200, v201, s[70:71]
    v_cndmask_b32 v202, v202, v203, s[70:71]
    v_mfma_f32_16x16x32_bf16 v[208:211], a[56:59], a[104:107], v[208:211]
    v_cndmask_b32 v204, v204, v205, s[70:71]
    v_cndmask_b32 v206, v206, v207, s[70:71]
    v_mfma_f32_16x16x32_bf16 v[212:215], a[60:63], a[104:107], v[212:215]
    v_cndmask_b32 v200, v200, v204, s[72:73]
    v_cndmask_b32 v201, v202, v206, s[74:75]
    v_mfma_f32_16x16x32_bf16 v[216:219], a[104:107], a[64:67], v[216:219]
    v_max_f32_e64 v31, v200, v201
    ds_swizzle_b32 v202, v31 offset:0x401F
    v_mfma_f32_16x16x32_bf16 v[220:223], a[68:71], a[104:107], v[220:223]
    v_mfma_f32_16x16x32_bf16 v[164:167], a[140:143], v[176:179], 0
    buffer_load_dwordx4 v[144:147], v21, s[20:23], s78 offen sc1
    v_cvt_pk_bf16_f32 v48, v68, v69
    v_mfma_f32_16x16x32_bf16 v[184:187], v[84:87], v[176:179], 0
    ds_read_b128 a[20:23], v14 offset:38912
    v_cvt_pk_bf16_f32 v49, v70, v71
    v_mfma_f32_16x16x32_bf16 v[188:191], v[44:47], v[176:179], 0
    s_waitcnt lgkmcnt(1)
    buffer_load_dwordx4 v[148:151], v21, s[20:23], s78 offen offset:1024 sc1
    v_mfma_f32_16x16x32_bf16 v[208:211], a[72:75], a[108:111], v[208:211]
    ds_read_b128 a[24:27], v13 offset:59392
    v_mfma_f32_16x16x32_bf16 v[212:215], a[76:79], a[108:111], v[212:215]
    v_max_f32 v31, v31, v202
    v_mfma_f32_16x16x32_bf16 v[216:219], a[108:111], a[80:83], v[216:219]
    buffer_load_dwordx4 v[152:155], v21, s[20:23], s78 offen offset:2048 sc1
    ds_bpermute_b32 v202, v8, v31
    v_mfma_f32_16x16x32_bf16 v[220:223], a[84:87], a[108:111], v[220:223]
    ds_read_b128 v[56:59], v11 offset:3840
    v_mfma_f32_16x16x32_bf16 v[208:211], a[0:3], a[16:19], v[208:211]
    v_mfma_f32_16x16x32_bf16 v[212:215], a[4:7], a[16:19], v[212:215]
    buffer_load_dwordx4 v[156:159], v21, s[20:23], s78 offen offset:3072 sc1
    v_mfma_f32_16x16x32_bf16 v[216:219], a[16:19], a[8:11], v[216:219]
    v_rcp_f32_e64 v164, v164
    v_mfma_f32_16x16x32_bf16 v[220:223], a[12:15], a[16:19], v[220:223]
    v_pk_mul_f32 v[184:185], v[184:185], v[164:165] op_sel_hi:[1,0]
    v_pk_mul_f32 v[186:187], v[186:187], v[164:165] op_sel_hi:[1,0]
    v_pk_mul_f32 v[188:189], v[188:189], v[164:165] op_sel_hi:[1,0]
    v_pk_mul_f32 v[190:191], v[190:191], v[164:165] op_sel_hi:[1,0]
    v_cvt_pk_bf16_f32 v162, v184, v185
    v_cvt_pk_bf16_f32 v163, v186, v187
    v_cvt_pk_bf16_f32 v188, v188, v189
    v_cvt_pk_bf16_f32 v189, v190, v191
    ds_write_b64 v10, v[188:189] offset:8704
    v_permlane32_swap_b32 v160, v162
    v_permlane32_swap_b32 v161, v163
    buffer_store_dwordx4 v[160:163], v9, s[20:23], s64 offen sc1
    s_add_u32 s64, s64, 151552
    s_waitcnt lgkmcnt(1)
    s_nop 0
    v_pk_mul_f32 v[208:209], v[208:209], v[32:33] op_sel_hi:[1,0]
    v_pk_mul_f32 v[210:211], v[210:211], v[32:33] op_sel_hi:[1,0]
    v_pk_mul_f32 v[212:213], v[212:213], v[32:33] op_sel_hi:[1,0]
    v_pk_mul_f32 v[214:215], v[214:215], v[32:33] op_sel_hi:[1,0]
    v_pk_mul_f32 v[216:217], v[216:217], v[56:57]
    v_pk_mul_f32 v[218:219], v[218:219], v[58:59]
    v_pk_mul_f32 v[220:221], v[220:221], v[32:33] op_sel_hi:[1,0]
    v_pk_mul_f32 v[222:223], v[222:223], v[32:33] op_sel_hi:[1,0]
    v_cvt_pk_bf16_f32 v208, v208, v209
    v_cvt_pk_bf16_f32 v209, v210, v211
    v_cvt_pk_bf16_f32 v212, v212, v213
    v_cvt_pk_bf16_f32 v213, v214, v215
    v_mov_b32 v210, 0
    v_mov_b32 v211, 0
    v_cvt_pk_bf16_f32 v214, v220, v221
    v_cvt_pk_bf16_f32 v215, v222, v223
    v_cvt_pk_bf16_f32 v90, v216, v217
    v_cvt_pk_bf16_f32 v91, v218, v219
    v_permlane16_swap_b32 v210, v214
    v_permlane16_swap_b32 v211, v215
    s_nop 1
    v_mfma_f32_16x16x32_bf16 v[216:219], v[212:215], v[208:211], 0
    s_add_u32 s78, s40, 86016
    v_max_f32 v31, v31, v202
    ds_read_b128 a[28:31], v14 offset:59392
    v_mfma_f32_16x16x32_bf16 v[220:223], v[196:199], v[208:211], 0
    v_mul_f32_e64 v31, s66, v31
    v_fma_f32 v200, v200, s66, -v31
    v_mfma_f32_16x16x16_bf16 v[64:67], v[210:211], v[2:3], 0
    v_fma_f32 v201, v201, s66, -v31
    v_exp_f32_e64 v200, v200
    v_mfma_f32_16x16x16_bf16 v[224:227], a[112:113], a[138:139], v[224:227]
    v_exp_f32_e64 v201, v201
    v_cvt_pk_bf16_f32 v200, v200, v200
    v_mfma_f32_16x16x16_bf16 v[228:231], a[114:115], a[138:139], v[228:231]
    v_cvt_pk_bf16_f32 v201, v201, v201
    v_and_b32 v192, v4, v200
    v_and_b32 v193, v5, v201
    v_mfma_f32_16x16x16_bf16 v[232:235], a[138:139], a[116:117], v[232:235]
    v_and_b32 v194, v6, v200
    v_and_b32 v195, v7, v201
    v_mfma_f32_16x16x16_bf16 v[236:239], a[118:119], a[138:139], v[236:239]
    v_cndmask_b32 v216, v216, v217, s[70:71]
    v_cndmask_b32 v218, v218, v219, s[70:71]
    v_mfma_f32_16x16x32_bf16 v[224:227], a[56:59], a[20:23], v[224:227]
    v_cndmask_b32 v220, v220, v221, s[70:71]
    v_cndmask_b32 v222, v222, v223, s[70:71]
    v_mfma_f32_16x16x32_bf16 v[228:231], a[60:63], a[20:23], v[228:231]
    v_cndmask_b32 v216, v216, v220, s[72:73]
    v_cndmask_b32 v217, v218, v222, s[74:75]
    v_mfma_f32_16x16x32_bf16 v[232:235], a[20:23], a[64:67], v[232:235]
    v_max_f32_e64 v32, v216, v217
    ds_swizzle_b32 v218, v32 offset:0x401F
    v_mfma_f32_16x16x32_bf16 v[236:239], a[68:71], a[20:23], v[236:239]
    v_mfma_f32_16x16x32_bf16 v[180:183], a[140:143], v[192:195], 0
    buffer_load_dwordx4 v[160:163], v21, s[20:23], s78 offen sc1
    v_cvt_pk_bf16_f32 v50, v64, v65
    v_mfma_f32_16x16x32_bf16 v[200:203], v[86:89], v[192:195], 0
    ds_read_b128 v[60:63], v11 offset:3904
    v_cvt_pk_bf16_f32 v51, v66, v67
    v_mfma_f32_16x16x32_bf16 v[204:207], v[46:49], v[192:195], 0
    s_waitcnt lgkmcnt(1)
    buffer_load_dwordx4 v[164:167], v21, s[20:23], s78 offen offset:1024 sc1
    v_mfma_f32_16x16x32_bf16 v[224:227], a[72:75], a[24:27], v[224:227]
    v_mfma_f32_16x16x32_bf16 v[228:231], a[76:79], a[24:27], v[228:231]
    v_max_f32 v32, v32, v218
    v_mfma_f32_16x16x32_bf16 v[232:235], a[24:27], a[80:83], v[232:235]
    buffer_load_dwordx4 v[168:171], v21, s[20:23], s78 offen offset:2048 sc1
    ds_bpermute_b32 v218, v8, v32
    v_mfma_f32_16x16x32_bf16 v[236:239], a[84:87], a[24:27], v[236:239]
    v_mfma_f32_16x16x32_bf16 v[224:227], a[0:3], a[28:31], v[224:227]
    v_mfma_f32_16x16x32_bf16 v[228:231], a[4:7], a[28:31], v[228:231]
    buffer_load_dwordx4 v[172:175], v21, s[20:23], s78 offen offset:3072 sc1
    v_mfma_f32_16x16x32_bf16 v[232:235], a[28:31], a[8:11], v[232:235]
    v_rcp_f32_e64 v180, v180
    v_mfma_f32_16x16x32_bf16 v[236:239], a[12:15], a[28:31], v[236:239]
    v_pk_mul_f32 v[200:201], v[200:201], v[180:181] op_sel_hi:[1,0]
    v_pk_mul_f32 v[202:203], v[202:203], v[180:181] op_sel_hi:[1,0]
    v_pk_mul_f32 v[204:205], v[204:205], v[180:181] op_sel_hi:[1,0]
    v_pk_mul_f32 v[206:207], v[206:207], v[180:181] op_sel_hi:[1,0]
    v_cvt_pk_bf16_f32 v192, v200, v201
    v_cvt_pk_bf16_f32 v193, v202, v203
    v_cvt_pk_bf16_f32 v204, v204, v205
    v_cvt_pk_bf16_f32 v205, v206, v207
    ds_write_b64 v10, v[204:205] offset:12288
    s_waitcnt lgkmcnt(2)
    s_nop 0
    v_pk_mul_f32 v[224:225], v[224:225], v[32:33] op_sel:[0,1]
    v_pk_mul_f32 v[226:227], v[226:227], v[32:33] op_sel:[0,1]
    v_pk_mul_f32 v[228:229], v[228:229], v[32:33] op_sel:[0,1]
    v_pk_mul_f32 v[230:231], v[230:231], v[32:33] op_sel:[0,1]
    v_pk_mul_f32 v[232:233], v[232:233], v[60:61]
    v_pk_mul_f32 v[234:235], v[234:235], v[62:63]
    v_pk_mul_f32 v[236:237], v[236:237], v[32:33] op_sel:[0,1]
    v_pk_mul_f32 v[238:239], v[238:239], v[32:33] op_sel:[0,1]
    v_cvt_pk_bf16_f32 v224, v224, v225
    v_cvt_pk_bf16_f32 v225, v226, v227
    v_cvt_pk_bf16_f32 v228, v228, v229
    v_cvt_pk_bf16_f32 v229, v230, v231
    v_mov_b32 v226, 0
    v_mov_b32 v227, 0
    v_cvt_pk_bf16_f32 v230, v236, v237
    v_cvt_pk_bf16_f32 v231, v238, v239
    v_cvt_pk_bf16_f32 v92, v232, v233
    v_cvt_pk_bf16_f32 v93, v234, v235
    v_permlane16_swap_b32 v226, v230
    v_permlane16_swap_b32 v227, v231
    s_barrier
    s_nop 0
    v_mfma_f32_16x16x32_bf16 v[232:235], v[228:231], v[224:227], 0
    s_waitcnt lgkmcnt(1)
    v_max_f32 v32, v32, v218
    v_mul_f32_e64 v32, s66, v32
    v_mfma_f32_16x16x32_bf16 v[236:239], v[212:215], v[224:227], 0
    s_add_u32 m0, s79, 98304
    v_fma_f32 v216, v216, s66, -v32
    v_fma_f32 v217, v217, s66, -v32
    v_mfma_f32_16x16x32_bf16 v[248:251], v[244:247], v[240:243], 0
    v_exp_f32_e64 v216, v216
    v_mfma_f32_16x16x32_bf16 v[252:255], v[228:231], v[240:243], v[252:255]
    s_add_u32 s78, s39, 129024
    v_exp_f32_e64 v217, v217
    v_mfma_f32_16x16x16_bf16 v[68:71], v[226:227], v[2:3], 0
    v_cvt_pk_bf16_f32 v216, v216, v216
    v_cvt_pk_bf16_f32 v217, v217, v217
    buffer_load_dwordx4 v21, s[20:23], s78 offen sc1 lds
    v_and_b32 v208, v4, v216
    v_and_b32 v209, v5, v217
    v_and_b32_e64 v210, v6, v216
    buffer_load_dwordx4 v21, s[20:23], s78 offen offset:1024 sc1 lds
    v_and_b32_e64 v211, v7, v217
    v_cndmask_b32 v232, v232, v233, s[70:71]
    buffer_load_dwordx4 v21, s[20:23], s78 offen offset:2048 sc1 lds
    v_cndmask_b32 v234, v234, v235, s[70:71]
    v_cndmask_b32 v236, v236, v237, s[70:71]
    v_cndmask_b32 v238, v238, v239, s[70:71]
    s_add_u32 s78, s39, 164864
    v_cndmask_b32 v232, v232, v236, s[72:73]
    v_cndmask_b32 v233, v234, v238, s[74:75]
    v_max_f32_e64 v33, v232, v233
    buffer_load_dwordx4 v21, s[20:23], s78 offen offset:3072 sc1 lds
    ds_swizzle_b32 v234, v33 offset:0x401F
    v_cndmask_b32 v248, v248, v249, s[70:71]
    v_cndmask_b32 v250, v250, v251, s[70:71]
    s_add_u32 m0, s79, 114688
    v_cndmask_b32 v252, v252, v253, s[70:71]
    v_cndmask_b32 v254, v254, v255, s[70:71]
    v_cndmask_b32 v248, v248, v252, s[72:73]
    s_add_u32 s78, s39, 168960
    v_cndmask_b32 v249, v250, v254, s[74:75]
    v_max_f32_e64 v24, v248, v249
    ds_swizzle_b32 v250, v24 offset:0x401F
    buffer_load_dwordx4 v21, s[20:23], s78 offen sc1 lds
    v_mfma_f32_16x16x32_bf16 v[196:199], a[140:143], v[208:211], 0
    v_cvt_pk_bf16_f32 v52, v68, v69
    v_cvt_pk_bf16_f32 v53, v70, v71
    v_mfma_f32_16x16x32_bf16 v[216:219], v[88:91], v[208:211], 0
    s_waitcnt lgkmcnt(1)
    buffer_load_dwordx4 v21, s[20:23], s78 offen offset:1024 sc1 lds
    v_max_f32 v33, v33, v234
    v_mfma_f32_16x16x32_bf16 v[220:223], v[48:51], v[208:211], 0
    ds_bpermute_b32 v234, v8, v33
    buffer_load_dwordx4 v21, s[20:23], s78 offen offset:2048 sc1 lds
    s_waitcnt lgkmcnt(1)
    v_max_f32 v24, v24, v250
    ds_bpermute_b32 v250, v8, v24
    buffer_load_dwordx4 v21, s[20:23], s78 offen offset:3072 sc1 lds
    v_rcp_f32_e64 v196, v196
    s_add_u32 m0, s79, 131072
    v_pk_mul_f32 v[216:217], v[216:217], v[196:197] op_sel_hi:[1,0]
    v_pk_mul_f32 v[218:219], v[218:219], v[196:197] op_sel_hi:[1,0]
    v_pk_mul_f32 v[220:221], v[220:221], v[196:197] op_sel_hi:[1,0]
    s_add_u32 s78, s39, 208896
    v_pk_mul_f32 v[222:223], v[222:223], v[196:197] op_sel_hi:[1,0]
    v_cvt_pk_bf16_f32 v194, v216, v217
    v_cvt_pk_bf16_f32 v195, v218, v219
    buffer_load_dwordx4 v21, s[20:23], s78 offen sc1 lds
    v_cvt_pk_bf16_f32 v220, v220, v221
    v_cvt_pk_bf16_f32 v221, v222, v223
    buffer_load_dwordx4 v21, s[20:23], s78 offen offset:1024 sc1 lds
    ds_write_b64 v10, v[220:221] offset:12800
    v_permlane32_swap_b32 v192, v194
    v_permlane32_swap_b32 v193, v195
    buffer_load_dwordx4 v21, s[20:23], s78 offen offset:2048 sc1 lds
    buffer_store_dwordx4 v[192:195], v9, s[20:23], s64 offen sc1
    s_sub_u32 s64, s64, 606208
    buffer_load_dwordx4 v21, s[20:23], s78 offen offset:3072 sc1 lds
    s_waitcnt lgkmcnt(2)
    v_max_f32 v33, v33, v234
    v_mul_f32_e64 v33, s66, v33
    v_fma_f32 v232, v232, s66, -v33
    s_add_u32 s78, s40, 90112
    v_fma_f32 v233, v233, s66, -v33
    v_exp_f32 v232, v232
    v_exp_f32 v233, v233
    buffer_load_dwordx4 v[176:179], v21, s[20:23], s78 offen sc1
    v_cvt_pk_bf16_f32 v232, v232, v232
    v_cvt_pk_bf16_f32 v233, v233, v233
    v_and_b32_e64 v224, v4, v232
    s_add_u32 s78, s40, 125952
    v_and_b32 v225, v5, v233
    v_and_b32 v226, v6, v232
    v_and_b32_e64 v227, v7, v233
    buffer_load_dwordx4 v[180:183], v21, s[20:23], s78 offen offset:1024 sc1
    s_waitcnt lgkmcnt(1)
    v_max_f32 v24, v24, v250
    v_mul_f32_e64 v24, s66, v24
    v_fma_f32 v248, v248, s66, -v24
    buffer_load_dwordx4 v[184:187], v21, s[20:23], s78 offen offset:2048 sc1
    v_fma_f32 v249, v249, s66, -v24
    v_exp_f32 v248, v248
    v_exp_f32 v249, v249
    buffer_load_dwordx4 v[188:191], v21, s[20:23], s78 offen offset:3072 sc1
L_isl_qkv_5:
    s_cbranch_execz L_warm_qkv_0
    v_cvt_pk_bf16_f32 v248, v248, v248
    v_cvt_pk_bf16_f32 v249, v249, v249
    v_and_b32 v240, v4, v248
    s_add_u32 s78, s40, 130048
    v_and_b32 v241, v5, v249
    v_and_b32 v242, v6, v248
    v_and_b32_e64 v243, v7, v249
    buffer_load_dwordx4 a[96:99], v21, s[20:23], s78 offen sc1
    v_mfma_f32_16x16x32_bf16 v[212:215], a[140:143], v[224:227], 0
    v_mfma_f32_16x16x32_bf16 v[232:235], v[90:93], v[224:227], 0
    v_mfma_f32_16x16x32_bf16 v[236:239], v[50:53], v[224:227], 0
    v_mfma_f32_16x16x32_bf16 v[228:231], a[140:143], v[240:243], 0
    v_mfma_f32_16x16x32_bf16 v[248:251], v[92:95], v[240:243], 0
    v_mfma_f32_16x16x32_bf16 v[252:255], v[52:55], v[240:243], 0
    s_nop 2
    v_rcp_f32 v212, v212
    s_nop 1
    v_rcp_f32 v228, v228
    buffer_load_dwordx4 a[100:103], v21, s[20:23], s78 offen offset:1024 sc1
    v_pk_mul_f32 v[232:233], v[232:233], v[212:213] op_sel_hi:[1,0]
    v_pk_mul_f32 v[234:235], v[234:235], v[212:213] op_sel_hi:[1,0]
    v_pk_mul_f32 v[236:237], v[236:237], v[212:213] op_sel_hi:[1,0]
    s_add_u32 s78, s40, 165888
    v_pk_mul_f32 v[238:239], v[238:239], v[212:213] op_sel_hi:[1,0]
    v_cvt_pk_bf16_f32 v224, v232, v233
    v_cvt_pk_bf16_f32 v225, v234, v235
    buffer_load_dwordx4 a[104:107], v21, s[20:23], s78 offen offset:2048 sc1
    v_cvt_pk_bf16_f32 v236, v236, v237
    v_cvt_pk_bf16_f32 v237, v238, v239
    ds_write_b64 v10, v[236:237] offset:1024
    buffer_load_dwordx4 a[108:111], v21, s[20:23], s78 offen offset:3072 sc1
    v_pk_mul_f32 v[248:249], v[248:249], v[228:229] op_sel_hi:[1,0]
    v_pk_mul_f32 v[250:251], v[250:251], v[228:229] op_sel_hi:[1,0]
    v_pk_mul_f32 v[252:253], v[252:253], v[228:229] op_sel_hi:[1,0]
    s_add_u32 s78, s40, 169984
    v_pk_mul_f32 v[254:255], v[254:255], v[228:229] op_sel_hi:[1,0]
    v_cvt_pk_bf16_f32 v226, v248, v249
    v_cvt_pk_bf16_f32 v227, v250, v251
    buffer_load_dwordx4 a[112:115], v21, s[20:23], s78 offen sc1
    v_cvt_pk_bf16_f32 v252, v252, v253
    v_cvt_pk_bf16_f32 v253, v254, v255
    ds_write_b64 v10, v[252:253] offset:1536
    buffer_load_dwordx4 a[116:119], v21, s[20:23], s78 offen offset:1024 sc1
    v_permlane32_swap_b32 v224, v226
    v_permlane32_swap_b32 v225, v227
    buffer_store_dwordx4 v[224:227], v72, s[20:23], s64 offen sc1
    buffer_load_dwordx4 a[120:123], v21, s[20:23], s78 offen offset:2048 sc1
    buffer_load_dword v15, v23, s[20:23], s52 offen sc1
    v_min_u32 v16, 1, v0
    v_lshlrev_b32 v16, 30, v16
    v_mov_b32_e64 v17, 1
    s_add_u32 s3, s79, 147456
    v_add_u32_e64 v1, s3, v21
    s_mul_i32 s3, s4, 151552
    s_add_u32 s64, s65, s3
    s_sub_u32 s65, s65, 151552
    s_cmp_eq_u32 s4, 0
    s_cselect_b64 s[70:71], -1, 0
    v_mov_b32 v3, 1073741824
    v_cndmask_b32 v2, v9, v12, s[70:71]
    v_cndmask_b32 v3, v3, v72, s[70:71]
    s_waitcnt lgkmcnt(0)
    s_barrier
    ds_read_b128 v[24:27], v1
    ds_read_b128 v[28:31], v1 offset:1024
    s_waitcnt lgkmcnt(1)
    buffer_store_dwordx4 v[24:27], v2, s[20:23], s64 offen sc1
    s_waitcnt lgkmcnt(0)
    buffer_store_dwordx4 v[28:31], v3, s[20:23], s65 offen sc1
    s_waitcnt vmcnt(2)
    s_mov_b32 s7, 0
L_spin_eqkv:
    v_cmp_eq_u32 vcc, 0, v15
    s_nop 3
    s_cbranch_vccz L_ok_eqkv
    s_add_u32 s7, s7, 1
    s_cmp_ge_u32 s7, 0x40000
    s_cbranch_scc1 L_ok_eqkv
    s_sleep 1
    buffer_load_dword v15, v23, s[20:23], s52 offen sc1
    s_waitcnt vmcnt(0)
    s_branch L_spin_eqkv
L_ok_eqkv:
    buffer_load_dwordx4 a[0:3], v21, s[20:23], s44 offen offset:0 sc1
    buffer_load_dwordx4 a[4:7], v21, s[20:23], s45 offen offset:0 sc1
    buffer_load_dwordx4 a[8:11], v21, s[20:23], s46 offen offset:0 sc1
    buffer_load_dwordx4 a[12:15], v21, s[20:23], s47 offen offset:0 sc1
    buffer_load_dwordx4 a[16:19], v21, s[20:23], s44 offen offset:1024 sc1
    buffer_load_dwordx4 a[20:23], v21, s[20:23], s45 offen offset:1024 sc1
    buffer_load_dwordx4 a[24:27], v21, s[20:23], s46 offen offset:1024 sc1
    buffer_load_dwordx4 a[28:31], v21, s[20:23], s47 offen offset:1024 sc1
    s_waitcnt vmcnt(8)
    s_barrier
    s_cmp_lg_u32 s4, 0
    s_cbranch_scc1 L_f2qkv
    buffer_store_dword v17, v16, s[20:23], s77 offen offset:128 sc1
L_f2qkv:
    buffer_load_dwordx4 a[32:35], v21, s[20:23], s44 offen offset:2048 sc1
    buffer_load_dwordx4 a[36:39], v21, s[20:23], s45 offen offset:2048 sc1
    buffer_load_dwordx4 a[40:43], v21, s[20:23], s46 offen offset:2048 sc1
    buffer_load_dwordx4 a[44:47], v21, s[20:23], s47 offen offset:2048 sc1
    s_waitcnt vmcnt(8)
    v_mfma_f32_16x16x32_bf16 v[192:195], a[144:147], a[0:3], 0
    v_add_u32 v8, s79, v21
    v_mfma_f32_16x16x32_bf16 v[196:199], a[148:151], a[0:3], 0
    v_add_u32 v9, 65536, v8
    v_mfma_f32_16x16x32_bf16 v[200:203], a[152:155], a[0:3], 0
    v_add_u32 v10, 131072, v8
    v_mfma_f32_16x16x32_bf16 v[204:207], a[156:159], a[0:3], 0
    v_min_u32_e64 v1, s55, v0
    v_mfma_f32_16x16x32_bf16 v[208:211], a[160:163], a[0:3], 0
    buffer_load_dwordx4 a[48:51], v21, s[20:23], s44 offen offset:3072 sc1
    v_lshlrev_b32_e64 v24, 8, v1
    v_mfma_f32_16x16x32_bf16 v[228:231], a[160:163], a[4:7], 0
    s_mov_b32 s28, s50
    v_mfma_f32_16x16x32_bf16 v[224:227], a[156:159], a[4:7], 0
    s_and_b32 s29, s51, 0xffff
    v_mfma_f32_16x16x32_bf16 v[220:223], a[152:155], a[4:7], 0
    s_mov_b32 s30, 2621440
    v_mfma_f32_16x16x32_bf16 v[216:219], a[148:151], a[4:7], 0
    s_mov_b32 s31, 0x20000
    v_mfma_f32_16x16x32_bf16 v[212:215], a[144:147], a[4:7], 0
    s_lshl_b32 s64, s36, 2
    buffer_load_dwordx4 a[52:55], v21, s[20:23], s45 offen offset:3072 sc1
    v_mfma_f32_16x16x32_bf16 v[232:235], a[144:147], a[8:11], 0
    s_add_u32 s64, s64, s4
    v_mfma_f32_16x16x32_bf16 v[236:239], a[148:151], a[8:11], 0
    s_lshl_b32 s65, s64, 6
    v_mfma_f32_16x16x32_bf16 v[240:243], a[152:155], a[8:11], 0
    s_add_u32 s65, s65, 22085632
    v_mfma_f32_16x16x32_bf16 v[244:247], a[156:159], a[8:11], 0
    s_mul_i32 s66, s64, 20480
    v_mfma_f32_16x16x32_bf16 v[248:251], a[160:163], a[8:11], 0
    s_mul_i32 s3, s37, 160
    buffer_load_dwordx4 a[56:59], v21, s[20:23], s46 offen offset:3072 sc1
    v_mfma_f32_16x16x32_bf16 v[92:95], a[160:163], a[12:15], 0
    s_add_u32 s66, s66, s3
    v_mfma_f32_16x16x32_bf16 v[88:91], a[156:159], a[12:15], 0
    v_mfma_f32_16x16x32_bf16 v[84:87], a[152:155], a[12:15], 0
    v_and_b32 v1, 15, v0
    v_mfma_f32_16x16x32_bf16 v[80:83], a[148:151], a[12:15], 0
    v_lshrrev_b32_e64 v2, 4, v0
    buffer_load_dwordx4 a[60:63], v21, s[20:23], s47 offen offset:3072 sc1
    v_mfma_f32_16x16x32_bf16 v[252:255], a[144:147], a[12:15], 0
    s_waitcnt vmcnt(8)
    v_mfma_f32_16x16x32_bf16 v[192:195], a[164:167], a[16:19], v[192:195]
    s_add_u32 s44, s44, 4096
    v_mul_u32_u24 v37, 160, v1
    v_mfma_f32_16x16x32_bf16 v[196:199], a[168:171], a[16:19], v[196:199]
    v_lshl_add_u32 v37, v2, 3, v37
    v_mfma_f32_16x16x32_bf16 v[200:203], a[172:175], a[16:19], v[200:203]
    v_lshlrev_b32 v38, 2, v1
    v_mfma_f32_16x16x32_bf16 v[204:207], a[176:179], a[16:19], v[204:207]
    s_add_u32 s68, s79, 147456
    buffer_load_dwordx4 a[64:67], v21, s[20:23], s44 offen offset:0 sc1
    v_mfma_f32_16x16x32_bf16 v[208:211], a[180:183], a[16:19], v[208:211]
    s_add_u32 s45, s45, 4096
    v_add_u32_e64 v35, s68, v37
    v_mfma_f32_16x16x32_bf16 v[228:231], a[180:183], a[20:23], v[228:231]
    v_add_u32_e64 v37, s79, v37
    v_mfma_f32_16x16x32_bf16 v[224:227], a[176:179], a[20:23], v[224:227]
    v_add_u32_e64 v1, 0, v0
    v_mfma_f32_16x16x32_bf16 v[220:223], a[172:175], a[20:23], v[220:223]
    v_mul_u32_u24 v2, 205, v1
    v_mfma_f32_16x16x32_bf16 v[216:219], a[168:171], a[20:23], v[216:219]
    buffer_load_dwordx4 a[68:71], v21, s[20:23], s45 offen offset:0 sc1
    v_lshrrev_b32_e64 v2, 11, v2
    v_mfma_f32_16x16x32_bf16 v[212:215], a[164:167], a[20:23], v[212:215]
    s_add_u32 s46, s46, 4096
    v_mfma_f32_16x16x32_bf16 v[232:235], a[164:167], a[24:27], v[232:235]
    v_mul_u32_u24 v3, 1120, v2
    v_mfma_f32_16x16x32_bf16 v[236:239], a[168:171], a[24:27], v[236:239]
    v_lshl_add_u32 v18, v1, 4, v3
    v_mfma_f32_16x16x32_bf16 v[240:243], a[172:175], a[24:27], v[240:243]
    v_add_u32_e64 v1, 64, v0
    v_mfma_f32_16x16x32_bf16 v[244:247], a[176:179], a[24:27], v[244:247]
    buffer_load_dwordx4 a[72:75], v21, s[20:23], s46 offen offset:0 sc1
    v_mul_u32_u24 v2, 205, v1
    v_mfma_f32_16x16x32_bf16 v[248:251], a[180:183], a[24:27], v[248:251]
    s_add_u32 s47, s47, 4096
    v_lshrrev_b32_e64 v2, 11, v2
    v_mfma_f32_16x16x32_bf16 v[92:95], a[180:183], a[28:31], v[92:95]
    v_mul_u32_u24 v3, 1120, v2
    v_mfma_f32_16x16x32_bf16 v[88:91], a[176:179], a[28:31], v[88:91]
    v_lshl_add_u32 v19, v1, 4, v3
    v_mfma_f32_16x16x32_bf16 v[84:87], a[172:175], a[28:31], v[84:87]
    v_add_u32 v1, 128, v0
    v_mfma_f32_16x16x32_bf16 v[80:83], a[168:171], a[28:31], v[80:83]
    buffer_load_dwordx4 a[76:79], v21, s[20:23], s47 offen offset:0 sc1
    v_mul_u32_u24 v2, 205, v1
    v_mfma_f32_16x16x32_bf16 v[252:255], a[164:167], a[28:31], v[252:255]
    s_waitcnt vmcnt(8)
    v_mfma_f32_16x16x32_bf16 v[192:195], a[184:187], a[32:35], v[192:195]
    v_lshrrev_b32 v2, 11, v2
    v_mfma_f32_16x16x32_bf16 v[196:199], a[188:191], a[32:35], v[196:199]
    v_mul_u32_u24 v3, 1120, v2
    v_mfma_f32_16x16x32_bf16 v[200:203], a[192:195], a[32:35], v[200:203]
    buffer_load_dword v15, v23, s[20:23], s53 offen sc1
    v_lshl_add_u32 v20, v1, 4, v3
    v_mfma_f32_16x16x32_bf16 v[204:207], a[196:199], a[32:35], v[204:207]
    v_lshrrev_b32_e64 v2, 4, v2
    v_mfma_f32_16x16x32_bf16 v[208:211], a[200:203], a[32:35], v[208:211]
    v_lshl_add_u32 v20, v2, 30, v20
    v_mfma_f32_16x16x32_bf16 v[228:231], a[200:203], a[36:39], v[228:231]
    s_sub_u32 s3, s4, 1
    v_mfma_f32_16x16x32_bf16 v[224:227], a[196:199], a[36:39], v[224:227]
    s_and_b32 s3, s3, 3
    buffer_load_dwordx4 a[80:83], v21, s[20:23], s44 offen offset:1024 sc1
    v_mfma_f32_16x16x32_bf16 v[220:223], a[192:195], a[36:39], v[220:223]
    s_lshl_b32 s3, s3, 12
    v_mfma_f32_16x16x32_bf16 v[216:219], a[188:191], a[36:39], v[216:219]
    s_add_u32 s3, s3, 0
    v_mfma_f32_16x16x32_bf16 v[212:215], a[184:187], a[36:39], v[212:215]
    v_mfma_f32_16x16x32_bf16 v[232:235], a[184:187], a[40:43], v[232:235]
    buffer_load_dwordx4 a[84:87], v21, s[20:23], s45 offen offset:1024 sc1
    v_add_u32_e64 v4, s3, v21
    v_mfma_f32_16x16x32_bf16 v[236:239], a[188:191], a[40:43], v[236:239]
    s_sub_u32 s3, s4, 2
    v_mfma_f32_16x16x32_bf16 v[240:243], a[192:195], a[40:43], v[240:243]
    s_and_b32 s3, s3, 3
    v_mfma_f32_16x16x32_bf16 v[244:247], a[196:199], a[40:43], v[244:247]
    s_lshl_b32 s3, s3, 12
    v_mfma_f32_16x16x32_bf16 v[248:251], a[200:203], a[40:43], v[248:251]
    s_add_u32 s3, s3, 1024
    buffer_load_dwordx4 a[88:91], v21, s[20:23], s46 offen offset:1024 sc1
    v_mfma_f32_16x16x32_bf16 v[92:95], a[200:203], a[44:47], v[92:95]
    v_add_u32 v5, s3, v21
    v_mfma_f32_16x16x32_bf16 v[88:91], a[196:199], a[44:47], v[88:91]
    s_sub_u32 s3, s4, 3
    v_mfma_f32_16x16x32_bf16 v[84:87], a[192:195], a[44:47], v[84:87]
    s_and_b32 s3, s3, 3
    v_mfma_f32_16x16x32_bf16 v[80:83], a[188:191], a[44:47], v[80:83]
    s_lshl_b32 s3, s3, 12
    buffer_load_dwordx4 a[92:95], v21, s[20:23], s47 offen offset:1024 sc1
    v_mfma_f32_16x16x32_bf16 v[252:255], a[184:187], a[44:47], v[252:255]
    s_waitcnt vmcnt(9)
    v_mfma_f32_16x16x32_bf16 v[192:195], a[204:207], a[48:51], v[192:195]
    s_add_u32 s3, s3, 2048
    s_sub_u32 s44, s44, s41
    v_mfma_f32_16x16x32_bf16 v[196:199], a[208:211], a[48:51], v[196:199]
    v_add_u32 v6, s3, v21
    v_mfma_f32_16x16x32_bf16 v[200:203], a[212:215], a[48:51], v[200:203]
    s_mul_i32 s3, s4, 15360
    v_mfma_f32_16x16x32_bf16 v[204:207], a[216:219], a[48:51], v[204:207]
    s_add_u32 s3, s3, 81920
    buffer_load_dwordx4 a[0:3], v21, s[20:23], s44 offen offset:2048 sc1
    v_mfma_f32_16x16x32_bf16 v[208:211], a[220:223], a[48:51], v[208:211]
    s_sub_u32 s45, s45, s41
    v_add_u32 v11, s3, v21
    v_mfma_f32_16x16x32_bf16 v[228:231], a[220:223], a[52:55], v[228:231]
    s_sub_u32 s3, s4, 1
    v_mfma_f32_16x16x32_bf16 v[224:227], a[216:219], a[52:55], v[224:227]
    s_and_b32 s3, s3, 3
    v_mfma_f32_16x16x32_bf16 v[220:223], a[212:215], a[52:55], v[220:223]
    s_mul_i32 s3, s3, 15360
    v_mfma_f32_16x16x32_bf16 v[216:219], a[208:211], a[52:55], v[216:219]
    s_add_u32 s3, s3, 81920
    buffer_load_dwordx4 a[4:7], v21, s[20:23], s45 offen offset:2048 sc1
    v_mfma_f32_16x16x32_bf16 v[212:215], a[204:207], a[52:55], v[212:215]
    s_sub_u32 s46, s46, s41
    v_add_u32 v7, s3, v21
    v_mfma_f32_16x16x32_bf16 v[232:235], a[204:207], a[56:59], v[232:235]
    s_sub_u32 s3, s4, 2
    v_mfma_f32_16x16x32_bf16 v[236:239], a[208:211], a[56:59], v[236:239]
    s_and_b32 s3, s3, 3
    v_mfma_f32_16x16x32_bf16 v[240:243], a[212:215], a[56:59], v[240:243]
    s_mul_i32 s3, s3, 15360
    v_mfma_f32_16x16x32_bf16 v[244:247], a[216:219], a[56:59], v[244:247]
    s_add_u32 s3, s3, 87040
    buffer_load_dwordx4 a[8:11], v21, s[20:23], s46 offen offset:2048 sc1
    v_mfma_f32_16x16x32_bf16 v[248:251], a[220:223], a[56:59], v[248:251]
    s_sub_u32 s47, s47, s41
    v_add_u32 v25, s3, v21
    v_mfma_f32_16x16x32_bf16 v[92:95], a[220:223], a[60:63], v[92:95]
    s_sub_u32 s3, s4, 3
    v_mfma_f32_16x16x32_bf16 v[88:91], a[216:219], a[60:63], v[88:91]
    s_and_b32 s3, s3, 3
    v_mfma_f32_16x16x32_bf16 v[84:87], a[212:215], a[60:63], v[84:87]
    s_mul_i32 s3, s3, 15360
    v_mfma_f32_16x16x32_bf16 v[80:83], a[208:211], a[60:63], v[80:83]
    s_add_u32 s3, s3, 92160
    buffer_load_dwordx4 a[12:15], v21, s[20:23], s47 offen offset:2048 sc1
    v_mfma_f32_16x16x32_bf16 v[252:255], a[204:207], a[60:63], v[252:255]
    v_add_u32 v34, s3, v21
    s_waitcnt vmcnt(8)
    v_cmp_eq_u32_e64 vcc, 0, v15
    v_mfma_f32_16x16x32_bf16 v[192:195], a[224:227], a[64:67], v[192:195]
    v_mfma_f32_16x16x32_bf16 v[196:199], a[228:231], a[64:67], v[196:199]
    ds_read_b128 v[72:75], v9 offset:0
    s_cbranch_vccnz L_slow_lqkv
L_ok_lqkv:
    v_mfma_f32_16x16x32_bf16 v[200:203], a[232:235], a[64:67], v[200:203]
    s_add_u32 s44, s44, s48
    v_mfma_f32_16x16x32_bf16 v[204:207], a[236:239], a[64:67], v[204:207]
    v_mfma_f32_16x16x32_bf16 v[208:211], a[240:243], a[64:67], v[208:211]
    buffer_load_dwordx4 a[16:19], v21, s[20:23], s44 offen offset:0 sc1
    v_mfma_f32_16x16x32_bf16 v[228:231], a[240:243], a[68:71], v[228:231]
    s_add_u32 s45, s45, s48
    v_mfma_f32_16x16x32_bf16 v[224:227], a[236:239], a[68:71], v[224:227]
    v_mfma_f32_16x16x32_bf16 v[220:223], a[232:235], a[68:71], v[220:223]
    ds_read_b128 v[76:79], v9 offset:1024
    v_mfma_f32_16x16x32_bf16 v[216:219], a[228:231], a[68:71], v[216:219]
    v_mfma_f32_16x16x32_bf16 v[212:215], a[224:227], a[68:71], v[212:215]
    buffer_load_dwordx4 a[20:23], v21, s[20:23], s45 offen offset:0 sc1
    v_mfma_f32_16x16x32_bf16 v[232:235], a[224:227], a[72:75], v[232:235]
    s_add_u32 s46, s46, s48
    v_mfma_f32_16x16x32_bf16 v[236:239], a[228:231], a[72:75], v[236:239]
    v_mfma_f32_16x16x32_bf16 v[240:243], a[232:235], a[72:75], v[240:243]
    v_mfma_f32_16x16x32_bf16 v[244:247], a[236:239], a[72:75], v[244:247]
    v_mfma_f32_16x16x32_bf16 v[248:251], a[240:243], a[72:75], v[248:251]
    buffer_load_dwordx4 a[24:27], v21, s[20:23], s46 offen offset:0 sc1
    s_add_u32 s47, s47, s48
    v_mfma_f32_16x16x32_bf16 v[92:95], a[240:243], a[76:79], v[92:95]
    v_mfma_f32_16x16x32_bf16 v[88:91], a[236:239], a[76:79], v[88:91]
    v_mfma_f32_16x16x32_bf16 v[84:87], a[232:235], a[76:79], v[84:87]
    v_mfma_f32_16x16x32_bf16 v[80:83], a[228:231], a[76:79], v[80:83]
    buffer_load_dwordx4 a[28:31], v21, s[20:23], s47 offen offset:0 sc1
    v_mfma_f32_16x16x32_bf16 v[252:255], a[224:227], a[76:79], v[252:255]
    s_waitcnt vmcnt(8) lgkmcnt(0)
    v_mfma_f32_16x16x32_bf16 v[192:195], a[244:247], a[80:83], v[192:195]
    v_mfma_f32_16x16x32_bf16 v[196:199], a[248:251], a[80:83], v[196:199]
    ds_read_b128 v[40:43], v9 offset:2048
    v_mfma_f32_16x16x32_bf16 v[200:203], a[252:255], a[80:83], v[200:203]
    v_mfma_f32_16x16x32_bf16 v[204:207], v[72:75], a[80:83], v[204:207]
    buffer_load_dwordx4 a[32:35], v21, s[20:23], s44 offen offset:1024 sc1
    ds_read_b128 v[44:47], v9 offset:3072
    v_mfma_f32_16x16x32_bf16 v[208:211], v[76:79], a[80:83], v[208:211]
    v_mfma_f32_16x16x32_bf16 v[228:231], v[76:79], a[84:87], v[228:231]
    v_mfma_f32_16x16x32_bf16 v[224:227], v[72:75], a[84:87], v[224:227]
    ds_read_b128 v[48:51], v9 offset:16384
    v_mfma_f32_16x16x32_bf16 v[220:223], a[252:255], a[84:87], v[220:223]
    v_mfma_f32_16x16x32_bf16 v[216:219], a[248:251], a[84:87], v[216:219]
    buffer_load_dwordx4 a[36:39], v21, s[20:23], s45 offen offset:1024 sc1
    ds_read_b128 v[52:55], v9 offset:17408
    v_mfma_f32_16x16x32_bf16 v[212:215], a[244:247], a[84:87], v[212:215]
    v_mfma_f32_16x16x32_bf16 v[232:235], a[244:247], a[88:91], v[232:235]
    v_mfma_f32_16x16x32_bf16 v[236:239], a[248:251], a[88:91], v[236:239]
    ds_read_b128 v[56:59], v9 offset:18432
    v_mfma_f32_16x16x32_bf16 v[240:243], a[252:255], a[88:91], v[240:243]
    v_mfma_f32_16x16x32_bf16 v[244:247], v[72:75], a[88:91], v[244:247]
    buffer_load_dwordx4 a[40:43], v21, s[20:23], s46 offen offset:1024 sc1
    v_mfma_f32_16x16x32_bf16 v[248:251], v[76:79], a[88:91], v[248:251]
    v_mfma_f32_16x16x32_bf16 v[92:95], v[76:79], a[92:95], v[92:95]
    v_mfma_f32_16x16x32_bf16 v[88:91], v[72:75], a[92:95], v[88:91]
    v_mfma_f32_16x16x32_bf16 v[84:87], a[252:255], a[92:95], v[84:87]
    v_mfma_f32_16x16x32_bf16 v[80:83], a[248:251], a[92:95], v[80:83]
    buffer_load_dwordx4 a[44:47], v21, s[20:23], s47 offen offset:1024 sc1
    v_mfma_f32_16x16x32_bf16 v[252:255], a[244:247], a[92:95], v[252:255]
    s_waitcnt vmcnt(8) lgkmcnt(0)
    v_mfma_f32_16x16x32_bf16 v[192:195], v[40:43], a[0:3], v[192:195]
    v_mfma_f32_16x16x32_bf16 v[196:199], v[44:47], a[0:3], v[196:199]
    ds_read_b128 v[60:63], v9 offset:19456
    v_mfma_f32_16x16x32_bf16 v[200:203], v[48:51], a[0:3], v[200:203]
    v_mfma_f32_16x16x32_bf16 v[204:207], v[52:55], a[0:3], v[204:207]
    buffer_load_dwordx4 a[48:51], v21, s[20:23], s44 offen offset:2048 sc1
    ds_read_b128 v[64:67], v8 offset:0
    v_mfma_f32_16x16x32_bf16 v[208:211], v[56:59], a[0:3], v[208:211]
    v_mfma_f32_16x16x32_bf16 v[228:231], v[56:59], a[4:7], v[228:231]
    v_mfma_f32_16x16x32_bf16 v[224:227], v[52:55], a[4:7], v[224:227]
    ds_read_b128 v[68:71], v8 offset:1024
    v_mfma_f32_16x16x32_bf16 v[220:223], v[48:51], a[4:7], v[220:223]
    v_mfma_f32_16x16x32_bf16 v[216:219], v[44:47], a[4:7], v[216:219]
    buffer_load_dwordx4 a[52:55], v21, s[20:23], s45 offen offset:2048 sc1
    ds_read_b128 v[72:75], v8 offset:2048
    v_mfma_f32_16x16x32_bf16 v[212:215], v[40:43], a[4:7], v[212:215]
    v_mfma_f32_16x16x32_bf16 v[232:235], v[40:43], a[8:11], v[232:235]
    v_mfma_f32_16x16x32_bf16 v[236:239], v[44:47], a[8:11], v[236:239]
    ds_read_b128 v[76:79], v8 offset:3072
    v_mfma_f32_16x16x32_bf16 v[240:243], v[48:51], a[8:11], v[240:243]
    v_mfma_f32_16x16x32_bf16 v[244:247], v[52:55], a[8:11], v[244:247]
    buffer_load_dwordx4 a[56:59], v21, s[20:23], s46 offen offset:2048 sc1
    v_mfma_f32_16x16x32_bf16 v[248:251], v[56:59], a[8:11], v[248:251]
    v_mfma_f32_16x16x32_bf16 v[92:95], v[56:59], a[12:15], v[92:95]
    v_mfma_f32_16x16x32_bf16 v[88:91], v[52:55], a[12:15], v[88:91]
    v_mfma_f32_16x16x32_bf16 v[84:87], v[48:51], a[12:15], v[84:87]
    v_mfma_f32_16x16x32_bf16 v[80:83], v[44:47], a[12:15], v[80:83]
    buffer_load_dwordx4 a[60:63], v21, s[20:23], s47 offen offset:2048 sc1
    v_mfma_f32_16x16x32_bf16 v[252:255], v[40:43], a[12:15], v[252:255]
    s_waitcnt vmcnt(8) lgkmcnt(0)
    v_mfma_f32_16x16x32_bf16 v[192:195], v[60:63], a[16:19], v[192:195]
    v_mfma_f32_16x16x32_bf16 v[196:199], v[64:67], a[16:19], v[196:199]
    ds_read_b128 v[40:43], v8 offset:16384
    v_mfma_f32_16x16x32_bf16 v[200:203], v[68:71], a[16:19], v[200:203]
    v_mfma_f32_16x16x32_bf16 v[204:207], v[72:75], a[16:19], v[204:207]
    buffer_load_dwordx4 a[64:67], v21, s[20:23], s44 offen offset:3072 sc1
    ds_read_b128 v[44:47], v8 offset:17408
    v_mfma_f32_16x16x32_bf16 v[208:211], v[76:79], a[16:19], v[208:211]
    v_mfma_f32_16x16x32_bf16 v[228:231], v[76:79], a[20:23], v[228:231]
    v_mfma_f32_16x16x32_bf16 v[224:227], v[72:75], a[20:23], v[224:227]
    ds_read_b128 v[48:51], v8 offset:18432
    v_mfma_f32_16x16x32_bf16 v[220:223], v[68:71], a[20:23], v[220:223]
    v_mfma_f32_16x16x32_bf16 v[216:219], v[64:67], a[20:23], v[216:219]
    buffer_load_dwordx4 a[68:71], v21, s[20:23], s45 offen offset:3072 sc1
    ds_read_b128 v[52:55], v8 offset:19456
    v_mfma_f32_16x16x32_bf16 v[212:215], v[60:63], a[20:23], v[212:215]
    v_mfma_f32_16x16x32_bf16 v[232:235], v[60:63], a[24:27], v[232:235]
    v_mfma_f32_16x16x32_bf16 v[236:239], v[64:67], a[24:27], v[236:239]
    ds_read_b128 v[56:59], v8 offset:32768
    v_mfma_f32_16x16x32_bf16 v[240:243], v[68:71], a[24:27], v[240:243]
    v_mfma_f32_16x16x32_bf16 v[244:247], v[72:75], a[24:27], v[244:247]
    buffer_load_dwordx4 a[72:75], v21, s[20:23], s46 offen offset:3072 sc1
    v_mfma_f32_16x16x32_bf16 v[248:251], v[76:79], a[24:27], v[248:251]
    v_mfma_f32_16x16x32_bf16 v[92:95], v[76:79], a[28:31], v[92:95]
    v_mfma_f32_16x16x32_bf16 v[88:91], v[72:75], a[28:31], v[88:91]
    v_mfma_f32_16x16x32_bf16 v[84:87], v[68:71], a[28:31], v[84:87]
    v_mfma_f32_16x16x32_bf16 v[80:83], v[64:67], a[28:31], v[80:83]
    buffer_load_dwordx4 a[76:79], v21, s[20:23], s47 offen offset:3072 sc1
    v_mfma_f32_16x16x32_bf16 v[252:255], v[60:63], a[28:31], v[252:255]
    s_waitcnt vmcnt(8) lgkmcnt(0)
    v_mfma_f32_16x16x32_bf16 v[192:195], v[40:43], a[32:35], v[192:195]
    s_add_u32 s45, s45, 4096
    v_mfma_f32_16x16x32_bf16 v[196:199], v[44:47], a[32:35], v[196:199]
    ds_read_b128 v[60:63], v8 offset:33792
    v_mfma_f32_16x16x32_bf16 v[200:203], v[48:51], a[32:35], v[200:203]
    v_mfma_f32_16x16x32_bf16 v[204:207], v[52:55], a[32:35], v[204:207]
    buffer_load_dwordx4 a[80:83], v21, s[20:23], s45 offen offset:0 sc1
    ds_read_b128 v[64:67], v8 offset:34816
    v_mfma_f32_16x16x32_bf16 v[208:211], v[56:59], a[32:35], v[208:211]
    v_mfma_f32_16x16x32_bf16 v[228:231], v[56:59], a[36:39], v[228:231]
    v_mfma_f32_16x16x32_bf16 v[224:227], v[52:55], a[36:39], v[224:227]
    ds_read_b128 v[68:71], v8 offset:35840
    v_mfma_f32_16x16x32_bf16 v[220:223], v[48:51], a[36:39], v[220:223]
    v_mfma_f32_16x16x32_bf16 v[216:219], v[44:47], a[36:39], v[216:219]
    buffer_load_dwordx4 a[84:87], v21, s[20:23], s45 offen offset:1024 sc1
    s_sub_u32 s45, s45, s41
    v_mfma_f32_16x16x32_bf16 v[212:215], v[40:43], a[36:39], v[212:215]
    ds_read_b128 v[72:75], v8 offset:49152
    v_mfma_f32_16x16x32_bf16 v[232:235], v[40:43], a[40:43], v[232:235]
    v_mfma_f32_16x16x32_bf16 v[236:239], v[44:47], a[40:43], v[236:239]
    ds_read_b128 v[76:79], v8 offset:50176
    v_mfma_f32_16x16x32_bf16 v[240:243], v[48:51], a[40:43], v[240:243]
    v_mfma_f32_16x16x32_bf16 v[244:247], v[52:55], a[40:43], v[244:247]
    buffer_load_dwordx4 a[88:91], v21, s[20:23], s45 offen offset:2048 sc1
    s_add_u32 s46, s46, 4096
    v_mfma_f32_16x16x32_bf16 v[248:251], v[56:59], a[40:43], v[248:251]
    v_mfma_f32_16x16x32_bf16 v[92:95], v[56:59], a[44:47], v[92:95]
    v_mfma_f32_16x16x32_bf16 v[88:91], v[52:55], a[44:47], v[88:91]
    v_mfma_f32_16x16x32_bf16 v[84:87], v[48:51], a[44:47], v[84:87]
    v_mfma_f32_16x16x32_bf16 v[80:83], v[44:47], a[44:47], v[80:83]
    buffer_load_dwordx4 a[92:95], v21, s[20:23], s46 offen offset:0 sc1
    v_mfma_f32_16x16x32_bf16 v[252:255], v[40:43], a[44:47], v[252:255]
    s_waitcnt vmcnt(8) lgkmcnt(0)
    v_mfma_f32_16x16x32_bf16 v[192:195], v[60:63], a[48:51], v[192:195]
    v_mfma_f32_16x16x32_bf16 v[196:199], v[64:67], a[48:51], v[196:199]
    buffer_load_dword v15, v24, s[20:23], s54 offen sc1
    ds_read_b128 v[40:43], v8 offset:51200
    v_mfma_f32_16x16x32_bf16 v[200:203], v[68:71], a[48:51], v[200:203]
    v_mfma_f32_16x16x32_bf16 v[204:207], v[72:75], a[48:51], v[204:207]
    ds_read_b128 v[44:47], v8 offset:52224
    v_mfma_f32_16x16x32_bf16 v[208:211], v[76:79], a[48:51], v[208:211]
    buffer_load_dwordx4 a[0:3], v21, s[20:23], s46 offen offset:1024 sc1
    s_sub_u32 s46, s46, s41
    v_mfma_f32_16x16x32_bf16 v[228:231], v[76:79], a[52:55], v[228:231]
    v_mfma_f32_16x16x32_bf16 v[224:227], v[72:75], a[52:55], v[224:227]
    ds_read_b128 v[48:51], v9 offset:32768
    v_mfma_f32_16x16x32_bf16 v[220:223], v[68:71], a[52:55], v[220:223]
    buffer_load_dwordx4 a[4:7], v21, s[20:23], s46 offen offset:2048 sc1
    v_mfma_f32_16x16x32_bf16 v[216:219], v[64:67], a[52:55], v[216:219]
    s_add_u32 s47, s47, 4096
    ds_read_b128 v[52:55], v9 offset:33792
    v_mfma_f32_16x16x32_bf16 v[212:215], v[60:63], a[52:55], v[212:215]
    v_mfma_f32_16x16x32_bf16 v[232:235], v[60:63], a[56:59], v[232:235]
    v_mfma_f32_16x16x32_bf16 v[236:239], v[64:67], a[56:59], v[236:239]
    buffer_load_dwordx4 a[8:11], v21, s[20:23], s47 offen offset:0 sc1
    ds_read_b128 v[56:59], v9 offset:34816
    v_mfma_f32_16x16x32_bf16 v[240:243], v[68:71], a[56:59], v[240:243]
    v_mfma_f32_16x16x32_bf16 v[244:247], v[72:75], a[56:59], v[244:247]
    v_mfma_f32_16x16x32_bf16 v[248:251], v[76:79], a[56:59], v[248:251]
    buffer_load_dwordx4 a[12:15], v21, s[20:23], s47 offen offset:1024 sc1
    v_mfma_f32_16x16x32_bf16 v[92:95], v[76:79], a[60:63], v[92:95]
    v_mfma_f32_16x16x32_bf16 v[88:91], v[72:75], a[60:63], v[88:91]
    v_mfma_f32_16x16x32_bf16 v[84:87], v[68:71], a[60:63], v[84:87]
    buffer_load_dword v36, v38, s[20:23], s65 offen sc1
    v_mfma_f32_16x16x32_bf16 v[80:83], v[64:67], a[60:63], v[80:83]
    v_mfma_f32_16x16x32_bf16 v[252:255], v[60:63], a[60:63], v[252:255]
    s_waitcnt vmcnt(10) lgkmcnt(0)
    v_mfma_f32_16x16x32_bf16 v[192:195], v[40:43], a[64:67], v[192:195]
    s_sub_u32 s47, s47, s41
    v_mfma_f32_16x16x32_bf16 v[196:199], v[44:47], a[64:67], v[196:199]
    ds_read_b128 v[60:63], v9 offset:35840
    v_mfma_f32_16x16x32_bf16 v[200:203], v[48:51], a[64:67], v[200:203]
    buffer_load_dwordx4 a[16:19], v21, s[20:23], s47 offen offset:2048 sc1
    v_mfma_f32_16x16x32_bf16 v[204:207], v[52:55], a[64:67], v[204:207]
    s_add_u32 s44, s44, 4096
    ds_read_b128 v[64:67], v9 offset:49152
    v_mfma_f32_16x16x32_bf16 v[208:211], v[56:59], a[64:67], v[208:211]
    v_mfma_f32_16x16x32_bf16 v[228:231], v[56:59], a[68:71], v[228:231]
    v_mfma_f32_16x16x32_bf16 v[224:227], v[52:55], a[68:71], v[224:227]
    ds_read_b128 v[68:71], v9 offset:50176
    v_mfma_f32_16x16x32_bf16 v[220:223], v[48:51], a[68:71], v[220:223]
    v_mfma_f32_16x16x32_bf16 v[216:219], v[44:47], a[68:71], v[216:219]
    buffer_load_dwordx4 a[20:23], v21, s[20:23], s44 offen offset:0 sc1
    ds_read_b128 v[72:75], v9 offset:51200
    v_mfma_f32_16x16x32_bf16 v[212:215], v[40:43], a[68:71], v[212:215]
    v_mfma_f32_16x16x32_bf16 v[232:235], v[40:43], a[72:75], v[232:235]
    v_mfma_f32_16x16x32_bf16 v[236:239], v[44:47], a[72:75], v[236:239]
    ds_read_b128 v[76:79], v9 offset:52224
    v_mfma_f32_16x16x32_bf16 v[240:243], v[48:51], a[72:75], v[240:243]
    v_mfma_f32_16x16x32_bf16 v[244:247], v[52:55], a[72:75], v[244:247]
    buffer_load_dwordx4 a[24:27], v21, s[20:23], s44 offen offset:1024 sc1
    s_sub_u32 s44, s44, s41
    v_mfma_f32_16x16x32_bf16 v[248:251], v[56:59], a[72:75], v[248:251]
    v_mfma_f32_16x16x32_bf16 v[92:95], v[56:59], a[76:79], v[92:95]
    v_mfma_f32_16x16x32_bf16 v[88:91], v[52:55], a[76:79], v[88:91]
    v_mfma_f32_16x16x32_bf16 v[84:87], v[48:51], a[76:79], v[84:87]
    v_mfma_f32_16x16x32_bf16 v[80:83], v[44:47], a[76:79], v[80:83]
    buffer_load_dwordx4 a[28:31], v21, s[20:23], s44 offen offset:2048 sc1
    v_mfma_f32_16x16x32_bf16 v[252:255], v[40:43], a[76:79], v[252:255]
    s_waitcnt vmcnt(9) lgkmcnt(0)
    v_cmp_eq_u32_e64 vcc, 0, v15
    v_mfma_f32_16x16x32_bf16 v[212:215], v[60:63], a[80:83], v[212:215]
    ds_read_b128 v[40:43], v10 offset:0
    v_mfma_f32_16x16x32_bf16 v[216:219], v[64:67], a[80:83], v[216:219]
    ds_read_b128 v[44:47], v10 offset:1024
    s_cbranch_vccnz L_slow_oqkv
L_ok_oqkv:
    v_mfma_f32_16x16x32_bf16 v[220:223], v[68:71], a[80:83], v[220:223]
    s_add_u32 s45, s45, s49
    ds_read_b128 v[48:51], v10 offset:2048
    v_mfma_f32_16x16x32_bf16 v[224:227], v[72:75], a[80:83], v[224:227]
    ds_read_b128 v[52:55], v10 offset:3072
    v_mfma_f32_16x16x32_bf16 v[228:231], v[76:79], a[80:83], v[228:231]
    buffer_load_dwordx4 a[32:35], v21, s[20:23], s45 offen offset:0 sc1
    v_mfma_f32_16x16x32_bf16 v[212:215], v[100:103], a[88:91], v[212:215]
    v_mfma_f32_16x16x32_bf16 v[216:219], v[104:107], a[88:91], v[216:219]
    v_mfma_f32_16x16x32_bf16 v[220:223], v[108:111], a[88:91], v[220:223]
    buffer_load_dwordx4 a[36:39], v21, s[20:23], s45 offen offset:1024 sc1
    v_mfma_f32_16x16x32_bf16 v[224:227], v[112:115], a[88:91], v[224:227]
    v_mfma_f32_16x16x32_bf16 v[228:231], v[116:119], a[88:91], v[228:231]
    s_waitcnt lgkmcnt(0)
    v_mfma_f32_16x16x32_bf16 v[212:215], v[40:43], a[84:87], v[212:215]
    buffer_load_dwordx4 a[40:43], v21, s[20:23], s45 offen offset:2048 sc1
    v_mfma_f32_16x16x32_bf16 v[216:219], v[44:47], a[84:87], v[216:219]
    v_mfma_f32_16x16x32_bf16 v[220:223], v[48:51], a[84:87], v[220:223]
    v_mfma_f32_16x16x32_bf16 v[224:227], v[52:55], a[84:87], v[224:227]
    buffer_load_dwordx4 a[44:47], v21, s[20:23], s45 offen offset:3072 sc1
    v_mfma_f32_16x16x32_bf16 v[228:231], v[96:99], a[84:87], v[228:231]
    v_mfma_f32_16x16x32_bf16 v[232:235], v[60:63], a[92:95], v[232:235]
    s_add_u32 s45, s45, 4096
    v_mfma_f32_16x16x32_bf16 v[236:239], v[64:67], a[92:95], v[236:239]
    ds_write_b128 v8, v[212:215] offset:0
    v_mfma_f32_16x16x32_bf16 v[240:243], v[68:71], a[92:95], v[240:243]
    buffer_load_dwordx4 a[48:51], v21, s[20:23], s45 offen offset:0 sc1
    v_mfma_f32_16x16x32_bf16 v[244:247], v[72:75], a[92:95], v[244:247]
    s_add_u32 s46, s46, s49
    ds_write_b128 v8, v[216:219] offset:16384
    v_mfma_f32_16x16x32_bf16 v[248:251], v[76:79], a[92:95], v[248:251]
    s_waitcnt vmcnt(10)
    v_mfma_f32_16x16x32_bf16 v[232:235], v[40:43], a[0:3], v[232:235]
    v_mfma_f32_16x16x32_bf16 v[236:239], v[44:47], a[0:3], v[236:239]
    ds_write_b128 v8, v[220:223] offset:32768
    v_mfma_f32_16x16x32_bf16 v[240:243], v[48:51], a[0:3], v[240:243]
    buffer_load_dwordx4 a[52:55], v21, s[20:23], s46 offen offset:0 sc1
    v_mfma_f32_16x16x32_bf16 v[244:247], v[52:55], a[0:3], v[244:247]
    ds_write_b128 v8, v[224:227] offset:49152
    v_mfma_f32_16x16x32_bf16 v[248:251], v[96:99], a[0:3], v[248:251]
    v_mfma_f32_16x16x32_bf16 v[232:235], v[100:103], a[4:7], v[232:235]
    buffer_load_dwordx4 a[56:59], v21, s[20:23], s46 offen offset:1024 sc1
    v_mfma_f32_16x16x32_bf16 v[236:239], v[104:107], a[4:7], v[236:239]
    ds_write_b128 v9, v[228:231] offset:0
    v_mfma_f32_16x16x32_bf16 v[240:243], v[108:111], a[4:7], v[240:243]
    v_mfma_f32_16x16x32_bf16 v[244:247], v[112:115], a[4:7], v[244:247]
    buffer_load_dwordx4 a[60:63], v21, s[20:23], s46 offen offset:2048 sc1
    v_mfma_f32_16x16x32_bf16 v[248:251], v[116:119], a[4:7], v[248:251]
L_isl_qkv_6:
    s_cbranch_execz L_warm_qkv_0
    v_mfma_f32_16x16x32_bf16 v[252:255], v[60:63], a[8:11], v[252:255]
    s_waitcnt vmcnt(12)
    v_mfma_f32_16x16x32_bf16 v[80:83], v[64:67], a[8:11], v[80:83]
    buffer_load_dwordx4 a[64:67], v21, s[20:23], s46 offen offset:3072 sc1
    ds_write_b128 v8, v[232:235] offset:1024
    v_mfma_f32_16x16x32_bf16 v[84:87], v[68:71], a[8:11], v[84:87]
    s_add_u32 s46, s46, 4096
    v_mfma_f32_16x16x32_bf16 v[88:91], v[72:75], a[8:11], v[88:91]
    v_mul_f32 v36, v36, v36
    ds_write_b128 v8, v[236:239] offset:17408
    v_mfma_f32_16x16x32_bf16 v[92:95], v[76:79], a[8:11], v[92:95]
    buffer_load_dwordx4 a[68:71], v21, s[20:23], s46 offen offset:0 sc1
    v_mfma_f32_16x16x32_bf16 v[252:255], v[40:43], a[12:15], v[252:255]
    s_add_u32 s47, s47, s49
    v_mfma_f32_16x16x32_bf16 v[80:83], v[44:47], a[12:15], v[80:83]
    ds_write_b128 v8, v[240:243] offset:33792
    v_mfma_f32_16x16x32_bf16 v[84:87], v[48:51], a[12:15], v[84:87]
    v_mul_f32 v38, 0xbfb8aa3b, v36
    v_mfma_f32_16x16x32_bf16 v[88:91], v[52:55], a[12:15], v[88:91]
    ds_write_b128 v8, v[244:247] offset:50176
    v_mfma_f32_16x16x32_bf16 v[92:95], v[96:99], a[12:15], v[92:95]
    buffer_load_dwordx4 a[72:75], v21, s[20:23], s47 offen offset:0 sc1
    s_waitcnt vmcnt(11)
    v_mfma_f32_16x16x32_bf16 v[252:255], v[100:103], a[16:19], v[252:255]
    v_mfma_f32_16x16x32_bf16 v[80:83], v[104:107], a[16:19], v[80:83]
    ds_write_b128 v9, v[248:251] offset:1024
    v_mfma_f32_16x16x32_bf16 v[84:87], v[108:111], a[16:19], v[84:87]
    buffer_load_dwordx4 a[76:79], v21, s[20:23], s47 offen offset:1024 sc1
    v_mfma_f32_16x16x32_bf16 v[88:91], v[112:115], a[16:19], v[88:91]
    v_rcp_f32_e64 v36, v36
    v_mfma_f32_16x16x32_bf16 v[92:95], v[116:119], a[16:19], v[92:95]
    v_mfma_f32_16x16x32_bf16 v[192:195], v[60:63], a[20:23], v[192:195]
    buffer_load_dwordx4 a[80:83], v21, s[20:23], s47 offen offset:2048 sc1
    v_mfma_f32_16x16x32_bf16 v[196:199], v[64:67], a[20:23], v[196:199]
    ds_write_b128 v8, v[252:255] offset:2048
    v_mfma_f32_16x16x32_bf16 v[200:203], v[68:71], a[20:23], v[200:203]
    v_mfma_f32_16x16x32_bf16 v[204:207], v[72:75], a[20:23], v[204:207]
    buffer_load_dwordx4 a[84:87], v21, s[20:23], s47 offen offset:3072 sc1
    ds_write_b128 v8, v[80:83] offset:18432
    v_mfma_f32_16x16x32_bf16 v[208:211], v[76:79], a[20:23], v[208:211]
    s_add_u32 s47, s47, 4096
    v_mfma_f32_16x16x32_bf16 v[192:195], v[40:43], a[24:27], v[192:195]
    v_mfma_f32_16x16x32_bf16 v[196:199], v[44:47], a[24:27], v[196:199]
    ds_write_b128 v8, v[84:87] offset:34816
    v_mfma_f32_16x16x32_bf16 v[200:203], v[48:51], a[24:27], v[200:203]
    buffer_load_dwordx4 a[88:91], v21, s[20:23], s47 offen offset:0 sc1
    v_mfma_f32_16x16x32_bf16 v[204:207], v[52:55], a[24:27], v[204:207]
    s_add_u32 s44, s44, s49
    ds_write_b128 v8, v[88:91] offset:51200
    v_mfma_f32_16x16x32_bf16 v[208:211], v[96:99], a[24:27], v[208:211]
    v_mfma_f32_16x16x32_bf16 v[192:195], v[100:103], a[28:31], v[192:195]
    v_mfma_f32_16x16x32_bf16 v[196:199], v[104:107], a[28:31], v[196:199]
    buffer_load_dwordx4 a[92:95], v21, s[20:23], s44 offen offset:0 sc1
    ds_write_b128 v9, v[92:95] offset:2048
    v_mfma_f32_16x16x32_bf16 v[200:203], v[108:111], a[28:31], v[200:203]
    v_mfma_f32_16x16x32_bf16 v[204:207], v[112:115], a[28:31], v[204:207]
    v_mfma_f32_16x16x32_bf16 v[208:211], v[116:119], a[28:31], v[208:211]
    s_waitcnt vmcnt(12)
    v_mfma_f32_16x16x32_bf16 a[144:147], v[120:123], a[32:35], 0
    v_mfma_f32_16x16x32_bf16 a[148:151], v[124:127], a[32:35], 0
    v_mfma_f32_16x16x32_bf16 a[152:155], v[128:131], a[32:35], 0
    v_mfma_f32_16x16x32_bf16 a[156:159], v[132:135], a[32:35], 0
    v_mfma_f32_16x16x32_bf16 a[160:163], v[136:139], a[32:35], 0
    v_mfma_f32_16x16x32_bf16 a[160:163], v[156:159], a[36:39], a[160:163]
    s_waitcnt lgkmcnt(0)
    s_barrier
    v_mfma_f32_16x16x32_bf16 a[156:159], v[152:155], a[36:39], a[156:159]
    buffer_load_dwordx4 a[0:3], v21, s[20:23], s44 offen offset:1024 sc1
    ds_read_b128 v[212:215], v4 offset:0
    v_mfma_f32_16x16x32_bf16 a[152:155], v[148:151], a[36:39], a[152:155]
    ds_read_b128 v[232:235], v5 offset:0
    v_mfma_f32_16x16x32_bf16 a[148:151], v[144:147], a[36:39], a[148:151]
    ds_read_b128 v[252:255], v6 offset:0
    v_mfma_f32_16x16x32_bf16 a[144:147], v[140:143], a[36:39], a[144:147]
    ds_read_b128 v[216:219], v4 offset:16384
    v_mfma_f32_16x16x32_bf16 a[144:147], v[160:163], a[40:43], a[144:147]
    buffer_load_dwordx4 a[4:7], v21, s[20:23], s44 offen offset:2048 sc1
    ds_read_b128 v[236:239], v5 offset:16384
    v_mfma_f32_16x16x32_bf16 a[148:151], v[164:167], a[40:43], a[148:151]
    ds_read_b128 v[80:83], v6 offset:16384
    v_mfma_f32_16x16x32_bf16 a[152:155], v[168:171], a[40:43], a[152:155]
    ds_read_b128 v[220:223], v4 offset:32768
    v_mfma_f32_16x16x32_bf16 a[156:159], v[172:175], a[40:43], a[156:159]
    ds_read_b128 v[240:243], v5 offset:32768
    v_mfma_f32_16x16x32_bf16 a[160:163], v[176:179], a[40:43], a[160:163]
    buffer_load_dwordx4 a[8:11], v21, s[20:23], s44 offen offset:3072 sc1
    v_mfma_f32_16x16x32_bf16 a[160:163], a[100:103], a[44:47], a[160:163]
    s_add_u32 s44, s44, 4096
    ds_read_b128 v[84:87], v6 offset:32768
    ds_read_b128 v[224:227], v4 offset:49152
    v_mfma_f32_16x16x32_bf16 a[156:159], a[96:99], a[44:47], a[156:159]
    ds_read_b128 v[244:247], v5 offset:49152
    v_mfma_f32_16x16x32_bf16 a[152:155], v[188:191], a[44:47], a[152:155]
    ds_read_b128 v[88:91], v6 offset:49152
    v_add_u32 v4, 65536, v4
    v_mfma_f32_16x16x32_bf16 a[148:151], v[184:187], a[44:47], a[148:151]
    v_add_u32 v5, 65536, v5
    v_add_u32 v6, 65536, v6
    v_mfma_f32_16x16x32_bf16 a[144:147], v[180:183], a[44:47], a[144:147]
    buffer_load_dwordx4 a[12:15], v21, s[20:23], s44 offen offset:0 sc1
    s_waitcnt vmcnt(12)
    v_mfma_f32_16x16x32_bf16 a[144:147], a[104:107], a[48:51], a[144:147]
    ds_read_b128 v[228:231], v4 offset:0
    v_mfma_f32_16x16x32_bf16 a[148:151], a[108:111], a[48:51], a[148:151]
    ds_read_b128 v[248:251], v5 offset:0
    v_mfma_f32_16x16x32_bf16 a[152:155], a[112:115], a[48:51], a[152:155]
    ds_read_b128 v[92:95], v6 offset:0
    s_waitcnt lgkmcnt(12)
    v_mfma_f32_16x16x32_bf16 a[156:159], a[116:119], a[48:51], a[156:159]
    v_add_f32 v192, v192, v212
    v_add_f32 v193, v193, v213
    v_mfma_f32_16x16x32_bf16 a[160:163], a[120:123], a[48:51], a[160:163]
    v_add_f32 v194, v194, v214
    v_add_f32 v195, v195, v215
    v_mfma_f32_16x16x32_bf16 a[164:167], v[120:123], a[52:55], 0
    s_add_u32 m0, s68, 0
    v_add_f32 v232, v232, v252
    v_add_f32_e64 v233, v233, v253
    v_mfma_f32_16x16x32_bf16 a[168:171], v[124:127], a[52:55], 0
    v_add_f32_e64 v234, v234, v254
    v_mfma_f32_16x16x32_bf16 a[172:175], v[128:131], a[52:55], 0
    v_add_f32 v235, v235, v255
    v_add_f32 v192, v192, v232
    v_mfma_f32_16x16x32_bf16 a[176:179], v[132:135], a[52:55], 0
    buffer_load_dwordx4 v18, s[8:11], s66 offen lds
    ds_write_b128 v11, a[144:147] offset:0
    v_mfma_f32_16x16x32_bf16 a[180:183], v[136:139], a[52:55], 0
    s_add_u32 m0, s68, 1024
    v_add_f32_e64 v193, v193, v233
    v_mfma_f32_16x16x32_bf16 a[180:183], v[156:159], a[56:59], a[180:183]
    v_add_f32 v194, v194, v234
    v_add_f32 v195, v195, v235
    v_mfma_f32_16x16x32_bf16 a[176:179], v[152:155], a[56:59], a[176:179]
    s_waitcnt lgkmcnt(10)
    v_add_f32 v196, v196, v216
    v_add_f32_e64 v197, v197, v217
    v_mfma_f32_16x16x32_bf16 a[172:175], v[148:151], a[56:59], a[172:175]
    ds_write_b128 v11, a[148:151] offset:1024
    v_add_f32_e64 v198, v198, v218
    v_mfma_f32_16x16x32_bf16 a[168:171], v[144:147], a[56:59], a[168:171]
    v_add_f32 v199, v199, v219
    v_add_f32 v236, v236, v80
    v_mfma_f32_16x16x32_bf16 a[164:167], v[140:143], a[56:59], a[164:167]
    v_add_f32_e64 v237, v237, v81
    v_mfma_f32_16x16x32_bf16 a[164:167], v[160:163], a[60:63], a[164:167]
    v_add_f32_e64 v238, v238, v82
    ds_write_b128 v11, a[152:155] offset:2048
    v_mfma_f32_16x16x32_bf16 a[168:171], v[164:167], a[60:63], a[168:171]
    buffer_load_dwordx4 v19, s[8:11], s66 offen lds
    v_add_f32_e64 v239, v239, v83
    v_mfma_f32_16x16x32_bf16 a[172:175], v[168:171], a[60:63], a[172:175]
    s_add_u32 m0, s68, 2048
    v_add_f32 v196, v196, v236
    v_add_f32 v197, v197, v237
    v_mfma_f32_16x16x32_bf16 a[176:179], v[172:175], a[60:63], a[176:179]
    v_add_f32 v198, v198, v238
    v_add_f32 v199, v199, v239
    v_mfma_f32_16x16x32_bf16 a[180:183], v[176:179], a[60:63], a[180:183]
    s_waitcnt lgkmcnt(9)
    ds_write_b128 v11, a[156:159] offset:3072
    s_waitcnt vmcnt(10)
    v_mfma_f32_16x16x32_bf16 a[180:183], a[100:103], a[64:67], a[180:183]
    v_add_f32 v200, v200, v220
    v_add_f32 v201, v201, v221
    v_mfma_f32_16x16x32_bf16 a[176:179], a[96:99], a[64:67], a[176:179]
    v_add_f32 v202, v202, v222
    v_add_f32 v203, v203, v223
    v_mfma_f32_16x16x32_bf16 a[172:175], v[188:191], a[64:67], a[172:175]
    v_add_f32_e64 v240, v240, v84
    v_mfma_f32_16x16x32_bf16 a[168:171], v[184:187], a[64:67], a[168:171]
    buffer_load_dwordx4 v20, s[8:11], s66 offen lds
    v_add_f32_e64 v241, v241, v85
    v_mfma_f32_16x16x32_bf16 a[164:167], v[180:183], a[64:67], a[164:167]
    v_add_f32_e64 v242, v242, v86
    v_mfma_f32_16x16x32_bf16 a[164:167], a[104:107], a[68:71], a[164:167]
    v_add_f32_e64 v243, v243, v87
    ds_write_b128 v11, a[160:163] offset:4096
    v_mfma_f32_16x16x32_bf16 a[168:171], a[108:111], a[68:71], a[168:171]
    v_add_f32 v200, v200, v240
    v_add_f32 v201, v201, v241
    v_mfma_f32_16x16x32_bf16 a[172:175], a[112:115], a[68:71], a[172:175]
    v_add_f32 v202, v202, v242
    v_add_f32 v203, v203, v243
    v_mfma_f32_16x16x32_bf16 a[176:179], a[116:119], a[68:71], a[176:179]
    s_waitcnt lgkmcnt(8)
    v_add_f32 v204, v204, v224
    v_mfma_f32_16x16x32_bf16 a[180:183], a[120:123], a[68:71], a[180:183]
    v_add_f32_e64 v205, v205, v225
    v_mfma_f32_16x16x32_bf16 a[184:187], v[120:123], a[72:75], 0
    v_add_f32 v206, v206, v226
    v_add_f32 v207, v207, v227
    v_mfma_f32_16x16x32_bf16 a[188:191], v[124:127], a[72:75], 0
    v_add_f32_e64 v244, v244, v88
    v_mfma_f32_16x16x32_bf16 a[192:195], v[128:131], a[72:75], 0
    v_add_f32_e64 v245, v245, v89
    ds_write_b128 v11, a[164:167] offset:5120
    v_mfma_f32_16x16x32_bf16 a[196:199], v[132:135], a[72:75], 0
    v_add_f32 v246, v246, v90
    v_add_f32 v247, v247, v91
    v_mfma_f32_16x16x32_bf16 a[200:203], v[136:139], a[72:75], 0
    v_add_f32_e64 v204, v204, v244
    v_mfma_f32_16x16x32_bf16 a[200:203], v[156:159], a[76:79], a[200:203]
    v_add_f32 v205, v205, v245
    v_add_f32 v206, v206, v246
    v_mfma_f32_16x16x32_bf16 a[196:199], v[152:155], a[76:79], a[196:199]
    v_add_f32_e64 v207, v207, v247
    ds_write_b128 v11, a[168:171] offset:6144
    v_mfma_f32_16x16x32_bf16 a[192:195], v[148:151], a[76:79], a[192:195]
    s_waitcnt lgkmcnt(7)
    v_add_f32 v208, v208, v228
    v_mfma_f32_16x16x32_bf16 a[188:191], v[144:147], a[76:79], a[188:191]
    v_add_f32_e64 v209, v209, v229
    v_mfma_f32_16x16x32_bf16 a[184:187], v[140:143], a[76:79], a[184:187]
    v_add_f32 v210, v210, v230
    s_waitcnt vmcnt(7)
    v_mfma_f32_16x16x32_bf16 a[184:187], v[160:163], a[80:83], a[184:187]
    v_add_f32 v211, v211, v231
    v_add_f32 v248, v248, v92
    v_mfma_f32_16x16x32_bf16 a[188:191], v[164:167], a[80:83], a[188:191]
    v_add_f32_e64 v249, v249, v93
    ds_write_b128 v11, a[172:175] offset:7168
    v_mfma_f32_16x16x32_bf16 a[192:195], v[168:171], a[80:83], a[192:195]
    v_add_f32 v250, v250, v94
    v_add_f32 v251, v251, v95
    v_mfma_f32_16x16x32_bf16 a[196:199], v[172:175], a[80:83], a[196:199]
    v_add_f32 v208, v208, v248
    v_add_f32 v209, v209, v249
    v_mfma_f32_16x16x32_bf16 a[200:203], v[176:179], a[80:83], a[200:203]
    v_add_f32_e64 v210, v210, v250
    v_mfma_f32_16x16x32_bf16 a[200:203], a[100:103], a[84:87], a[200:203]
    v_add_f32_e64 v211, v211, v251
    ds_write_b128 v11, a[176:179] offset:8192
    v_mfma_f32_16x16x32_bf16 a[196:199], a[96:99], a[84:87], a[196:199]
    v_mul_f32 v26, v38, v192
    v_mul_f32 v27, v38, v193
    v_mfma_f32_16x16x32_bf16 a[192:195], v[188:191], a[84:87], a[192:195]
    v_mul_f32_e64 v28, v38, v194
    v_mfma_f32_16x16x32_bf16 a[188:191], v[184:187], a[84:87], a[188:191]
    v_mul_f32_e64 v29, v38, v195
    ds_write_b128 v11, a[180:183] offset:9216
    v_mfma_f32_16x16x32_bf16 a[184:187], v[180:183], a[84:87], a[184:187]
    v_mfma_f32_16x16x32_bf16 a[184:187], a[104:107], a[88:91], a[184:187]
    v_exp_f32_e64 v26, v26
    v_mfma_f32_16x16x32_bf16 a[188:191], a[108:111], a[88:91], a[188:191]
    v_exp_f32_e64 v27, v27
    v_mfma_f32_16x16x32_bf16 a[192:195], a[112:115], a[88:91], a[192:195]
    v_exp_f32 v28, v28
    v_exp_f32 v29, v29
    v_mfma_f32_16x16x32_bf16 a[196:199], a[116:119], a[88:91], a[196:199]
    v_fma_f32 v26, v26, v36, v36
    v_fma_f32 v27, v27, v36, v36
    v_fma_f32 v28, v28, v36, v36
    v_mfma_f32_16x16x32_bf16 a[200:203], a[120:123], a[88:91], a[200:203]
    v_fma_f32 v29, v29, v36, v36
    v_rcp_f32_e64 v26, v26
    v_mfma_f32_16x16x32_bf16 v[40:43], v[120:123], a[92:95], 0
    v_rcp_f32_e64 v27, v27
    v_mfma_f32_16x16x32_bf16 v[44:47], v[124:127], a[92:95], 0
    v_rcp_f32_e64 v28, v28
    v_mfma_f32_16x16x32_bf16 v[48:51], v[128:131], a[92:95], 0
    v_rcp_f32_e64 v29, v29
    v_mfma_f32_16x16x32_bf16 v[52:55], v[132:135], a[92:95], 0
    ds_write_b128 v11, a[184:187] offset:10240
    v_mul_f32_e64 v192, v192, v26
    v_mfma_f32_16x16x32_bf16 v[56:59], v[136:139], a[92:95], 0
    v_mul_f32 v193, v193, v27
    s_waitcnt vmcnt(3)
    v_mfma_f32_16x16x32_bf16 v[56:59], v[156:159], a[0:3], v[56:59]
    s_waitcnt vmcnt(0)
    ds_write_b128 v11, a[188:191] offset:11264
    v_mul_f32 v194, v194, v28
    v_mfma_f32_16x16x32_bf16 v[52:55], v[152:155], a[0:3], v[52:55]
    v_mul_f32_e64 v195, v195, v29
    ds_write_b128 v11, a[192:195] offset:12288
    v_mfma_f32_16x16x32_bf16 v[48:51], v[148:151], a[0:3], v[48:51]
    v_mul_f32_e64 v30, v38, v196
    ds_read_b64 v[62:63], v35 offset:0
    v_mfma_f32_16x16x32_bf16 v[44:47], v[144:147], a[0:3], v[44:47]
    v_mul_f32 v31, v38, v197
    v_mul_f32 v32, v38, v198
    v_mfma_f32_16x16x32_bf16 v[40:43], v[140:143], a[0:3], v[40:43]
    ds_write_b128 v11, a[196:199] offset:13312
    v_mfma_f32_16x16x32_bf16 v[40:43], v[160:163], a[4:7], v[40:43]
    ds_read_b64 v[66:67], v35 offset:32
    v_mul_f32_e64 v33, v38, v199
    v_mfma_f32_16x16x32_bf16 v[44:47], v[164:167], a[4:7], v[44:47]
    v_exp_f32_e64 v30, v30
    v_mfma_f32_16x16x32_bf16 v[48:51], v[168:171], a[4:7], v[48:51]
    v_exp_f32_e64 v31, v31
    v_mfma_f32_16x16x32_bf16 v[52:55], v[172:175], a[4:7], v[52:55]
    ds_read_b64 v[70:71], v35 offset:64
    ds_read_b64 v[74:75], v35 offset:96
    ds_write_b128 v11, a[200:203] offset:14336
    v_mfma_f32_16x16x32_bf16 v[56:59], v[176:179], a[4:7], v[56:59]
    ds_read_b64 v[78:79], v35 offset:128
    v_mfma_f32_16x16x32_bf16 v[56:59], a[100:103], a[8:11], v[56:59]
    v_exp_f32 v32, v32
    v_exp_f32 v33, v33
    v_fma_f32 v30, v30, v36, v36
    v_mfma_f32_16x16x32_bf16 v[52:55], a[96:99], a[8:11], v[52:55]
    v_fma_f32 v31, v31, v36, v36
    v_fma_f32 v32, v32, v36, v36
    s_waitcnt lgkmcnt(0)
    s_barrier
    v_mfma_f32_16x16x32_bf16 v[48:51], v[188:191], a[8:11], v[48:51]
    ds_read_b128 v[212:215], v7 offset:0
    v_fma_f32 v33, v33, v36, v36
    ds_read_b128 v[232:235], v25 offset:0
    v_rcp_f32_e64 v30, v30
    v_mfma_f32_16x16x32_bf16 v[44:47], v[184:187], a[8:11], v[44:47]
    ds_read_b128 v[252:255], v34 offset:0
    ds_read_b128 v[216:219], v7 offset:1024
    v_rcp_f32_e64 v31, v31
    v_mfma_f32_16x16x32_bf16 v[40:43], v[180:183], a[8:11], v[40:43]
    ds_read_b128 v[236:239], v25 offset:1024
    ds_read_b128 v[80:83], v34 offset:1024
    v_rcp_f32_e64 v32, v32
    v_mfma_f32_16x16x32_bf16 v[40:43], a[104:107], a[12:15], v[40:43]
    ds_read_b128 v[220:223], v7 offset:2048
    ds_read_b128 v[240:243], v25 offset:2048
    v_rcp_f32_e64 v33, v33
    v_mfma_f32_16x16x32_bf16 v[44:47], a[108:111], a[12:15], v[44:47]
    ds_read_b128 v[84:87], v34 offset:2048
    v_mul_f32_e64 v196, v196, v30
    ds_read_b128 v[224:227], v7 offset:3072
    v_mul_f32_e64 v197, v197, v31
    v_mfma_f32_16x16x32_bf16 v[48:51], a[112:115], a[12:15], v[48:51]
    ds_read_b128 v[244:247], v25 offset:3072
    ds_read_b128 v[88:91], v34 offset:3072
    v_mfma_f32_16x16x32_bf16 v[52:55], a[116:119], a[12:15], v[52:55]
    v_mul_f32_e64 v198, v198, v32
    ds_read_b128 v[228:231], v7 offset:4096
    ds_read_b128 v[248:251], v25 offset:4096
    v_mfma_f32_16x16x32_bf16 v[56:59], a[120:123], a[12:15], v[56:59]
    v_mul_f32_e64 v199, v199, v33
    ds_read_b128 v[92:95], v34 offset:4096
    v_lshlrev_b32_e64 v60, 16, v62
    v_and_b32 v61, 0xffff0000, v62
    v_lshlrev_b32_e64 v62, 16, v63
    v_and_b32 v63, 0xffff0000, v63
    v_lshlrev_b32_e64 v64, 16, v66
    v_and_b32 v65, 0xffff0000, v66
    v_lshlrev_b32_e64 v66, 16, v67
    v_and_b32 v67, 0xffff0000, v67
    v_lshlrev_b32_e64 v68, 16, v70
    v_and_b32 v69, 0xffff0000, v70
    v_lshlrev_b32_e64 v70, 16, v71
    v_and_b32 v71, 0xffff0000, v71
    v_lshlrev_b32_e64 v72, 16, v74
    v_and_b32 v73, 0xffff0000, v74
    v_lshlrev_b32_e64 v74, 16, v75
    v_and_b32 v75, 0xffff0000, v75
    v_lshlrev_b32_e64 v76, 16, v78
    v_and_b32 v77, 0xffff0000, v78
    v_lshlrev_b32_e64 v78, 16, v79
    v_and_b32 v79, 0xffff0000, v79
    v_pk_mul_f32 v[12:13], v[200:201], v[38:39] op_sel_hi:[1,0]
    v_pk_mul_f32 v[26:27], v[204:205], v[38:39] op_sel_hi:[1,0]
    v_pk_mul_f32 v[30:31], v[208:209], v[38:39] op_sel_hi:[1,0]
    v_pk_mul_f32 v[14:15], v[202:203], v[38:39] op_sel_hi:[1,0]
    v_pk_mul_f32 v[28:29], v[206:207], v[38:39] op_sel_hi:[1,0]
    v_pk_mul_f32 v[32:33], v[210:211], v[38:39] op_sel_hi:[1,0]
    v_exp_f32 v12, v12
    v_exp_f32 v26, v26
    v_exp_f32 v30, v30
    v_exp_f32 v13, v13
    v_exp_f32 v27, v27
    v_exp_f32 v31, v31
    v_exp_f32 v14, v14
    v_exp_f32 v28, v28
    v_exp_f32 v32, v32
    v_exp_f32 v15, v15
    v_exp_f32 v29, v29
    v_exp_f32 v33, v33
    v_pk_fma_f32 v[12:13], v[12:13], v[36:37], v[36:37] op_sel_hi:[1,0,0]
    v_pk_fma_f32 v[26:27], v[26:27], v[36:37], v[36:37] op_sel_hi:[1,0,0]
    v_pk_fma_f32 v[30:31], v[30:31], v[36:37], v[36:37] op_sel_hi:[1,0,0]
    v_pk_fma_f32 v[14:15], v[14:15], v[36:37], v[36:37] op_sel_hi:[1,0,0]
    v_pk_fma_f32 v[28:29], v[28:29], v[36:37], v[36:37] op_sel_hi:[1,0,0]
    v_pk_fma_f32 v[32:33], v[32:33], v[36:37], v[36:37] op_sel_hi:[1,0,0]
    v_rcp_f32 v12, v12
    v_rcp_f32 v26, v26
    v_rcp_f32 v30, v30
    v_rcp_f32 v13, v13
    v_rcp_f32 v27, v27
    v_rcp_f32 v31, v31
    v_rcp_f32 v14, v14
    v_rcp_f32 v28, v28
    v_rcp_f32 v32, v32
    v_rcp_f32 v15, v15
    v_rcp_f32 v29, v29
    v_rcp_f32 v33, v33
    v_pk_mul_f32 v[200:201], v[200:201], v[12:13]
    v_pk_mul_f32 v[204:205], v[204:205], v[26:27]
    v_pk_mul_f32 v[208:209], v[208:209], v[30:31]
    v_pk_mul_f32 v[202:203], v[202:203], v[14:15]
    v_pk_mul_f32 v[206:207], v[206:207], v[28:29]
    v_pk_mul_f32 v[210:211], v[210:211], v[32:33]
    s_waitcnt lgkmcnt(12)
    s_nop 0
    v_pk_add_f32 v[40:41], v[40:41], v[212:213]
    v_pk_add_f32 v[42:43], v[42:43], v[214:215]
    v_pk_add_f32 v[232:233], v[232:233], v[252:253]
    v_pk_add_f32 v[234:235], v[234:235], v[254:255]
    v_pk_add_f32 v[40:41], v[40:41], v[232:233]
    v_pk_add_f32 v[42:43], v[42:43], v[234:235]
    v_pk_fma_f32 v[40:41], v[40:41], v[192:193], v[60:61]
    v_pk_fma_f32 v[42:43], v[42:43], v[194:195], v[62:63]
    v_cvt_pk_bf16_f32 v40, v40, v41
    v_cvt_pk_bf16_f32 v41, v42, v43
    ds_write_b64 v37, v[40:41] offset:0
    s_waitcnt lgkmcnt(10)
    s_nop 0
    v_pk_add_f32 v[44:45], v[44:45], v[216:217]
    v_pk_add_f32 v[46:47], v[46:47], v[218:219]
    v_pk_add_f32 v[236:237], v[236:237], v[80:81]
    v_pk_add_f32 v[238:239], v[238:239], v[82:83]
    v_pk_add_f32 v[44:45], v[44:45], v[236:237]
    v_pk_add_f32 v[46:47], v[46:47], v[238:239]
    v_pk_fma_f32 v[44:45], v[44:45], v[196:197], v[64:65]
    v_pk_fma_f32 v[46:47], v[46:47], v[198:199], v[66:67]
    v_cvt_pk_bf16_f32 v44, v44, v45
    v_cvt_pk_bf16_f32 v45, v46, v47
    ds_write_b64 v37, v[44:45] offset:32
    s_waitcnt lgkmcnt(8)
    s_nop 0
    v_pk_add_f32 v[48:49], v[48:49], v[220:221]
    v_pk_add_f32 v[50:51], v[50:51], v[222:223]
    v_pk_add_f32 v[240:241], v[240:241], v[84:85]
    v_pk_add_f32 v[242:243], v[242:243], v[86:87]
    v_pk_add_f32 v[48:49], v[48:49], v[240:241]
    v_pk_add_f32 v[50:51], v[50:51], v[242:243]
    v_pk_fma_f32 v[48:49], v[48:49], v[200:201], v[68:69]
    v_pk_fma_f32 v[50:51], v[50:51], v[202:203], v[70:71]
    v_cvt_pk_bf16_f32 v48, v48, v49
    v_cvt_pk_bf16_f32 v49, v50, v51
    ds_write_b64 v37, v[48:49] offset:64
    s_waitcnt lgkmcnt(6)
    s_nop 0
    v_pk_add_f32 v[52:53], v[52:53], v[224:225]
    v_pk_add_f32 v[54:55], v[54:55], v[226:227]
    v_pk_add_f32 v[244:245], v[244:245], v[88:89]
    v_pk_add_f32 v[246:247], v[246:247], v[90:91]
    v_pk_add_f32 v[52:53], v[52:53], v[244:245]
    v_pk_add_f32 v[54:55], v[54:55], v[246:247]
    v_pk_fma_f32 v[52:53], v[52:53], v[204:205], v[72:73]
    v_pk_fma_f32 v[54:55], v[54:55], v[206:207], v[74:75]
    v_cvt_pk_bf16_f32 v52, v52, v53
    v_cvt_pk_bf16_f32 v53, v54, v55
    ds_write_b64 v37, v[52:53] offset:96
    s_waitcnt lgkmcnt(4)
    s_nop 0
    v_pk_add_f32 v[56:57], v[56:57], v[228:229]
    v_pk_add_f32 v[58:59], v[58:59], v[230:231]
    v_pk_add_f32 v[248:249], v[248:249], v[92:93]
    v_pk_add_f32 v[250:251], v[250:251], v[94:95]
    v_pk_add_f32 v[56:57], v[56:57], v[248:249]
    v_pk_add_f32 v[58:59], v[58:59], v[250:251]
    v_pk_fma_f32 v[56:57], v[56:57], v[208:209], v[76:77]
    v_pk_fma_f32 v[58:59], v[58:59], v[210:211], v[78:79]
    v_cvt_pk_bf16_f32 v56, v56, v57
    v_cvt_pk_bf16_f32 v57, v58, v59
    ds_write_b64 v37, v[56:57] offset:128
    ds_read_b128 v[212:215], v8 offset:0
    ds_read_b128 v[216:219], v8 offset:1024
    ds_read_b128 v[220:223], v8 offset:2048
    s_waitcnt lgkmcnt(2)
    buffer_store_dwordx4 v[212:215], v18, s[28:31], s66 offen nt
    s_waitcnt lgkmcnt(1)
    buffer_store_dwordx4 v[216:219], v19, s[28:31], s66 offen nt
    s_waitcnt lgkmcnt(0)
    buffer_store_dwordx4 v[220:223], v20, s[28:31], s66 offen nt
L_exit:
    s_endpgm
L_slow_csqkv:
    s_mov_b32 s7, 0
L_spin_csqkv:
    s_sleep 1
    buffer_load_dwordx2 v[48:49], v60, s[20:23], s42 offen offset:0 sc1
    buffer_load_dwordx2 v[50:51], v60, s[20:23], s42 offen offset:512 sc1
    buffer_load_dwordx2 v[52:53], v60, s[20:23], s42 offen offset:1024 sc1
    buffer_load_dwordx2 v[54:55], v60, s[20:23], s42 offen offset:1536 sc1
    s_waitcnt vmcnt(0)
    s_nop 0
    v_max3_u32 v61, v48, v49, v50
    v_max3_u32 v61, v61, v51, v52
    v_max3_u32 v61, v61, v53, v54
    v_max_u32 v61, v61, v55
    v_cmp_eq_u32 vcc, -1, v61
    v_accvgpr_write_b32 a112, v48
    v_accvgpr_write_b32 a113, v49
    v_accvgpr_write_b32 a114, v50
    v_accvgpr_write_b32 a115, v51
    v_accvgpr_write_b32 a116, v52
    v_accvgpr_write_b32 a117, v53
    v_accvgpr_write_b32 a118, v54
    v_accvgpr_write_b32 a119, v55
    s_add_u32 s7, s7, 1
    s_cmp_ge_u32 s7, 0x40000
    s_cbranch_scc1 L_ok_csqkv
    s_cbranch_vccnz L_spin_csqkv
    s_branch L_ok_csqkv
L_slow_rqkv:
    s_mov_b32 s7, 0
L_spin_rqkv:
    s_sleep 1
    buffer_load_dword v47, off, s[32:35], 0 sc1
    s_waitcnt vmcnt(0)
    v_cmp_eq_u32 vcc, 0, v47
    s_add_u32 s7, s7, 1
    s_cmp_ge_u32 s7, 0x40000
    s_cbranch_scc1 L_ok_rqkv
    s_nop 1
    s_cbranch_vccnz L_spin_rqkv
    s_branch L_ok_rqkv
L_slow_s1qkv:
    s_mov_b32 s7, 0
L_spin_s1qkv:
    s_sleep 1
    buffer_load_dword v47, v46, s[20:23], 0 offen sc1
    s_waitcnt vmcnt(0)
    v_cmp_eq_u32 vcc, 0, v47
    s_add_u32 s7, s7, 1
    s_cmp_ge_u32 s7, 0x40000
    s_cbranch_scc1 L_ok_s1qkv
    s_nop 1
    s_cbranch_vccnz L_spin_s1qkv
    s_branch L_ok_s1qkv
L_slow_lqkv:
    s_mov_b32 s7, 0
L_spin_lqkv:
    s_sleep 1
    buffer_load_dword v15, v23, s[20:23], s53 offen sc1
    s_waitcnt vmcnt(0)
    v_cmp_eq_u32 vcc, 0, v15
    s_add_u32 s7, s7, 1
    s_cmp_ge_u32 s7, 0x40000
    s_cbranch_scc1 L_ok_lqkv
    s_nop 1
    s_cbranch_vccnz L_spin_lqkv
    s_branch L_ok_lqkv
L_slow_oqkv:
    s_mov_b32 s7, 0
L_spin_oqkv:
    s_sleep 1
    buffer_load_dword v15, v24, s[20:23], s54 offen sc1
    s_waitcnt vmcnt(0)
    v_cmp_eq_u32 vcc, 0, v15
    s_add_u32 s7, s7, 1
    s_cmp_ge_u32 s7, 0x40000
    s_cbranch_scc1 L_ok_oqkv
    s_nop 1
    s_cbranch_vccnz L_spin_oqkv
    s_branch L_ok_oqkv
CODE_END:
.section .rodata,"a"
.p2align 6
.amdhsa_kernel recurrent_scan__sliding_local_dilated__glu_gated_reglu__prompt_kernel
  .amdhsa_next_free_vgpr 512
  .amdhsa_next_free_sgpr 102
  .amdhsa_accum_offset 256
  .amdhsa_group_segment_fixed_size 0
  .amdhsa_kernarg_size 80
  .amdhsa_user_sgpr_count 2
  .amdhsa_user_sgpr_kernarg_segment_ptr 1
  .amdhsa_system_sgpr_workgroup_id_x 1
  .amdhsa_float_denorm_mode_32 3
.end_amdhsa_kernel
```
